```python
import torch

def _softmax(x, axis=-1):
    return torch.softmax(x, dim=axis)
def _gelu(x):
    return torch.nn.functional.gelu(x, approximate="tanh")
def _silu(x):
    return torch.nn.functional.silu(x)
def _sigmoid(x):
    return torch.sigmoid(x)
def _layernorm(x, axis=-1, eps=1e-5):
    m = x.mean(dim=axis, keepdim=True)
    v = x.var(dim=axis, keepdim=True, unbiased=False)
    return (x - m) / torch.sqrt(v + eps)
def _scatter_add(tgt, idx, src, axis=0):
    return tgt.clone().index_add_(axis, idx, src)
def _segment_sum(src, seg, n):
    out = torch.zeros((n,) + src.shape[1:], dtype=src.dtype)
    return out.index_add_(0, seg, src)
def _pad(x, pw):
    flat = tuple(v for pair in reversed(pw) for v in pair)
    return torch.nn.functional.pad(x, flat)

kernel_name = 'interleave_layers__linear_attn_block__geglu_ffn__prompt'

def setup_inputs():

    _w = (lambda a: (lambda t: t.to(torch.bfloat16) if t.is_floating_point() else t)(torch.as_tensor(a)))
    def _A_setup():
        B, S, D = 1, 2048, 640
        return {
            "x": _w((lambda *s: torch.randn(*s, dtype=torch.bfloat16) * 0.05)(B, S, D)),
            "wqkv": _w((lambda *s: torch.randn(*s, dtype=torch.bfloat16) * 0.05)(D, 3 * D)),
            "wo": _w((lambda *s: torch.randn(*s, dtype=torch.bfloat16) * 0.05)(D, D)),
        }
    _A_in = _A_setup()

    def _B_setup():
        B, S, D, F = 1, 2048, 640, 1536
        return {
            "x": _w((lambda *s: torch.randn(*s, dtype=torch.bfloat16) * 0.05)(B, S, D)),
            "w_gate": _w((lambda *s: torch.randn(*s, dtype=torch.bfloat16) * 0.05)(D, F)),
            "w_up": _w((lambda *s: torch.randn(*s, dtype=torch.bfloat16) * 0.05)(D, F)),
            "w_down": _w((lambda *s: torch.randn(*s, dtype=torch.bfloat16) * 0.05)(F, D)),
        }
    _B_in = _B_setup()

    return {
        "A_x": _A_in["x"],
        "A_wqkv": _A_in["wqkv"],
        "A_wo": _A_in["wo"],
        "B_x": _B_in["x"],
        "B_w_gate": _B_in["w_gate"],
        "B_w_up": _B_in["w_up"],
        "B_w_down": _B_in["w_down"],
    }

def reference(A_x, A_wqkv, A_wo, B_x, B_w_gate, B_w_up, B_w_down):
    def _A_ref(x, wqkv, wo):
        B, S, D = x.shape
        H = 32; Dh = D // H
        qkv = (lambda x, *d: x.permute(*d))((x @ wqkv).reshape(B, S, 3, H, Dh), 2, 0, 3, 1, 4)
        q, k, v = qkv[0], qkv[1], qkv[2]
        phi = lambda t: torch.where(t > 0, t + 1, torch.exp(t)) + 1e-6
        pq, pk = phi(q), phi(k)
        kv = torch.einsum("bhsd,bhse->bhde", pk, v)
        z = torch.einsum("bhsd->bhd", pk)
        num = torch.einsum("bhqd,bhde->bhqe", pq, kv)
        den = torch.einsum("bhqd,bhd->bhq", pq, z)[..., None] + 1e-6
        o = num / den
        return (lambda x, *d: x.permute(*d))(o, 0, 2, 1, 3).reshape(B, S, D) @ wo

    def _B_ref(x, w_gate, w_up, w_down):
        return (_gelu(x @ w_gate) * (x @ w_up)) @ w_down

    x = A_x
    x = x + _A_ref(_layernorm(x, axis=-1), A_wqkv, A_wo)
    x = x + _B_ref(_layernorm(x, axis=-1), B_w_gate, B_w_up, B_w_down)
    x = x + _A_ref(_layernorm(x, axis=-1), A_wqkv, A_wo)
    x = x + _B_ref(_layernorm(x, axis=-1), B_w_gate, B_w_up, B_w_down)
    return x
```

```asm
; @launch grid=(256,1,1) block=(256,1,1) lds=163840
.amdgcn_target "amdgcn-amd-amdhsa--gfx950"
.text
.globl interleave_layers__linear_attn_block__geglu_ffn__prompt_kernel
.p2align 8
.type interleave_layers__linear_attn_block__geglu_ffn__prompt_kernel,@function
interleave_layers__linear_attn_block__geglu_ffn__prompt_kernel:
s_cmp_ge_u32 s2, 256
s_cbranch_scc1 L_end
s_load_dwordx2 s[4:5], s[0:1], 72
s_load_dwordx4 s[84:87], s[0:1], 0
s_load_dwordx2 s[88:89], s[0:1], 16
s_load_dwordx2 s[90:91], s[0:1], 32
s_load_dwordx2 s[92:93], s[0:1], 40
s_load_dwordx2 s[96:97], s[0:1], 48
s_load_dwordx2 s[94:95], s[0:1], 64
v_lshrrev_b32 v1, 6, v0
s_nop 0
v_readfirstlane_b32 s10, v1
v_and_b32 v1, 63, v0
v_lshlrev_b32 v2, 4, v1
v_and_b32 v3, 15, v1
v_lshrrev_b32 v4, 4, v1
s_mov_b32 s6, 39284736
s_mov_b32 s7, 0x20000
s_lshl_b32 s38, s10, 8
s_add_u32 s38, s38, s2
s_sub_u32 s16, s38, 160
s_cmp_lt_u32 s2, 160
s_cselect_b32 s16, s2, s16
s_cmp_eq_u32 s10, 2
s_cselect_b32 s38, s16, s38
s_add_u32 s39, s2, 256
s_sub_u32 s16, 767, s2
s_cmp_eq_u32 s10, 2
s_cselect_b32 s39, s16, s39
s_cmp_eq_u32 s10, 3
s_cselect_b32 s39, s2, s39
s_cmp_eq_u32 s10, 0
s_cselect_b32 s39, 0x1000, s39
s_lshl_b32 s18, s10, 14
s_lshl_b32 s37, s10, 13
s_add_u32 s37, s37, 0x20000
s_mov_b32 s23, 0x20000
s_mov_b32 s35, 0x20000
s_cmp_lt_u32 s38, 160
s_cbranch_scc1 L_i_w1
s_cmp_lt_u32 s38, 416
s_cbranch_scc1 L_i_x
s_cmp_lt_u32 s38, 516
s_cbranch_scc1 L_i_w2
s_waitcnt lgkmcnt(0)
s_cmp_lt_u32 s38, 563
s_cbranch_scc0 L_i_b
s_sub_u32 s16, s38, 516
s_cmp_ge_u32 s16, 14
s_cselect_b32 s17, 14417920, 0
s_cmp_ge_u32 s16, 28
s_cselect_b32 s17, 0xffd09000, s17
s_cmp_ge_u32 s16, 31
s_cselect_b32 s17, 0xffd29000, s17
s_add_u32 s17, s17, 12496896
s_lshl_b32 s16, s16, 12
s_add_u32 s17, s17, s16
v_mov_b32 v16, 0
v_mov_b32 v17, 0
v_mov_b32 v18, 0
v_mov_b32 v19, 0
buffer_store_dwordx4 v[16:19], v2, s[4:7], s17 offen offset:0 sc1
buffer_store_dwordx4 v[16:19], v2, s[4:7], s17 offen offset:1024 sc1
buffer_store_dwordx4 v[16:19], v2, s[4:7], s17 offen offset:2048 sc1
buffer_store_dwordx4 v[16:19], v2, s[4:7], s17 offen offset:3072 sc1
s_branch L_i_b
L_i_w1:
s_and_b32 s24, s38, 7
s_mul_i32 s24, s24, 20
s_lshr_b32 s25, s38, 3
s_add_u32 s25, s25, s24
s_lshr_b32 s24, s25, 3
s_and_b32 s25, s25, 7
v_mul_u32_u24 v12, 205, v1
v_lshrrev_b32 v12, 11, v12
v_mul_u32_u24 v13, 10, v12
v_sub_u32 v13, v1, v13
v_cmp_le_u32 vcc, 3, v12
s_nop 1
v_cndmask_b32 v14, 0, 1, vcc
v_mul_u32_u24 v15, 3, v14
v_sub_u32 v12, v12, v15
v_add_u32_e64 v12, 1, v12
v_cmp_eq_u32 vcc, 3, v12
s_nop 1
v_cndmask_b32 v12, v12, 0, vcc
v_mul_u32_u24 v12, 1280, v12
v_lshl_add_u32 v12, v13, 4, v12
v_mul_u32_u24 v14, 3840, v14
s_mul_i32 s17, s24, 122880
s_mul_i32 s19, s25, 160
s_add_u32 s17, s17, s19
s_mul_i32 s19, s10, 30720
s_add_u32 s17, s17, s19
s_lshl_b32 s18, s10, 12
v_add3_u32 v12, v12, v14, s17
v_mov_b32 v13, 0x40000000
v_cmp_gt_u32 vcc, 60, v1
s_nop 1
v_cndmask_b32 v12, v13, v12, vcc
s_mov_b32 s22, 2457600
s_waitcnt lgkmcnt(0)
s_mov_b32 s20, s86
s_mov_b32 s21, s87
s_add_u32 m0, s18, 0
s_mov_b32 s19, 0
buffer_load_dwordx4 v12, s[20:23], s19 offen lds
s_add_u32 m0, s18, 1024
s_mov_b32 s19, 7680
buffer_load_dwordx4 v12, s[20:23], s19 offen lds
s_add_u32 m0, s18, 2048
s_mov_b32 s19, 15360
buffer_load_dwordx4 v12, s[20:23], s19 offen lds
s_add_u32 m0, s18, 3072
s_mov_b32 s19, 23040
buffer_load_dwordx4 v12, s[20:23], s19 offen lds
s_add_u32 m0, s18, 4096
s_mov_b32 s19, 30720
buffer_load_dwordx4 v12, s[20:23], s19 offen lds
s_add_u32 m0, s18, 5120
s_mov_b32 s19, 38400
buffer_load_dwordx4 v12, s[20:23], s19 offen lds
s_add_u32 m0, s18, 6144
s_mov_b32 s19, 46080
buffer_load_dwordx4 v12, s[20:23], s19 offen lds
s_add_u32 m0, s18, 7168
s_mov_b32 s19, 53760
buffer_load_dwordx4 v12, s[20:23], s19 offen lds
s_branch L_i_b
L_i_x:
s_sub_u32 s16, s38, 160
s_lshr_b32 s24, s16, 1
s_and_b32 s25, s16, 1
s_mul_i32 s17, s24, 20480
s_mul_i32 s19, s25, 640
s_add_u32 s19, s19, s17
v_mul_u32_u24 v12, 1280, v3
v_lshl_add_u32 v13, v4, 4, v12
s_mov_b32 s22, 2621440
s_waitcnt lgkmcnt(0)
s_mov_b32 s20, s84
s_mov_b32 s21, s85
buffer_load_dwordx4 v[96:99], v13, s[20:23], s19 offen offset:0
buffer_load_dwordx4 v[100:103], v13, s[20:23], s19 offen offset:64
buffer_load_dwordx4 v[104:107], v13, s[20:23], s19 offen offset:128
buffer_load_dwordx4 v[108:111], v13, s[20:23], s19 offen offset:192
buffer_load_dwordx4 v[112:115], v13, s[20:23], s19 offen offset:256
buffer_load_dwordx4 v[116:119], v13, s[20:23], s19 offen offset:320
buffer_load_dwordx4 v[120:123], v13, s[20:23], s19 offen offset:384
buffer_load_dwordx4 v[124:127], v13, s[20:23], s19 offen offset:448
buffer_load_dwordx4 v[128:131], v13, s[20:23], s19 offen offset:512
buffer_load_dwordx4 v[132:135], v13, s[20:23], s19 offen offset:576
s_branch L_i_b
L_i_w2:
s_sub_u32 s16, s38, 416
s_mul_i32 s24, s16, 52429
s_lshr_b32 s24, s24, 18
s_mul_i32 s17, s24, 5
s_sub_u32 s25, s16, s17
s_mov_b32 s22, 819200
s_mov_b32 s16, 1280
s_waitcnt lgkmcnt(0)
s_mov_b32 s20, s88
s_mov_b32 s21, s89
s_mul_i32 s28, s24, 52
s_lshr_b32 s28, s28, 8
s_mul_i32 s17, s28, 5
s_sub_u32 s26, s24, s17
s_mul_i32 s17, s28, 160
s_mul_i32 s19, s26, 40
s_cmp_eq_u32 s26, 4
s_cselect_b32 s19, 32, s19
s_cselect_b32 s27, 46080, 0
s_max_u32 s27, s27, 5120
s_add_u32 s17, s17, s19
s_mul_i32 s17, s17, 1280
s_lshl_b32 s19, s25, 8
s_add_u32 s17, s17, s19
v_mul_u32_u24 v12, 1280, v4
v_lshl_add_u32 v12, v3, 4, v12
s_add_u32 m0, s18, 0
s_nop 0
buffer_load_dwordx4 v12, s[20:23], s17 offen nt lds
s_add_u32 s17, s17, 5120
s_add_u32 m0, s18, 1024
s_nop 0
buffer_load_dwordx4 v12, s[20:23], s17 offen nt lds
s_add_u32 s17, s17, s27
s_add_u32 m0, s18, 2048
s_nop 0
buffer_load_dwordx4 v12, s[20:23], s17 offen nt lds
s_add_u32 s17, s17, 5120
s_add_u32 m0, s18, 3072
s_nop 0
buffer_load_dwordx4 v12, s[20:23], s17 offen nt lds
s_add_u32 s17, s17, s27
s_add_u32 m0, s18, 4096
s_nop 0
buffer_load_dwordx4 v12, s[20:23], s17 offen nt lds
s_add_u32 s17, s17, 5120
s_add_u32 m0, s18, 5120
s_nop 0
buffer_load_dwordx4 v12, s[20:23], s17 offen nt lds
s_add_u32 s17, s17, s27
s_add_u32 m0, s18, 6144
s_nop 0
buffer_load_dwordx4 v12, s[20:23], s17 offen nt lds
s_add_u32 s17, s17, 5120
s_add_u32 m0, s18, 7168
s_nop 0
buffer_load_dwordx4 v12, s[20:23], s17 offen nt lds
s_add_u32 s17, s17, s27
L_i_b:
s_mov_b32 s28, s18
s_and_b32 s16, s2, 7
s_lshr_b32 s17, s2, 3
s_lshr_b32 s11, s16, 1
s_lshl_b32 s11, s11, 2
s_and_b32 s18, s17, 3
s_add_u32 s11, s11, s18
s_lshr_b32 s17, s17, 2
s_and_b32 s16, s16, 1
s_lshl_b32 s12, s16, 3
s_add_u32 s12, s12, s17
s_lshl_b32 s13, s11, 1
s_and_b32 s18, s12, 1
s_add_u32 s13, s13, s18
s_lshr_b32 s14, s12, 1
s_and_b32 s18, s11, 0
s_mul_i32 s9, s18, 3
s_mul_i32 s8, s18, 5
s_lshr_b32 s8, s8, 1
s_mov_b32 s15, 0
s_mov_b32 s40, 0
s_lshl_b32 s17, s11, 11
s_add_u32 s17, s17, 9646080
v_lshl_add_u32 v5, v3, 7, s17
v_mov_b32 v255, 0x40000000
v_cmp_gt_u32 vcc, 16, v1
s_lshl_b32 s18, s12, 7
s_add_u32 s17, s17, s18
v_cndmask_b32 v5, v255, v5, vcc
v_mov_b32 v6, s17
s_add_u32 s100, s4, s17
s_addc_u32 s101, s5, 0
v_cmp_eq_u32 vcc, 0, v1
s_nop 1
v_cndmask_b32 v6, v255, v6, vcc
s_mov_b32 s18, s28
s_cmp_eq_u32 s10, 3
s_cbranch_scc0 L_i_c
s_cmp_eq_u32 s12, 0
s_cbranch_scc0 L_i_c
v_mov_b32 v16, 0
v_mov_b32 v17, 0
v_mov_b32 v18, 0
v_mov_b32 v19, 0
s_lshl_b32 s17, s11, 11
s_add_u32 s17, s17, 9711616
buffer_store_dwordx4 v[16:19], v2, s[4:7], s17 offen sc1
buffer_store_dwordx4 v[16:19], v2, s[4:7], s17 offen offset:1024 sc1
L_i_c:
s_barrier
s_cmp_eq_u32 s10, 3
s_cbranch_scc0 L_i_b1
s_cmp_eq_u32 s12, 0
s_cbranch_scc0 L_i_b0
s_mov_b64 exec, 1
v_mov_b32 v16, 1
s_waitcnt vmcnt(0)
global_atomic_add v2, v16, s[94:95]
s_mov_b64 exec, -1
L_i_b0:
s_getpc_b64 s[32:33]
L_pc:
s_lshr_b32 s17, s2, 3
s_lshl_b32 s17, s17, 11
v_add_u32 v12, s17, v2
v_min_u32 v12, L_code_end-L_pc-1040, v12
v_mov_b32 v15, s33
v_add_co_u32 v14, vcc, s32, v12
s_nop 1
v_addc_co_u32 v15, vcc, 0, v15, vcc
global_load_dwordx4 a[252:255], v[14:15], off
global_load_dwordx4 a[252:255], v[14:15], off offset:1024
L_i_b1:
L_p_a:
s_nop 0
v_cmp_eq_u32 s[50:51], 0, v4
v_mov_b32 v56, 0x3f803f80
v_cmp_eq_u32 s[52:53], 1, v4
v_mov_b32 v57, 0x3f803f80
v_cmp_eq_u32 s[54:55], 2, v4
v_mov_b32 v58, 0x3f803f80
v_cmp_eq_u32 s[56:57], 3, v4
v_mov_b32 v59, 0x3f803f80
s_cmp_lt_u32 s38, 160
s_cbranch_scc1 L_p_w1
s_cmp_lt_u32 s38, 416
s_cbranch_scc1 L_p_x
s_cmp_lt_u32 s38, 516
s_cbranch_scc1 L_p_w2
s_barrier
s_branch L_drain
L_p_w1:
s_mov_b32 s29, 2
s_mov_b32 s30, 2048
v_lshrrev_b32 v12, 3, v3
v_lshl_add_u32 v12, v4, s29, v12
v_lshlrev_b32 v12, 10, v12
v_bfe_u32 v14, v3, 2, 1
v_mul_u32_u24 v14, 480, v14
s_mul_i32 s18, s10, 40
v_add3_u32 v12, v12, v14, s18
v_and_b32 v14, 3, v3
v_lshlrev_b32 v14, 2, v14
v_add_u32 v15, 0, v14
v_mul_u32_u24 v32, 205, v15
v_lshrrev_b32 v32, 13, v32
v_min_u32 v32, 2, v32
v_mul_u32_u24 v32, 80, v32
v_lshl_add_u32 v32, v15, 1, v32
v_add_u32 v16, v12, v32
v_add_u32 v24, s30, v16
v_add_u32 v15, 16, v14
v_mul_u32_u24 v32, 205, v15
v_lshrrev_b32 v32, 13, v32
v_min_u32_e64 v32, 2, v32
v_mul_u32_u24 v32, 80, v32
v_lshl_add_u32 v32, v15, 1, v32
v_add_u32 v17, v12, v32
v_add_u32 v25, s30, v17
v_add_u32 v15, 32, v14
v_mul_u32_u24 v32, 205, v15
v_lshrrev_b32 v32, 13, v32
v_min_u32_e64 v32, 2, v32
v_mul_u32_u24 v32, 80, v32
v_lshl_add_u32 v32, v15, 1, v32
v_add_u32 v18, v12, v32
v_add_u32 v26, s30, v18
v_add_u32 v15, 48, v14
v_mul_u32_u24 v32, 205, v15
v_lshrrev_b32 v32, 13, v32
v_min_u32_e64 v32, 2, v32
v_mul_u32_u24 v32, 80, v32
v_lshl_add_u32 v32, v15, 1, v32
v_add_u32 v19, v12, v32
v_add_u32 v27, s30, v19
v_add_u32 v15, 64, v14
v_mul_u32_u24 v32, 205, v15
v_lshrrev_b32 v32, 13, v32
v_min_u32_e64 v32, 2, v32
v_mul_u32_u24 v32, 80, v32
v_lshl_add_u32 v32, v15, 1, v32
v_add_u32 v20, v12, v32
v_add_u32 v28, s30, v20
v_add_u32 v15, 80, v14
v_mul_u32_u24 v32, 205, v15
v_lshrrev_b32 v32, 13, v32
v_min_u32 v32, 2, v32
v_mul_u32_u24 v32, 80, v32
v_lshl_add_u32 v32, v15, 1, v32
v_add_u32 v21, v12, v32
v_add_u32 v29, s30, v21
v_add_u32 v15, 96, v14
v_mul_u32_u24 v32, 205, v15
v_lshrrev_b32 v32, 13, v32
v_min_u32 v32, 2, v32
v_mul_u32_u24 v32, 80, v32
v_lshl_add_u32 v32, v15, 1, v32
v_add_u32 v22, v12, v32
v_add_u32 v30, s30, v22
v_add_u32 v15, 112, v14
v_mul_u32_u24 v32, 205, v15
v_lshrrev_b32 v32, 13, v32
v_min_u32 v32, 2, v32
v_mul_u32_u24 v32, 80, v32
v_lshl_add_u32 v32, v15, 1, v32
v_add_u32 v23, v12, v32
v_add_u32 v31, s30, v23
s_mul_i32 s28, s24, 52
s_lshr_b32 s28, s28, 8
s_mul_i32 s17, s28, 5
s_sub_u32 s17, s24, s17
s_lshl_b32 s17, s17, 2
s_lshr_b32 s19, 0xa1980, s17
s_and_b32 s19, s19, 15
s_cmp_ge_u32 s19, 8
s_cselect_b32 s17, 3, 2
s_mul_i32 s17, s17, s28
s_add_u32 s27, s17, s19
s_lshl_b32 s17, s25, 1
s_lshr_b32 s19, s10, 1
s_add_u32 s17, s17, s19
s_mul_i32 s17, s17, 163840
s_add_u32 s17, s17, 0
s_mul_i32 s19, s27, 6144
s_add_u32 s19, s19, s17
v_add_u32 v33, s19, v2
s_lshl_b32 s19, s27, 11
s_add_u32 s19, s19, s17
s_add_u32 s19, s19, 122880
v_add_u32 v34, s19, v2
s_lshl_b32 s17, s24, 13
s_lshl_b32 s19, s25, 10
s_add_u32 s17, s17, s19
s_lshl_b32 s19, s10, 8
s_add_u32 s17, s17, s19
s_add_u32 s17, s17, 9338880
v_lshl_add_u32 v35, v1, 2, s17
s_mov_b32 s82, 4096
s_waitcnt vmcnt(0)
s_barrier
ds_read_b64_tr_b16 v[96:97], v16
ds_read_b64_tr_b16 v[98:99], v24
ds_read_b64_tr_b16 v[100:101], v17
ds_read_b64_tr_b16 v[102:103], v25
ds_read_b64_tr_b16 v[104:105], v18
ds_read_b64_tr_b16 v[106:107], v26
ds_read_b64_tr_b16 v[108:109], v19
ds_read_b64_tr_b16 v[110:111], v27
ds_read_b64_tr_b16 v[112:113], v20
ds_read_b64_tr_b16 v[114:115], v28
ds_read_b64_tr_b16 v[116:117], v21
ds_read_b64_tr_b16 v[118:119], v29
ds_read_b64_tr_b16 v[120:121], v22
ds_read_b64_tr_b16 v[122:123], v30
ds_read_b64_tr_b16 v[124:125], v23
ds_read_b64_tr_b16 v[126:127], v31
s_waitcnt lgkmcnt(14)
buffer_store_dwordx4 v[96:99], v33, s[4:7], 0 offen offset:0 sc1
v_mfma_f32_16x16x32_bf16 v[64:67], v[56:59], v[96:99], 0
s_waitcnt lgkmcnt(12)
buffer_store_dwordx4 v[100:103], v33, s[4:7], 0 offen offset:1024 sc1
v_mfma_f32_16x16x32_bf16 v[68:71], v[56:59], v[100:103], 0
s_waitcnt lgkmcnt(10)
buffer_store_dwordx4 v[104:107], v33, s[4:7], 0 offen offset:2048 sc1
v_mfma_f32_16x16x32_bf16 v[72:75], v[56:59], v[104:107], 0
s_nop 1
v_cndmask_b32 v60, v60, v64, s[50:51]
s_waitcnt lgkmcnt(8)
buffer_store_dwordx4 v[108:111], v33, s[4:7], 0 offen offset:3072 sc1
v_mfma_f32_16x16x32_bf16 v[76:79], v[56:59], v[108:111], 0
v_cndmask_b32 v60, v60, v68, s[52:53]
s_waitcnt lgkmcnt(6)
buffer_store_dwordx4 v[112:115], v33, s[4:7], s82 offen offset:0 sc1
v_mfma_f32_16x16x32_bf16 v[64:67], v[56:59], v[112:115], 0
v_cndmask_b32 v60, v60, v72, s[54:55]
s_waitcnt lgkmcnt(4)
buffer_store_dwordx4 v[116:119], v33, s[4:7], s82 offen offset:1024 sc1
v_mfma_f32_16x16x32_bf16 v[68:71], v[56:59], v[116:119], 0
v_cndmask_b32 v60, v60, v76, s[56:57]
s_waitcnt lgkmcnt(2)
buffer_store_dwordx4 v[120:123], v34, s[4:7], 0 offen offset:0 sc1
v_mfma_f32_16x16x32_bf16 v[72:75], v[56:59], v[120:123], 0
v_cndmask_b32 v61, v61, v64, s[50:51]
s_waitcnt lgkmcnt(0)
buffer_store_dwordx4 v[124:127], v34, s[4:7], 0 offen offset:1024 sc1
v_mfma_f32_16x16x32_bf16 v[76:79], v[56:59], v[124:127], 0
v_cndmask_b32 v61, v61, v68, s[52:53]
s_nop 2
v_cndmask_b32 v61, v61, v72, s[54:55]
s_nop 2
v_cndmask_b32 v61, v61, v76, s[56:57]
buffer_store_dword v60, v35, s[4:7], 0 offen offset:0 sc1
buffer_store_dword v61, v35, s[4:7], 0 offen offset:256 sc1
s_branch L_drain
L_p_x:
s_mul_i32 s17, s24, 20480
s_mul_i32 s19, s25, 10240
s_add_u32 s17, s17, s19
s_add_u32 s17, s17, 9744384
v_add_u32 v12, s17, v2
s_mov_b32 s82, 4096
s_mov_b32 s83, 8192
v_mov_b32 v16, 0
v_mov_b32 v17, 0
v_mov_b32 v18, 0
v_mov_b32 v19, 0
s_mov_b32 s28, 0x3f803f80
s_lshl_b32 s17, s24, 10
s_lshl_b32 s19, s25, 7
s_add_u32 s17, s17, s19
s_add_u32 s17, s17, 12365824
v_lshlrev_b32 v14, 3, v3
v_lshl_add_u32 v14, v4, 8, v14
s_waitcnt vmcnt(9)
buffer_store_dwordx4 v[96:99], v12, s[4:7], 0 offen offset:0 sc1
s_waitcnt vmcnt(9)
buffer_store_dwordx4 v[100:103], v12, s[4:7], 0 offen offset:1024 sc1
s_waitcnt vmcnt(9)
buffer_store_dwordx4 v[104:107], v12, s[4:7], 0 offen offset:2048 sc1
s_waitcnt vmcnt(9)
buffer_store_dwordx4 v[108:111], v12, s[4:7], 0 offen offset:3072 sc1
s_waitcnt vmcnt(9)
buffer_store_dwordx4 v[112:115], v12, s[4:7], s82 offen offset:0 sc1
s_waitcnt vmcnt(9)
buffer_store_dwordx4 v[116:119], v12, s[4:7], s82 offen offset:1024 sc1
s_waitcnt vmcnt(9)
buffer_store_dwordx4 v[120:123], v12, s[4:7], s82 offen offset:2048 sc1
s_waitcnt vmcnt(9)
buffer_store_dwordx4 v[124:127], v12, s[4:7], s82 offen offset:3072 sc1
s_waitcnt vmcnt(9)
buffer_store_dwordx4 v[128:131], v12, s[4:7], s83 offen offset:0 sc1
s_waitcnt vmcnt(9)
buffer_store_dwordx4 v[132:135], v12, s[4:7], s83 offen offset:1024 sc1
s_barrier
v_dot2c_f32_bf16 v16, s28, v96
v_dot2c_f32_bf16 v17, v96, v96
v_dot2c_f32_bf16 v18, s28, v97
v_dot2c_f32_bf16 v19, v97, v97
v_dot2c_f32_bf16 v16, s28, v98
v_dot2c_f32_bf16 v17, v98, v98
v_dot2c_f32_bf16 v18, s28, v99
v_dot2c_f32_bf16 v19, v99, v99
v_dot2c_f32_bf16 v16, s28, v100
v_dot2c_f32_bf16 v17, v100, v100
v_dot2c_f32_bf16 v18, s28, v101
v_dot2c_f32_bf16 v19, v101, v101
v_dot2c_f32_bf16 v16, s28, v102
v_dot2c_f32_bf16 v17, v102, v102
v_dot2c_f32_bf16 v18, s28, v103
v_dot2c_f32_bf16 v19, v103, v103
v_dot2c_f32_bf16 v16, s28, v104
v_dot2c_f32_bf16 v17, v104, v104
v_dot2c_f32_bf16 v18, s28, v105
v_dot2c_f32_bf16 v19, v105, v105
v_dot2c_f32_bf16 v16, s28, v106
v_dot2c_f32_bf16 v17, v106, v106
v_dot2c_f32_bf16 v18, s28, v107
v_dot2c_f32_bf16 v19, v107, v107
v_dot2c_f32_bf16 v16, s28, v108
v_dot2c_f32_bf16 v17, v108, v108
v_dot2c_f32_bf16 v18, s28, v109
v_dot2c_f32_bf16 v19, v109, v109
v_dot2c_f32_bf16 v16, s28, v110
v_dot2c_f32_bf16 v17, v110, v110
v_dot2c_f32_bf16 v18, s28, v111
v_dot2c_f32_bf16 v19, v111, v111
v_dot2c_f32_bf16 v16, s28, v112
v_dot2c_f32_bf16 v17, v112, v112
v_dot2c_f32_bf16 v18, s28, v113
v_dot2c_f32_bf16 v19, v113, v113
v_dot2c_f32_bf16 v16, s28, v114
v_dot2c_f32_bf16 v17, v114, v114
v_dot2c_f32_bf16 v18, s28, v115
v_dot2c_f32_bf16 v19, v115, v115
v_dot2c_f32_bf16 v16, s28, v116
v_dot2c_f32_bf16 v17, v116, v116
v_dot2c_f32_bf16 v18, s28, v117
v_dot2c_f32_bf16 v19, v117, v117
v_dot2c_f32_bf16 v16, s28, v118
v_dot2c_f32_bf16 v17, v118, v118
v_dot2c_f32_bf16 v18, s28, v119
v_dot2c_f32_bf16 v19, v119, v119
v_dot2c_f32_bf16 v16, s28, v120
v_dot2c_f32_bf16 v17, v120, v120
v_dot2c_f32_bf16 v18, s28, v121
v_dot2c_f32_bf16 v19, v121, v121
v_dot2c_f32_bf16 v16, s28, v122
v_dot2c_f32_bf16 v17, v122, v122
v_dot2c_f32_bf16 v18, s28, v123
v_dot2c_f32_bf16 v19, v123, v123
v_dot2c_f32_bf16 v16, s28, v124
v_dot2c_f32_bf16 v17, v124, v124
v_dot2c_f32_bf16 v18, s28, v125
v_dot2c_f32_bf16 v19, v125, v125
v_dot2c_f32_bf16 v16, s28, v126
v_dot2c_f32_bf16 v17, v126, v126
v_dot2c_f32_bf16 v18, s28, v127
v_dot2c_f32_bf16 v19, v127, v127
v_dot2c_f32_bf16 v16, s28, v128
v_dot2c_f32_bf16 v17, v128, v128
v_dot2c_f32_bf16 v18, s28, v129
v_dot2c_f32_bf16 v19, v129, v129
v_dot2c_f32_bf16 v16, s28, v130
v_dot2c_f32_bf16 v17, v130, v130
v_dot2c_f32_bf16 v18, s28, v131
v_dot2c_f32_bf16 v19, v131, v131
v_dot2c_f32_bf16 v16, s28, v132
v_dot2c_f32_bf16 v17, v132, v132
v_dot2c_f32_bf16 v18, s28, v133
v_dot2c_f32_bf16 v19, v133, v133
v_dot2c_f32_bf16 v16, s28, v134
v_dot2c_f32_bf16 v17, v134, v134
v_dot2c_f32_bf16 v18, s28, v135
v_dot2c_f32_bf16 v19, v135, v135
s_nop 2
v_pk_add_f32 v[16:17], v[16:17], v[18:19] op_sel:[0,0] op_sel_hi:[1,1]
buffer_store_dwordx2 v[16:17], v14, s[4:7], s17 offen sc1
s_branch L_drain
L_p_w2:
s_cmp_eq_u32 s26, 4
s_cselect_b32 s29, 3, 2
s_cselect_b32 s30, 1, 4
s_lshl_b32 s30, s30, 10
v_lshrrev_b32 v230, 2, v3
v_lshl_add_u32 v230, v4, s29, v230
v_lshlrev_b32 v230, 8, v230
v_and_b32 v231, 3, v3
v_lshl_add_u32 v230, v231, 3, v230
v_add_u32 v230, s18, v230
v_add_u32 v231, s30, v230
s_lshl_b32 s17, s25, 3
s_mul_i32 s19, s17, 52
s_lshr_b32 s19, s19, 8
s_mul_i32 s28, s19, 5
s_sub_u32 s17, s17, s28
s_and_b32 s27, s19, 1
s_mul_i32 s19, s19, 20
s_add_u32 s19, s19, s24
s_mul_i32 s19, s19, 5120
s_add_u32 s19, s19, 2621440
s_sub_u32 s28, s17, s27
s_cselect_b32 s28, 4, s28
s_lshl_b32 s28, s28, 10
s_add_u32 s82, s28, s19
s_add_u32 s17, s17, 1
s_cmp_eq_u32 s17, 5
s_cselect_b32 s17, 0, s17
s_cselect_b32 s28, 1, 0
s_xor_b32 s27, s27, s28
s_mul_i32 s28, s28, 102400
s_add_u32 s19, s19, s28
s_sub_u32 s28, s17, s27
s_cselect_b32 s28, 4, s28
s_lshl_b32 s28, s28, 10
s_add_u32 s83, s28, s19
s_add_u32 s17, s17, 1
s_cmp_eq_u32 s17, 5
s_cselect_b32 s17, 0, s17
s_cselect_b32 s28, 1, 0
s_xor_b32 s27, s27, s28
s_mul_i32 s28, s28, 102400
s_add_u32 s19, s19, s28
s_sub_u32 s28, s17, s27
s_cselect_b32 s28, 4, s28
s_lshl_b32 s28, s28, 10
s_add_u32 s86, s28, s19
s_add_u32 s17, s17, 1
s_cmp_eq_u32 s17, 5
s_cselect_b32 s17, 0, s17
s_cselect_b32 s28, 1, 0
s_xor_b32 s27, s27, s28
s_mul_i32 s28, s28, 102400
s_add_u32 s19, s19, s28
s_sub_u32 s28, s17, s27
s_cselect_b32 s28, 4, s28
s_lshl_b32 s28, s28, 10
s_add_u32 s87, s28, s19
s_add_u32 s17, s17, 1
s_cmp_eq_u32 s17, 5
s_cselect_b32 s17, 0, s17
s_cselect_b32 s28, 1, 0
s_xor_b32 s27, s27, s28
s_mul_i32 s28, s28, 102400
s_add_u32 s19, s19, s28
s_sub_u32 s28, s17, s27
s_cselect_b32 s28, 4, s28
s_lshl_b32 s28, s28, 10
s_add_u32 s88, s28, s19
s_add_u32 s17, s17, 1
s_cmp_eq_u32 s17, 5
s_cselect_b32 s17, 0, s17
s_cselect_b32 s28, 1, 0
s_xor_b32 s27, s27, s28
s_mul_i32 s28, s28, 102400
s_add_u32 s19, s19, s28
s_sub_u32 s28, s17, s27
s_cselect_b32 s28, 4, s28
s_lshl_b32 s28, s28, 10
s_add_u32 s89, s28, s19
s_add_u32 s17, s17, 1
s_cmp_eq_u32 s17, 5
s_cselect_b32 s17, 0, s17
s_cselect_b32 s28, 1, 0
s_xor_b32 s27, s27, s28
s_mul_i32 s28, s28, 102400
s_add_u32 s19, s19, s28
s_sub_u32 s28, s17, s27
s_cselect_b32 s28, 4, s28
s_lshl_b32 s28, s28, 10
s_add_u32 s98, s28, s19
s_add_u32 s17, s17, 1
s_cmp_eq_u32 s17, 5
s_cselect_b32 s17, 0, s17
s_cselect_b32 s28, 1, 0
s_xor_b32 s27, s27, s28
s_mul_i32 s28, s28, 102400
s_add_u32 s19, s19, s28
s_sub_u32 s28, s17, s27
s_cselect_b32 s28, 4, s28
s_lshl_b32 s28, s28, 10
s_add_u32 s99, s28, s19
s_waitcnt vmcnt(0)
s_barrier
ds_read_b64_tr_b16 v[96:97], v230 offset:0
ds_read_b64_tr_b16 v[98:99], v231 offset:0
ds_read_b64_tr_b16 v[100:101], v230 offset:32
ds_read_b64_tr_b16 v[102:103], v231 offset:32
ds_read_b64_tr_b16 v[104:105], v230 offset:64
ds_read_b64_tr_b16 v[106:107], v231 offset:64
ds_read_b64_tr_b16 v[108:109], v230 offset:96
ds_read_b64_tr_b16 v[110:111], v231 offset:96
ds_read_b64_tr_b16 v[112:113], v230 offset:128
ds_read_b64_tr_b16 v[114:115], v231 offset:128
ds_read_b64_tr_b16 v[116:117], v230 offset:160
ds_read_b64_tr_b16 v[118:119], v231 offset:160
ds_read_b64_tr_b16 v[120:121], v230 offset:192
ds_read_b64_tr_b16 v[122:123], v231 offset:192
ds_read_b64_tr_b16 v[124:125], v230 offset:224
ds_read_b64_tr_b16 v[126:127], v231 offset:224
s_waitcnt lgkmcnt(14)
buffer_store_dwordx4 v[96:99], v2, s[4:7], s82 offen sc1
s_waitcnt lgkmcnt(12)
buffer_store_dwordx4 v[100:103], v2, s[4:7], s83 offen sc1
s_waitcnt lgkmcnt(10)
buffer_store_dwordx4 v[104:107], v2, s[4:7], s86 offen sc1
s_waitcnt lgkmcnt(8)
buffer_store_dwordx4 v[108:111], v2, s[4:7], s87 offen sc1
s_waitcnt lgkmcnt(6)
buffer_store_dwordx4 v[112:115], v2, s[4:7], s88 offen sc1
s_waitcnt lgkmcnt(4)
buffer_store_dwordx4 v[116:119], v2, s[4:7], s89 offen sc1
s_waitcnt lgkmcnt(2)
buffer_store_dwordx4 v[120:123], v2, s[4:7], s98 offen sc1
s_waitcnt lgkmcnt(0)
buffer_store_dwordx4 v[124:127], v2, s[4:7], s99 offen sc1
L_drain:
v_mov_b32 v236, 0x40000000
v_mov_b32 v237, 0x40000000
v_mov_b32 v238, 0x40000000
s_mov_b32 s82, 0
s_mov_b32 s83, 0
s_mov_b32 s86, 0
s_mov_b32 s87, 0
s_mov_b32 s88, 0
s_mov_b32 s89, 0
s_mov_b32 s98, 0
s_mov_b32 s99, 0
s_mov_b32 s31, 0
s_mov_b32 s32, s4
s_mov_b32 s33, s5
s_mov_b32 s34, 0
v_mov_b32 v229, 0
v_add_u32 v230, s37, v2
v_add_u32 v231, s37, v2
s_cmp_lt_u32 s39, 480
s_cbranch_scc1 L_d_w3
s_cmp_lt_u32 s39, 720
s_cbranch_scc0 L_d_done
s_sub_u32 s16, s39, 480
s_mul_i32 s36, s16, 52429
s_lshr_b32 s36, s36, 18
s_mul_i32 s17, s36, 5
s_sub_u32 s58, s16, s17
s_mov_b32 s31, 3
s_mov_b32 s34, 1966080
s_mov_b32 s48, 1280
s_mov_b32 s32, s96
s_mov_b32 s33, s97
s_lshl_b32 s17, s58, 3
s_mul_i32 s19, s17, 52
s_lshr_b32 s19, s19, 8
s_mul_i32 s28, s19, 5
s_sub_u32 s17, s17, s28
s_and_b32 s27, s19, 1
s_mul_i32 s19, s19, 48
s_add_u32 s19, s19, s36
s_mul_i32 s19, s19, 5120
s_add_u32 s19, s19, 7372800
s_sub_u32 s28, s17, s27
s_cselect_b32 s28, 4, s28
s_lshl_b32 s28, s28, 10
s_add_u32 s82, s28, s19
s_add_u32 s17, s17, 1
s_cmp_eq_u32 s17, 5
s_cselect_b32 s17, 0, s17
s_cselect_b32 s28, 1, 0
s_xor_b32 s27, s27, s28
s_mul_i32 s28, s28, 245760
s_add_u32 s19, s19, s28
s_sub_u32 s28, s17, s27
s_cselect_b32 s28, 4, s28
s_lshl_b32 s28, s28, 10
s_add_u32 s83, s28, s19
s_add_u32 s17, s17, 1
s_cmp_eq_u32 s17, 5
s_cselect_b32 s17, 0, s17
s_cselect_b32 s28, 1, 0
s_xor_b32 s27, s27, s28
s_mul_i32 s28, s28, 245760
s_add_u32 s19, s19, s28
s_sub_u32 s28, s17, s27
s_cselect_b32 s28, 4, s28
s_lshl_b32 s28, s28, 10
s_add_u32 s86, s28, s19
s_add_u32 s17, s17, 1
s_cmp_eq_u32 s17, 5
s_cselect_b32 s17, 0, s17
s_cselect_b32 s28, 1, 0
s_xor_b32 s27, s27, s28
s_mul_i32 s28, s28, 245760
s_add_u32 s19, s19, s28
s_sub_u32 s28, s17, s27
s_cselect_b32 s28, 4, s28
s_lshl_b32 s28, s28, 10
s_add_u32 s87, s28, s19
s_add_u32 s17, s17, 1
s_cmp_eq_u32 s17, 5
s_cselect_b32 s17, 0, s17
s_cselect_b32 s28, 1, 0
s_xor_b32 s27, s27, s28
s_mul_i32 s28, s28, 245760
s_add_u32 s19, s19, s28
s_sub_u32 s28, s17, s27
s_cselect_b32 s28, 4, s28
s_lshl_b32 s28, s28, 10
s_add_u32 s88, s28, s19
s_add_u32 s17, s17, 1
s_cmp_eq_u32 s17, 5
s_cselect_b32 s17, 0, s17
s_cselect_b32 s28, 1, 0
s_xor_b32 s27, s27, s28
s_mul_i32 s28, s28, 245760
s_add_u32 s19, s19, s28
s_sub_u32 s28, s17, s27
s_cselect_b32 s28, 4, s28
s_lshl_b32 s28, s28, 10
s_add_u32 s89, s28, s19
s_add_u32 s17, s17, 1
s_cmp_eq_u32 s17, 5
s_cselect_b32 s17, 0, s17
s_cselect_b32 s28, 1, 0
s_xor_b32 s27, s27, s28
s_mul_i32 s28, s28, 245760
s_add_u32 s19, s19, s28
s_sub_u32 s28, s17, s27
s_cselect_b32 s28, 4, s28
s_lshl_b32 s28, s28, 10
s_add_u32 s98, s28, s19
s_add_u32 s17, s17, 1
s_cmp_eq_u32 s17, 5
s_cselect_b32 s17, 0, s17
s_cselect_b32 s28, 1, 0
s_xor_b32 s27, s27, s28
s_mul_i32 s28, s28, 245760
s_add_u32 s19, s19, s28
s_sub_u32 s28, s17, s27
s_cselect_b32 s28, 4, s28
s_lshl_b32 s28, s28, 10
s_add_u32 s99, s28, s19
s_mov_b32 s29, 2
s_mov_b32 s30, 4096
s_branch L_d_rd
L_d_w3:
s_mul_i32 s36, s39, 43691
s_lshr_b32 s36, s36, 20
s_mul_i32 s17, s36, 24
s_sub_u32 s58, s39, s17
s_and_b32 s31, s58, 1
s_lshr_b32 s58, s58, 1
s_mov_b32 s34, 1966080
s_mov_b32 s48, 3072
s_cmp_eq_u32 s31, 1
s_cselect_b32 s32, s92, s90
s_cselect_b32 s33, s93, s91
s_add_u32 s31, s31, 1
s_mul_i32 s28, s36, 52
s_lshr_b32 s28, s28, 8
s_mul_i32 s17, s28, 5
s_sub_u32 s17, s36, s17
s_lshl_b32 s17, s17, 2
s_lshr_b32 s19, 0xa1980, s17
s_and_b32 s19, s19, 15
s_cmp_ge_u32 s19, 8
s_cselect_b32 s17, 3, 2
s_mul_i32 s17, s17, s28
s_add_u32 s27, s17, s19
s_lshl_b32 s17, s58, 4
s_add_u32 s17, s17, s31
s_sub_u32 s17, s17, 1
s_lshl_b32 s28, s17, 6
s_add_u32 s28, s28, 9502720
v_lshl_add_u32 v236, v3, 2, s28
v_lshl_add_u32 v236, v4, 7, v236
v_add_u32 v237, 512, v236
s_mul_i32 s19, s17, 43691
s_lshr_b32 s19, s19, 19
s_mul_i32 s28, s19, 12
s_sub_u32 s17, s17, s28
s_mul_i32 s19, s19, 20
s_add_u32 s19, s19, s27
s_mul_i32 s19, s19, 12
s_add_u32 s19, s19, s17
s_lshl_b32 s19, s19, 10
s_add_u32 s19, s19, 3440640
s_mov_b32 s82, s19
s_add_u32 s17, s17, 2
s_cmp_ge_u32 s17, 12
s_cselect_b32 s28, 12, 0
s_sub_u32 s17, s17, s28
s_mul_i32 s28, s28, 19456
s_add_u32 s19, s19, s28
s_add_u32 s19, s19, 2048
s_mov_b32 s83, s19
s_add_u32 s17, s17, 2
s_cmp_ge_u32 s17, 12
s_cselect_b32 s28, 12, 0
s_sub_u32 s17, s17, s28
s_mul_i32 s28, s28, 19456
s_add_u32 s19, s19, s28
s_add_u32 s19, s19, 2048
s_mov_b32 s86, s19
s_add_u32 s17, s17, 2
s_cmp_ge_u32 s17, 12
s_cselect_b32 s28, 12, 0
s_sub_u32 s17, s17, s28
s_mul_i32 s28, s28, 19456
s_add_u32 s19, s19, s28
s_add_u32 s19, s19, 2048
s_mov_b32 s87, s19
s_add_u32 s17, s17, 2
s_cmp_ge_u32 s17, 12
s_cselect_b32 s28, 12, 0
s_sub_u32 s17, s17, s28
s_mul_i32 s28, s28, 19456
s_add_u32 s19, s19, s28
s_add_u32 s19, s19, 2048
s_mov_b32 s88, s19
s_add_u32 s17, s17, 2
s_cmp_ge_u32 s17, 12
s_cselect_b32 s28, 12, 0
s_sub_u32 s17, s17, s28
s_mul_i32 s28, s28, 19456
s_add_u32 s19, s19, s28
s_add_u32 s19, s19, 2048
s_mov_b32 s89, s19
s_add_u32 s17, s17, 2
s_cmp_ge_u32 s17, 12
s_cselect_b32 s28, 12, 0
s_sub_u32 s17, s17, s28
s_mul_i32 s28, s28, 19456
s_add_u32 s19, s19, s28
s_add_u32 s19, s19, 2048
s_mov_b32 s98, s19
s_add_u32 s17, s17, 2
s_cmp_ge_u32 s17, 12
s_cselect_b32 s28, 12, 0
s_sub_u32 s17, s17, s28
s_mul_i32 s28, s28, 19456
s_add_u32 s19, s19, s28
s_add_u32 s19, s19, 2048
s_mov_b32 s99, s19
s_mov_b32 s29, 3
s_mov_b32 s30, 1024
L_d_rd:
v_lshrrev_b32 v230, 2, v3
v_lshl_add_u32 v230, v4, s29, v230
v_lshlrev_b32 v230, 8, v230
v_and_b32 v231, 3, v3
v_lshl_add_u32 v230, v231, 3, v230
v_add_u32 v230, s37, v230
v_add_u32 v231, s30, v230
s_cmp_eq_u32 s10, 3
s_cbranch_scc0 L_d_done
v_mov_b32 v229, 0
global_load_dword v233, v229, s[94:95] offset:0 sc1
v_mul_lo_u32 v232, v4, s48
v_lshl_add_u32 v232, v3, 4, v232
s_mul_i32 s17, s36, s48
s_lshl_b32 s17, s17, 5
s_lshl_b32 s19, s58, 8
s_add_u32 s17, s17, s19
s_lshl_b32 s19, s48, 2
s_add_u32 m0, s37, 0
s_nop 0
buffer_load_dwordx4 v232, s[32:35], s17 offen nt lds
s_add_u32 s17, s17, s19
s_add_u32 m0, s37, 1024
s_nop 0
buffer_load_dwordx4 v232, s[32:35], s17 offen nt lds
s_add_u32 s17, s17, s19
s_add_u32 m0, s37, 2048
s_nop 0
buffer_load_dwordx4 v232, s[32:35], s17 offen nt lds
s_add_u32 s17, s17, s19
s_add_u32 m0, s37, 3072
s_nop 0
buffer_load_dwordx4 v232, s[32:35], s17 offen nt lds
s_add_u32 s17, s17, s19
s_add_u32 m0, s37, 4096
s_nop 0
buffer_load_dwordx4 v232, s[32:35], s17 offen nt lds
s_add_u32 s17, s17, s19
s_add_u32 m0, s37, 5120
s_nop 0
buffer_load_dwordx4 v232, s[32:35], s17 offen nt lds
s_add_u32 s17, s17, s19
s_add_u32 m0, s37, 6144
s_nop 0
buffer_load_dwordx4 v232, s[32:35], s17 offen nt lds
s_add_u32 s17, s17, s19
s_add_u32 m0, s37, 7168
s_nop 0
buffer_load_dwordx4 v232, s[32:35], s17 offen nt lds
s_add_u32 s17, s17, s19
L_d_done:
s_lshl_b32 s17, s12, 7
s_add_u32 s17, s17, 9711616
v_lshl_add_u32 v34, v0, 11, s17
v_and_b32 v232, 0x40000000, v5
v_or_b32 v34, v232, v34
s_cmp_eq_u32 s10, 3
s_cbranch_scc0 L_clr_ok
s_mov_b32 s42, 200000
s_waitcnt vmcnt(8)
L_clr:
v_readfirstlane_b32 s43, v233
s_cmp_ge_u32 s43, 16
s_cbranch_scc1 L_drained
s_sleep 12
global_load_dword v233, v229, s[94:95] offset:0 sc1
s_sub_u32 s42, s42, 1
s_waitcnt vmcnt(0)
s_cbranch_scc0 L_clr
L_clr_ok:
s_waitcnt vmcnt(0)
L_drained:
s_barrier
s_cmp_lg_u32 s10, 0
s_cbranch_scc1 L_p_b
v_mov_b32 v232, 1
buffer_atomic_add v232, v34, s[4:7], 0 offen
L_p_b:
s_cmp_eq_u32 s31, 0
s_cbranch_scc1 L_p_nb
s_cmp_eq_u32 s10, 3
s_cbranch_scc1 L_p_nb
v_mul_lo_u32 v232, v4, s48
v_lshl_add_u32 v232, v3, 4, v232
s_mul_i32 s17, s36, s48
s_lshl_b32 s17, s17, 5
s_lshl_b32 s19, s58, 8
s_add_u32 s17, s17, s19
s_lshl_b32 s19, s48, 2
s_add_u32 m0, s37, 0
s_nop 0
buffer_load_dwordx4 v232, s[32:35], s17 offen nt lds
s_add_u32 s17, s17, s19
s_add_u32 m0, s37, 1024
s_nop 0
buffer_load_dwordx4 v232, s[32:35], s17 offen nt lds
s_add_u32 s17, s17, s19
s_add_u32 m0, s37, 2048
s_nop 0
buffer_load_dwordx4 v232, s[32:35], s17 offen nt lds
s_add_u32 s17, s17, s19
s_add_u32 m0, s37, 3072
s_nop 0
buffer_load_dwordx4 v232, s[32:35], s17 offen nt lds
s_add_u32 s17, s17, s19
s_add_u32 m0, s37, 4096
s_nop 0
buffer_load_dwordx4 v232, s[32:35], s17 offen nt lds
s_add_u32 s17, s17, s19
s_add_u32 m0, s37, 5120
s_nop 0
buffer_load_dwordx4 v232, s[32:35], s17 offen nt lds
s_add_u32 s17, s17, s19
s_add_u32 m0, s37, 6144
s_nop 0
buffer_load_dwordx4 v232, s[32:35], s17 offen nt lds
s_add_u32 s17, s17, s19
s_add_u32 m0, s37, 7168
s_nop 0
buffer_load_dwordx4 v232, s[32:35], s17 offen nt lds
s_add_u32 s17, s17, s19
L_p_nb:
s_mul_i32 s17, s12, 163840
s_lshl_b32 s44, s10, 12
s_add_u32 s17, s17, s44
s_add_u32 s17, s17, 0
v_add_u32 v8, s17, v2
s_mov_b32 s45, 0
s_lshl_b32 s16, s11, 3
s_lshl_b32 s17, s10, 1
s_add_u32 s16, s16, s17
s_mul_i32 s19, s16, 20480
s_add_u32 s19, s19, s15
s_add_u32 s17, s19, 9744384
v_add_u32_e64 v12, s17, v2
v_add_u32 v13, 20480, v12
v_add_u32 v14, 0x10000, v2
v_lshlrev_b32 v196, 3, v3
v_lshl_add_u32 v196, v4, 8, v196
s_lshl_b32 s17, s16, 10
s_add_u32 s17, s17, s15
s_add_u32 s17, s17, 12365824
v_add_u32 v16, s17, v196
v_cmp_lt_u32 s[26:27], v3, 8
v_add_u32 v15, 0x20000, v2
s_lshr_b32 s17, s12, 2
s_mul_i32 s17, s17, 5120
s_add_u32 s19, s19, s17
s_add_u32 s19, s19, 12554240
s_and_b32 s17, s12, 3
s_lshl_b32 s18, s17, 10
s_add_u32 s18, s18, s19
v_add_u32 v19, s18, v2
s_lshl_b32 s17, s17, 8
s_add_u32 s17, s17, s19
s_add_u32 s17, s17, 4096
v_add_u32 v20, s17, v2
v_mov_b32 v198, 0x40000000
v_cmp_gt_u32 vcc, 16, v1
s_nop 1
v_cndmask_b32 v20, v198, v20, vcc
s_lshl_b32 s17, s12, 7
s_add_u32 s17, s17, 9711616
v_lshl_add_u32 v34, v0, 11, s17
v_cmp_gt_u32 vcc, 16, v0
s_nop 1
v_cndmask_b32 v34, v198, v34, vcc
v_add_u32 v201, 15360, v2
s_mul_i32 s19, s10, 3584
s_add_u32 s19, s19, 0
s_add_u32 s17, s19, 3200
v_lshl_add_u32 v196, v4, 2, 0
v_add_u32 v197, -8, v3
v_cmp_le_u32 vcc, 20, v196
s_nop 1
v_cndmask_b32 v198, 0, 20, vcc
v_sub_u32 v199, v197, v198
v_sub_u32 v198, v196, v198
v_cmp_gt_u32 vcc, 20, v199
v_mad_i32_i24 v198, v197, 20, v198
v_lshl_add_u32 v198, v198, 2, s19
v_cndmask_b32 v24, v201, v198, vcc
v_cmp_eq_u32 vcc, 0, v3
v_lshl_add_u32 v198, v196, 2, s17
s_nop 0
v_cndmask_b32 v24, v24, v198, vcc
v_lshl_add_u32 v196, v4, 2, 0
v_add_u32 v197, 8, v3
v_cmp_le_u32 vcc, 20, v196
s_nop 1
v_cndmask_b32 v198, 0, 20, vcc
v_sub_u32 v199, v197, v198
v_sub_u32 v198, v196, v198
v_cmp_gt_u32 vcc, 20, v199
v_mad_i32_i24 v198, v197, 20, v198
v_lshl_add_u32 v198, v198, 2, s19
v_cndmask_b32 v25, v201, v198, vcc
v_lshl_add_u32 v196, v4, 2, 16
v_add_u32 v197, -8, v3
v_cmp_le_u32 vcc, 20, v196
s_nop 1
v_cndmask_b32 v198, 0, 20, vcc
v_sub_u32 v199, v197, v198
v_sub_u32_e64 v198, v196, v198
v_cmp_gt_u32 vcc, 20, v199
v_mad_i32_i24 v198, v197, 20, v198
v_lshl_add_u32 v198, v198, 2, s19
v_cndmask_b32 v26, v201, v198, vcc
v_cmp_eq_u32 vcc, 0, v3
v_lshl_add_u32 v198, v196, 2, s17
s_nop 0
v_cndmask_b32 v26, v26, v198, vcc
v_lshl_add_u32 v196, v4, 2, 16
v_add_u32 v197, 8, v3
v_cmp_le_u32 vcc, 20, v196
s_nop 1
v_cndmask_b32 v198, 0, 20, vcc
v_sub_u32 v199, v197, v198
v_sub_u32 v198, v196, v198
v_cmp_gt_u32 vcc, 20, v199
v_mad_i32_i24 v198, v197, 20, v198
v_lshl_add_u32 v198, v198, 2, s19
v_cndmask_b32 v27, v201, v198, vcc
v_lshl_add_u32 v196, v4, 2, 16
v_add_u32 v197, 24, v3
v_cmp_le_u32 vcc, 20, v196
s_nop 1
v_cndmask_b32 v198, 0, 20, vcc
v_sub_u32 v199, v197, v198
v_sub_u32_e64 v198, v196, v198
v_cmp_gt_u32 vcc, 20, v199
v_mad_i32_i24 v198, v197, 20, v198
v_lshl_add_u32 v198, v198, 2, s19
v_cndmask_b32 v28, v201, v198, vcc
v_lshl_add_u32 v196, v4, 2, 32
v_add_u32 v197, -8, v3
v_cmp_le_u32 vcc, 20, v196
s_nop 1
v_cndmask_b32 v198, 0, 20, vcc
v_sub_u32 v199, v197, v198
v_sub_u32_e64 v198, v196, v198
v_cmp_gt_u32 vcc, 20, v199
v_mad_i32_i24 v198, v197, 20, v198
v_lshl_add_u32 v198, v198, 2, s19
v_cndmask_b32 v29, v201, v198, vcc
v_cmp_eq_u32 vcc, 0, v3
v_lshl_add_u32 v198, v196, 2, s17
s_nop 0
v_cndmask_b32 v29, v29, v198, vcc
v_cmp_gt_u32 vcc, 2, v4
s_nop 1
v_cndmask_b32 v29, v201, v29, vcc
v_lshl_add_u32 v196, v4, 2, 32
v_add_u32 v197, 8, v3
v_cmp_le_u32 vcc, 20, v196
s_nop 1
v_cndmask_b32 v198, 0, 20, vcc
v_sub_u32 v199, v197, v198
v_sub_u32_e64 v198, v196, v198
v_cmp_gt_u32 vcc, 20, v199
v_mad_i32_i24 v198, v197, 20, v198
v_lshl_add_u32 v198, v198, 2, s19
v_cndmask_b32 v30, v201, v198, vcc
v_cmp_gt_u32 vcc, 2, v4
s_nop 1
v_cndmask_b32 v30, v201, v30, vcc
v_lshl_add_u32 v196, v4, 2, 32
v_add_u32 v197, 24, v3
v_cmp_le_u32 vcc, 20, v196
s_nop 1
v_cndmask_b32 v198, 0, 20, vcc
v_sub_u32 v199, v197, v198
v_sub_u32 v198, v196, v198
v_cmp_gt_u32 vcc, 20, v199
v_mad_i32_i24 v198, v197, 20, v198
v_lshl_add_u32 v198, v198, 2, s19
v_cndmask_b32 v31, v201, v198, vcc
v_cmp_gt_u32 vcc, 2, v4
s_nop 1
v_cndmask_b32 v31, v201, v31, vcc
v_lshlrev_b32 v33, 2, v0
s_mul_i32 s17, s12, 3360
s_add_u32 s17, s17, s15
s_add_u32 s17, s17, 12496896
v_add_u32 v32, s17, v33
v_add_u32 v33, 0, v33
s_lshl_b32 s17, s2, 9
s_add_u32 s17, s17, 9515008
v_lshl_add_u32 v17, v3, 2, s17
v_lshl_add_u32 v18, v4, 4, s17
s_mov_b32 s23, 20480
s_mov_b32 s20, 0
v_lshlrev_b32 v196, 4, v4
v_add_u32 v197, 0, v196
v_add_u32 v198, 4, v196
v_add_u32 v199, 8, v196
v_add_u32 v200, 12, v196
s_mul_i32 s3, s12, 3360
s_add_u32 s3, s3, s15
s_add_u32 s3, s3, 12496896
v_mov_b32 v207, 0x40000000
s_lshl_b32 s17, s10, 1
s_add_u32 s17, s17, 1
s_lshr_b32 s19, s17, 1
s_lshl_b32 s19, s19, 4
v_add_u32 v204, s19, v3
v_cmp_le_u32 vcc, 20, v204
s_nop 1
v_cndmask_b32 v205, 0, 20, vcc
v_mul_u32_u24 v206, 20, v204
v_sub_u32 v206, v206, v205
v_cmp_gt_u32 vcc, 40, v204
s_nop 1
v_cndmask_b32 v205, 63, v205, vcc
s_cmp_eq_u32 s19, 48
s_cselect_b64 vcc, -1, 0
v_and_b32 v204, 3, v1
v_mul_u32_u24 v204, 20, v204
v_cndmask_b32 v205, v205, v204, vcc
v_mov_b32 v204, 800
v_cndmask_b32_e64 v206, v206, v204, vcc
s_cmp_eq_u32 s10, 0
s_cselect_b32 s19, 0, 32
v_lshl_add_u32 v204, v4, 2, s19
v_cmp_gt_u32 s[38:39], 40, v204
v_add_lshl_u32 v224, v204, v206, 2
v_sub_u32 v204, v204, v205
v_cmp_gt_u32 vcc, 20, v204
s_and_b64 vcc, vcc, s[38:39]
s_nop 0
v_cndmask_b32 v224, v207, v224, vcc
v_lshl_add_u32 v204, v4, 2, s19
v_add_u32 v204, 16, v204
v_cmp_gt_u32 s[38:39], 40, v204
v_add_lshl_u32 v225, v204, v206, 2
v_sub_u32 v204, v204, v205
v_cmp_gt_u32 vcc, 20, v204
s_and_b64 vcc, vcc, s[38:39]
s_nop 0
v_cndmask_b32 v225, v207, v225, vcc
s_lshl_b32 s17, s10, 1
s_add_u32 s17, s17, 2
s_lshr_b32 s19, s17, 1
s_lshl_b32 s19, s19, 4
v_add_u32 v204, s19, v3
v_cmp_le_u32 vcc, 20, v204
s_nop 1
v_cndmask_b32 v205, 0, 20, vcc
v_mul_u32_u24 v206, 20, v204
v_sub_u32 v206, v206, v205
v_cmp_gt_u32 vcc, 40, v204
s_nop 1
v_cndmask_b32 v205, 63, v205, vcc
s_cmp_eq_u32 s19, 48
s_cselect_b64 vcc, -1, 0
v_and_b32 v204, 3, v1
v_mul_u32_u24 v204, 20, v204
v_cndmask_b32 v205, v205, v204, vcc
v_mov_b32 v204, 800
v_cndmask_b32_e64 v206, v206, v204, vcc
s_cmp_eq_u32 s10, 3
s_cselect_b32 s19, 64, 0
v_lshl_add_u32 v204, v4, 2, s19
v_cmp_gt_u32 s[38:39], 40, v204
v_add_lshl_u32 v226, v204, v206, 2
v_sub_u32 v204, v204, v205
v_cmp_gt_u32 vcc, 20, v204
s_and_b64 vcc, vcc, s[38:39]
s_nop 0
v_cndmask_b32 v226, v207, v226, vcc
v_lshl_add_u32 v204, v4, 2, s19
v_add_u32 v204, 16, v204
v_cmp_gt_u32 s[38:39], 40, v204
v_add_lshl_u32 v227, v204, v206, 2
v_sub_u32 v204, v204, v205
v_cmp_gt_u32 vcc, 20, v204
s_and_b64 vcc, vcc, s[38:39]
s_nop 0
v_cndmask_b32 v227, v207, v227, vcc
s_lshl_b32 s17, s11, 11
s_add_u32 s17, s17, 9711616
v_lshl_add_u32 v153, v1, 7, s17
s_cmp_eq_u32 s10, 1
s_cselect_b32 s17, 0, 0x40000000
v_and_b32 v204, 0x40000000, v5
v_or3_b32 v153, v204, s17, v153
s_lshl_b32 s17, s10, 11
s_add_u32 s17, s17, 122880
v_add_u32 v154, s17, v2
v_add_u32 v155, 122880, v2
s_cmp_eq_u32 s31, 0
s_cbranch_scc1 L_p_x2
s_waitcnt vmcnt(0)
v_mov_b32 v238, v2
ds_read_b64_tr_b16 a[192:193], v230 offset:0
ds_read_b64_tr_b16 a[194:195], v231 offset:0
ds_read_b64_tr_b16 a[196:197], v230 offset:32
ds_read_b64_tr_b16 a[198:199], v231 offset:32
ds_read_b64_tr_b16 a[200:201], v230 offset:64
ds_read_b64_tr_b16 a[202:203], v231 offset:64
ds_read_b64_tr_b16 a[204:205], v230 offset:96
ds_read_b64_tr_b16 a[206:207], v231 offset:96
ds_read_b64_tr_b16 a[208:209], v230 offset:128
ds_read_b64_tr_b16 a[210:211], v231 offset:128
ds_read_b64_tr_b16 a[212:213], v230 offset:160
ds_read_b64_tr_b16 a[214:215], v231 offset:160
ds_read_b64_tr_b16 a[216:217], v230 offset:192
ds_read_b64_tr_b16 a[218:219], v231 offset:192
ds_read_b64_tr_b16 a[220:221], v230 offset:224
ds_read_b64_tr_b16 a[222:223], v231 offset:224
s_waitcnt lgkmcnt(14)
v_mfma_f32_16x16x32_bf16 v[64:67], v[56:59], a[192:195], 0
s_waitcnt lgkmcnt(12)
v_mfma_f32_16x16x32_bf16 v[68:71], v[56:59], a[196:199], 0
s_waitcnt lgkmcnt(10)
v_mfma_f32_16x16x32_bf16 v[72:75], v[56:59], a[200:203], 0
s_nop 3
v_cndmask_b32 v60, v60, v64, s[50:51]
s_waitcnt lgkmcnt(8)
v_mfma_f32_16x16x32_bf16 v[76:79], v[56:59], a[204:207], 0
v_cndmask_b32 v60, v60, v68, s[52:53]
s_waitcnt lgkmcnt(6)
v_mfma_f32_16x16x32_bf16 v[64:67], v[56:59], a[208:211], 0
v_cndmask_b32 v60, v60, v72, s[54:55]
s_waitcnt lgkmcnt(4)
v_mfma_f32_16x16x32_bf16 v[68:71], v[56:59], a[212:215], 0
s_nop 1
v_cndmask_b32 v60, v60, v76, s[56:57]
s_waitcnt lgkmcnt(2)
v_mfma_f32_16x16x32_bf16 v[72:75], v[56:59], a[216:219], 0
v_cndmask_b32 v61, v61, v64, s[50:51]
s_waitcnt lgkmcnt(0)
v_mfma_f32_16x16x32_bf16 v[76:79], v[56:59], a[220:223], 0
v_cndmask_b32 v61, v61, v68, s[52:53]
s_nop 3
v_cndmask_b32 v61, v61, v72, s[54:55]
s_nop 1
v_cndmask_b32 v61, v61, v76, s[56:57]
v_mov_b32 v234, v60
v_mov_b32 v239, v61
L_p_x2:
s_cmp_lg_u32 s10, 0
s_cbranch_scc1 L_go
s_lshl_b32 s17, s11, 11
s_add_u32 s17, s17, 9711616
s_mov_b64 exec, 0xffff
v_lshlrev_b32 v233, 7, v1
s_mov_b32 s42, 200000
L_gop:
v_mov_b32 v255, 0
buffer_atomic_add v255, v233, s[4:7], s17 offen sc0
s_waitcnt vmcnt(0)
v_cmp_le_u32 vcc, 16, v255
s_cmp_eq_u32 vcc_lo, 0xffff
s_cbranch_scc1 L_go0
s_sleep 2
s_sub_u32 s42, s42, 1
s_cbranch_scc0 L_gop
L_go0:
s_mov_b64 exec, -1
L_go:
s_waitcnt lgkmcnt(0)
s_mov_b32 s49, 16
s_mov_b32 s22, 0
s_load_dwordx2 s[90:91], s[0:1], 56
s_barrier
s_add_u32 m0, s44, s45
s_nop 0
buffer_load_dwordx4 v8, s[4:7], s45 offen offset:0 sc1 lds
buffer_load_dwordx4 v8, s[4:7], s45 offen offset:1024 sc1 lds
buffer_load_dwordx4 v8, s[4:7], s45 offen offset:2048 sc1 lds
buffer_load_dwordx4 v8, s[4:7], s45 offen offset:3072 sc1 lds
s_add_u32 s45, s45, 16384
s_add_u32 m0, s44, s45
s_nop 0
buffer_load_dwordx4 v8, s[4:7], s45 offen offset:0 sc1 lds
buffer_load_dwordx4 v8, s[4:7], s45 offen offset:1024 sc1 lds
buffer_load_dwordx4 v8, s[4:7], s45 offen offset:2048 sc1 lds
buffer_load_dwordx4 v8, s[4:7], s45 offen offset:3072 sc1 lds
s_add_u32 s45, s45, 16384
s_add_u32 m0, s44, s45
s_nop 0
buffer_load_dwordx4 v8, s[4:7], s45 offen offset:0 sc1 lds
buffer_load_dwordx4 v8, s[4:7], s45 offen offset:1024 sc1 lds
buffer_load_dwordx4 v8, s[4:7], s45 offen offset:2048 sc1 lds
buffer_load_dwordx4 v8, s[4:7], s45 offen offset:3072 sc1 lds
s_add_u32 s45, s45, 16384
s_lshl_b32 s17, s12, 9
s_add_u32 s17, s17, 9338880
v_lshrrev_b32 v232, 5, v1
v_lshlrev_b32 v232, 13, v232
v_and_b32 v233, 31, v1
v_lshlrev_b32 v233, 4, v233
s_cmp_eq_u32 s10, 0
s_cselect_b32 s19, 0, 0x40000000
v_add3_u32 v232, v232, v233, s19
v_or_b32 v233, s19, v233
s_lshl_b32 s48, s2, 9
s_add_u32 s48, s48, 9515008
s_mov_b32 s21, s17
s_mov_b32 s20, 0
buffer_load_dwordx4 a[0:3], v12, s[4:7], s20 offen offset:0 sc1
buffer_load_dwordx4 a[4:7], v13, s[4:7], s20 offen offset:0 sc1
buffer_load_dwordx4 a[8:11], v12, s[4:7], s20 offen offset:3072 sc1
buffer_load_dwordx4 a[12:15], v13, s[4:7], s20 offen offset:3072 sc1
s_mov_b32 s20, 4096
buffer_load_dwordx4 a[16:19], v12, s[4:7], s20 offen offset:1024 sc1
buffer_load_dwordx4 a[20:23], v13, s[4:7], s20 offen offset:1024 sc1
s_mov_b32 s20, 8192
buffer_load_dwordx4 a[24:27], v12, s[4:7], s20 offen offset:0 sc1
buffer_load_dwordx4 a[28:31], v13, s[4:7], s20 offen offset:0 sc1
buffer_load_dwordx4 a[32:35], v12, s[4:7], s20 offen offset:2048 sc1
buffer_load_dwordx4 a[36:39], v13, s[4:7], s20 offen offset:2048 sc1
s_mov_b32 s20, 12288
buffer_load_dwordx4 a[40:43], v12, s[4:7], s20 offen offset:1024 sc1
buffer_load_dwordx4 a[44:47], v13, s[4:7], s20 offen offset:1024 sc1
buffer_load_dwordx4 a[48:51], v12, s[4:7], s20 offen offset:3072 sc1
buffer_load_dwordx4 a[52:55], v13, s[4:7], s20 offen offset:3072 sc1
s_waitcnt vmcnt(12)
s_barrier
ds_read_b128 a[160:163], v2 offset:0
ds_read_b128 a[164:167], v2 offset:1024
ds_read_b128 a[168:171], v2 offset:2048
ds_read_b128 a[172:175], v2 offset:3072
ds_read_b128 a[176:179], v2 offset:4096
ds_read_b128 a[180:183], v2 offset:5120
ds_read_b128 a[184:187], v2 offset:6144
s_waitcnt lgkmcnt(5)
v_mfma_f32_16x16x32_bf16 v[84:87], a[0:3], a[160:163], 0
v_mfma_f32_16x16x32_bf16 v[116:119], a[4:7], a[160:163], 0
ds_read_b128 a[188:191], v2 offset:7168
v_mfma_f32_16x16x32_bf16 v[88:91], a[0:3], a[164:167], 0
buffer_load_dwordx4 v[156:159], v232, s[4:7], s21 offen sc1
s_add_u32 s21, s21, 16384
buffer_load_dwordx4 v[160:163], v232, s[4:7], s21 offen sc1
s_add_u32 s21, s21, 16384
v_mfma_f32_16x16x32_bf16 v[120:123], a[4:7], a[164:167], 0
ds_read_b128 a[160:163], v2 offset:8192
s_waitcnt lgkmcnt(5)
v_mfma_f32_16x16x32_bf16 v[92:95], a[0:3], a[168:171], 0
v_mfma_f32_16x16x32_bf16 v[124:127], a[4:7], a[168:171], 0
ds_read_b128 a[164:167], v2 offset:9216
v_mfma_f32_16x16x32_bf16 v[96:99], a[0:3], a[172:175], 0
buffer_load_dwordx4 v[164:167], v232, s[4:7], s21 offen sc1
s_add_u32 s21, s21, 16384
buffer_load_dwordx4 v[168:171], v232, s[4:7], s21 offen sc1
s_add_u32 s21, s21, 16384
v_mfma_f32_16x16x32_bf16 v[128:131], a[4:7], a[172:175], 0
ds_read_b128 a[168:171], v2 offset:10240
s_waitcnt lgkmcnt(5)
v_mfma_f32_16x16x32_bf16 v[100:103], a[0:3], a[176:179], 0
v_mfma_f32_16x16x32_bf16 v[132:135], a[4:7], a[176:179], 0
ds_read_b128 a[172:175], v2 offset:11264
v_mfma_f32_16x16x32_bf16 v[104:107], a[180:183], a[0:3], 0
buffer_load_dwordx4 v[172:175], v232, s[4:7], s21 offen sc1
s_add_u32 s21, s21, 16384
buffer_load_dwordx4 v[176:179], v232, s[4:7], s21 offen sc1
s_add_u32 s21, s21, 16384
v_mfma_f32_16x16x32_bf16 v[136:139], a[180:183], a[4:7], 0
s_waitcnt vmcnt(16)
ds_read_b128 a[176:179], v2 offset:12288
s_waitcnt lgkmcnt(5)
v_mfma_f32_16x16x32_bf16 v[84:87], a[8:11], a[184:187], v[84:87]
v_mfma_f32_16x16x32_bf16 v[116:119], a[12:15], a[184:187], v[116:119]
ds_read_b128 a[180:183], v2 offset:13312
v_mfma_f32_16x16x32_bf16 v[88:91], a[8:11], a[188:191], v[88:91]
buffer_load_dwordx4 v[180:183], v232, s[4:7], s21 offen sc1
s_add_u32 s21, s21, 16384
buffer_load_dwordx4 v[184:187], v232, s[4:7], s21 offen sc1
s_add_u32 s21, s21, 16384
v_mfma_f32_16x16x32_bf16 v[120:123], a[12:15], a[188:191], v[120:123]
ds_read_b128 a[184:187], v2 offset:14336
s_waitcnt lgkmcnt(5)
v_mfma_f32_16x16x32_bf16 v[92:95], a[8:11], a[160:163], v[92:95]
buffer_load_dwordx4 v[188:191], v232, s[4:7], s21 offen sc1
s_add_u32 s21, s21, 16384
buffer_load_dwordx4 v[192:195], v232, s[4:7], s21 offen sc1
s_add_u32 s21, s21, 16384
v_mfma_f32_16x16x32_bf16 v[124:127], a[12:15], a[160:163], v[124:127]
ds_read_b128 a[188:191], v2 offset:15360
v_mfma_f32_16x16x32_bf16 v[96:99], a[8:11], a[164:167], v[96:99]
v_mfma_f32_16x16x32_bf16 v[128:131], a[12:15], a[164:167], v[128:131]
ds_read_b128 a[160:163], v2 offset:16384
s_waitcnt lgkmcnt(5)
v_mfma_f32_16x16x32_bf16 v[100:103], a[8:11], a[168:171], v[100:103]
buffer_load_dwordx2 v[68:69], v16, s[4:7], 0 offen offset:0 sc1
buffer_load_dwordx2 v[70:71], v16, s[4:7], 0 offen offset:128 sc1
v_mfma_f32_16x16x32_bf16 v[132:135], a[12:15], a[168:171], v[132:135]
ds_read_b128 a[164:167], v2 offset:17408
v_mfma_f32_16x16x32_bf16 v[104:107], a[172:175], a[8:11], v[104:107]
v_mfma_f32_16x16x32_bf16 v[136:139], a[172:175], a[12:15], v[136:139]
s_waitcnt vmcnt(20)
ds_read_b128 a[168:171], v2 offset:18432
s_waitcnt lgkmcnt(5)
v_mfma_f32_16x16x32_bf16 v[84:87], a[16:19], a[176:179], v[84:87]
buffer_load_dwordx2 v[72:73], v16, s[4:7], 0 offen offset:1024 sc1
buffer_load_dwordx2 v[74:75], v16, s[4:7], 0 offen offset:1152 sc1
v_mfma_f32_16x16x32_bf16 v[116:119], a[20:23], a[176:179], v[116:119]
ds_read_b128 a[172:175], v2 offset:19456
v_mfma_f32_16x16x32_bf16 v[88:91], a[16:19], a[180:183], v[88:91]
v_mfma_f32_16x16x32_bf16 v[120:123], a[20:23], a[180:183], v[120:123]
ds_read_b128 a[176:179], v2 offset:20480
s_waitcnt lgkmcnt(5)
v_mfma_f32_16x16x32_bf16 v[92:95], a[16:19], a[184:187], v[92:95]
s_mov_b32 s20, 16384
buffer_load_dwordx4 a[56:59], v12, s[4:7], s20 offen offset:2048 sc1
v_mfma_f32_16x16x32_bf16 v[124:127], a[20:23], a[184:187], v[124:127]
ds_read_b128 a[180:183], v2 offset:21504
v_mfma_f32_16x16x32_bf16 v[96:99], a[16:19], a[188:191], v[96:99]
buffer_load_dwordx4 a[60:63], v13, s[4:7], s20 offen offset:2048 sc1
v_mfma_f32_16x16x32_bf16 v[128:131], a[20:23], a[188:191], v[128:131]
ds_read_b128 a[184:187], v2 offset:22528
s_waitcnt lgkmcnt(5)
v_mfma_f32_16x16x32_bf16 v[100:103], a[16:19], a[160:163], v[100:103]
v_mfma_f32_16x16x32_bf16 v[132:135], a[20:23], a[160:163], v[132:135]
ds_read_b128 a[188:191], v2 offset:23552
v_mfma_f32_16x16x32_bf16 v[104:107], a[164:167], a[16:19], v[104:107]
s_add_u32 m0, s44, s45
s_nop 0
buffer_load_dwordx4 v8, s[4:7], s45 offen offset:0 sc1 lds
v_mfma_f32_16x16x32_bf16 v[136:139], a[164:167], a[20:23], v[136:139]
s_waitcnt vmcnt(23)
ds_read_b128 a[160:163], v2 offset:24576
s_waitcnt lgkmcnt(5)
v_mfma_f32_16x16x32_bf16 v[84:87], a[24:27], a[168:171], v[84:87]
v_mfma_f32_16x16x32_bf16 v[116:119], a[28:31], a[168:171], v[116:119]
ds_read_b128 a[164:167], v2 offset:25600
v_mfma_f32_16x16x32_bf16 v[88:91], a[24:27], a[172:175], v[88:91]
buffer_load_dwordx4 v8, s[4:7], s45 offen offset:1024 sc1 lds
v_mfma_f32_16x16x32_bf16 v[120:123], a[28:31], a[172:175], v[120:123]
ds_read_b128 a[168:171], v2 offset:26624
s_waitcnt lgkmcnt(5)
v_mfma_f32_16x16x32_bf16 v[92:95], a[24:27], a[176:179], v[92:95]
v_mfma_f32_16x16x32_bf16 v[124:127], a[28:31], a[176:179], v[124:127]
ds_read_b128 a[172:175], v2 offset:27648
v_mfma_f32_16x16x32_bf16 v[96:99], a[24:27], a[180:183], v[96:99]
buffer_load_dwordx4 v8, s[4:7], s45 offen offset:2048 sc1 lds
v_mfma_f32_16x16x32_bf16 v[128:131], a[28:31], a[180:183], v[128:131]
ds_read_b128 a[176:179], v2 offset:28672
s_waitcnt lgkmcnt(5)
v_mfma_f32_16x16x32_bf16 v[100:103], a[24:27], a[184:187], v[100:103]
s_waitcnt vmcnt(9)
v_add_f32 v156, v156, v160
v_mfma_f32_16x16x32_bf16 v[132:135], a[28:31], a[184:187], v[132:135]
ds_read_b128 a[180:183], v2 offset:29696
v_mfma_f32_16x16x32_bf16 v[104:107], a[188:191], a[24:27], v[104:107]
buffer_load_dwordx4 v8, s[4:7], s45 offen offset:3072 sc1 lds
s_add_u32 s45, s45, 16384
v_add_f32 v157, v157, v161
v_add_f32 v158, v158, v162
v_mfma_f32_16x16x32_bf16 v[136:139], a[188:191], a[28:31], v[136:139]
ds_read_b128 a[184:187], v2 offset:30720
s_waitcnt lgkmcnt(5)
v_mfma_f32_16x16x32_bf16 v[84:87], a[32:35], a[160:163], v[84:87]
s_mov_b32 s20, 0
buffer_load_dwordx4 a[64:67], v12, s[4:7], s20 offen offset:1024 sc1
v_add_f32 v159, v159, v163
v_add_f32 v156, v156, v164
v_mfma_f32_16x16x32_bf16 v[116:119], a[36:39], a[160:163], v[116:119]
ds_read_b128 a[188:191], v2 offset:31744
v_mfma_f32_16x16x32_bf16 v[88:91], a[32:35], a[164:167], v[88:91]
v_add_f32 v157, v157, v165
v_add_f32 v158, v158, v166
v_mfma_f32_16x16x32_bf16 v[120:123], a[36:39], a[164:167], v[120:123]
ds_read_b128 a[160:163], v2 offset:32768
s_waitcnt lgkmcnt(5)
v_mfma_f32_16x16x32_bf16 v[92:95], a[32:35], a[168:171], v[92:95]
buffer_load_dwordx4 a[68:71], v13, s[4:7], s20 offen offset:1024 sc1
v_add_f32 v159, v159, v167
v_add_f32 v156, v156, v168
v_mfma_f32_16x16x32_bf16 v[124:127], a[36:39], a[168:171], v[124:127]
ds_read_b128 a[164:167], v2 offset:33792
v_mfma_f32_16x16x32_bf16 v[96:99], a[32:35], a[172:175], v[96:99]
v_add_f32 v157, v157, v169
v_add_f32 v158, v158, v170
v_mfma_f32_16x16x32_bf16 v[128:131], a[36:39], a[172:175], v[128:131]
ds_read_b128 a[168:171], v2 offset:34816
s_waitcnt lgkmcnt(5)
v_mfma_f32_16x16x32_bf16 v[100:103], a[32:35], a[176:179], v[100:103]
buffer_load_dwordx4 a[72:75], v12, s[4:7], s20 offen offset:2048 sc1
v_add_f32 v159, v159, v171
v_add_f32 v156, v156, v172
v_mfma_f32_16x16x32_bf16 v[132:135], a[36:39], a[176:179], v[132:135]
ds_read_b128 a[172:175], v2 offset:35840
v_mfma_f32_16x16x32_bf16 v[104:107], a[180:183], a[32:35], v[104:107]
v_add_f32 v157, v157, v173
v_add_f32 v158, v158, v174
v_mfma_f32_16x16x32_bf16 v[136:139], a[180:183], a[36:39], v[136:139]
ds_read_b128 a[176:179], v2 offset:36864
s_waitcnt lgkmcnt(5)
v_mfma_f32_16x16x32_bf16 v[84:87], a[40:43], a[184:187], v[84:87]
buffer_load_dwordx4 a[76:79], v13, s[4:7], s20 offen offset:2048 sc1
v_add_f32 v159, v159, v175
v_add_f32 v156, v156, v176
v_mfma_f32_16x16x32_bf16 v[116:119], a[44:47], a[184:187], v[116:119]
ds_read_b128 a[180:183], v2 offset:37888
v_mfma_f32_16x16x32_bf16 v[88:91], a[40:43], a[188:191], v[88:91]
s_add_u32 m0, s44, s45
s_nop 0
buffer_load_dwordx4 v8, s[4:7], s45 offen offset:0 sc1 lds
v_add_f32 v157, v157, v177
v_add_f32 v158, v158, v178
v_mfma_f32_16x16x32_bf16 v[120:123], a[44:47], a[188:191], v[120:123]
ds_read_b128 a[184:187], v2 offset:38912
s_waitcnt lgkmcnt(5)
v_mfma_f32_16x16x32_bf16 v[92:95], a[40:43], a[160:163], v[92:95]
v_add_f32 v159, v159, v179
v_add_f32 v156, v156, v180
v_mfma_f32_16x16x32_bf16 v[124:127], a[44:47], a[160:163], v[124:127]
ds_read_b128 a[188:191], v2 offset:39936
v_mfma_f32_16x16x32_bf16 v[96:99], a[40:43], a[164:167], v[96:99]
buffer_load_dwordx4 v8, s[4:7], s45 offen offset:1024 sc1 lds
v_add_f32 v157, v157, v181
v_add_f32 v158, v158, v182
v_mfma_f32_16x16x32_bf16 v[128:131], a[44:47], a[164:167], v[128:131]
ds_read_b128 a[160:163], v2 offset:40960
s_waitcnt lgkmcnt(5)
v_mfma_f32_16x16x32_bf16 v[100:103], a[40:43], a[168:171], v[100:103]
v_add_f32 v159, v159, v183
v_add_f32 v156, v156, v184
v_mfma_f32_16x16x32_bf16 v[132:135], a[44:47], a[168:171], v[132:135]
ds_read_b128 a[164:167], v2 offset:41984
v_mfma_f32_16x16x32_bf16 v[104:107], a[172:175], a[40:43], v[104:107]
buffer_load_dwordx4 v8, s[4:7], s45 offen offset:2048 sc1 lds
v_add_f32 v157, v157, v185
v_add_f32 v158, v158, v186
v_mfma_f32_16x16x32_bf16 v[136:139], a[172:175], a[44:47], v[136:139]
ds_read_b128 a[168:171], v2 offset:43008
s_waitcnt lgkmcnt(5)
v_mfma_f32_16x16x32_bf16 v[84:87], a[48:51], a[176:179], v[84:87]
v_add_f32 v159, v159, v187
v_add_f32 v156, v156, v188
v_mfma_f32_16x16x32_bf16 v[116:119], a[52:55], a[176:179], v[116:119]
ds_read_b128 a[172:175], v2 offset:44032
v_mfma_f32_16x16x32_bf16 v[88:91], a[48:51], a[180:183], v[88:91]
buffer_load_dwordx4 v8, s[4:7], s45 offen offset:3072 sc1 lds
s_add_u32 s45, s45, 16384
v_add_f32 v157, v157, v189
v_add_f32 v158, v158, v190
v_mfma_f32_16x16x32_bf16 v[120:123], a[52:55], a[180:183], v[120:123]
ds_read_b128 a[176:179], v2 offset:45056
s_waitcnt lgkmcnt(5)
v_mfma_f32_16x16x32_bf16 v[92:95], a[48:51], a[184:187], v[92:95]
s_mov_b32 s20, 4096
buffer_load_dwordx4 a[80:83], v12, s[4:7], s20 offen offset:0 sc1
v_add_f32 v159, v159, v191
v_add_f32 v156, v156, v192
v_mfma_f32_16x16x32_bf16 v[124:127], a[52:55], a[184:187], v[124:127]
ds_read_b128 a[180:183], v2 offset:46080
v_mfma_f32_16x16x32_bf16 v[96:99], a[48:51], a[188:191], v[96:99]
v_add_f32 v157, v157, v193
v_add_f32 v158, v158, v194
v_mfma_f32_16x16x32_bf16 v[128:131], a[52:55], a[188:191], v[128:131]
ds_read_b128 a[184:187], v2 offset:47104
s_waitcnt lgkmcnt(5)
v_mfma_f32_16x16x32_bf16 v[100:103], a[48:51], a[160:163], v[100:103]
buffer_load_dwordx4 a[84:87], v13, s[4:7], s20 offen offset:0 sc1
v_add_f32 v159, v159, v195
v_mov_b32 v160, v156
v_mfma_f32_16x16x32_bf16 v[132:135], a[52:55], a[160:163], v[132:135]
ds_read_b128 a[188:191], v2 offset:48128
v_mfma_f32_16x16x32_bf16 v[104:107], a[164:167], a[48:51], v[104:107]
v_permlane32_swap_b32 v156, v160
v_add_f32 v156, v156, v160
v_mfma_f32_16x16x32_bf16 v[136:139], a[164:167], a[52:55], v[136:139]
s_waitcnt vmcnt(14)
s_waitcnt vmcnt(10)
s_barrier
ds_read_b128 a[160:163], v2 offset:49152
s_waitcnt lgkmcnt(5)
v_mfma_f32_16x16x32_bf16 v[84:87], a[56:59], a[168:171], v[84:87]
buffer_load_dwordx4 a[88:91], v12, s[4:7], s20 offen offset:2048 sc1
v_mov_b32 v160, v157
s_nop 1
v_permlane32_swap_b32 v157, v160
v_mfma_f32_16x16x32_bf16 v[116:119], a[60:63], a[168:171], v[116:119]
ds_read_b128 a[164:167], v2 offset:50176
v_mfma_f32_16x16x32_bf16 v[88:91], a[56:59], a[172:175], v[88:91]
v_add_f32 v157, v157, v160
v_mov_b32 v160, v158
v_mfma_f32_16x16x32_bf16 v[120:123], a[60:63], a[172:175], v[120:123]
ds_read_b128 a[168:171], v2 offset:51200
s_waitcnt lgkmcnt(5)
v_mfma_f32_16x16x32_bf16 v[92:95], a[56:59], a[176:179], v[92:95]
buffer_load_dwordx4 a[92:95], v13, s[4:7], s20 offen offset:2048 sc1
v_permlane32_swap_b32 v158, v160
v_add_f32 v158, v158, v160
v_mfma_f32_16x16x32_bf16 v[124:127], a[60:63], a[176:179], v[124:127]
ds_read_b128 a[172:175], v2 offset:52224
v_mfma_f32_16x16x32_bf16 v[96:99], a[56:59], a[180:183], v[96:99]
v_mov_b32 v160, v159
s_nop 1
v_permlane32_swap_b32 v159, v160
v_mfma_f32_16x16x32_bf16 v[128:131], a[60:63], a[180:183], v[128:131]
ds_read_b128 a[176:179], v2 offset:53248
s_waitcnt lgkmcnt(5)
v_mfma_f32_16x16x32_bf16 v[100:103], a[56:59], a[184:187], v[100:103]
buffer_load_dwordx4 a[96:99], v12, s[4:7], s20 offen offset:3072 sc1
v_add_f32 v159, v159, v160
buffer_store_dwordx4 v[156:159], v233, s[4:7], s48 offen
v_mfma_f32_16x16x32_bf16 v[132:135], a[60:63], a[184:187], v[132:135]
ds_read_b128 a[180:183], v2 offset:54272
v_mfma_f32_16x16x32_bf16 v[104:107], a[188:191], a[56:59], v[104:107]
buffer_load_dwordx4 a[100:103], v13, s[4:7], s20 offen offset:3072 sc1
v_add_f32 v68, v68, v70
v_mfma_f32_16x16x32_bf16 v[136:139], a[188:191], a[60:63], v[136:139]
s_waitcnt vmcnt(13)
ds_read_b128 a[184:187], v2 offset:55296
s_waitcnt lgkmcnt(5)
v_mfma_f32_16x16x32_bf16 v[84:87], a[64:67], a[160:163], v[84:87]
v_add_f32 v69, v69, v71
v_mov_b32 v76, v68
v_mfma_f32_16x16x32_bf16 v[116:119], a[68:71], a[160:163], v[116:119]
ds_read_b128 a[188:191], v2 offset:56320
v_mfma_f32_16x16x32_bf16 v[88:91], a[64:67], a[164:167], v[88:91]
s_add_u32 m0, s44, s45
s_nop 0
buffer_load_dwordx4 v8, s[4:7], s45 offen offset:0 sc1 lds
v_permlane16_swap_b32 v68, v76
v_add_f32 v68, v68, v76
v_mfma_f32_16x16x32_bf16 v[120:123], a[68:71], a[164:167], v[120:123]
ds_read_b128 a[160:163], v2 offset:57344
s_waitcnt lgkmcnt(5)
v_mfma_f32_16x16x32_bf16 v[92:95], a[64:67], a[168:171], v[92:95]
v_mov_b32 v76, v68
s_nop 1
v_permlane32_swap_b32 v68, v76
v_mfma_f32_16x16x32_bf16 v[124:127], a[68:71], a[168:171], v[124:127]
ds_read_b128 a[164:167], v2 offset:58368
v_mfma_f32_16x16x32_bf16 v[96:99], a[64:67], a[172:175], v[96:99]
buffer_load_dwordx4 v8, s[4:7], s45 offen offset:1024 sc1 lds
v_add_f32 v68, v68, v76
v_mov_b32 v76, v69
v_mfma_f32_16x16x32_bf16 v[128:131], a[68:71], a[172:175], v[128:131]
ds_read_b128 a[168:171], v2 offset:59392
s_waitcnt lgkmcnt(5)
v_mfma_f32_16x16x32_bf16 v[100:103], a[64:67], a[176:179], v[100:103]
v_permlane16_swap_b32 v69, v76
v_add_f32 v69, v69, v76
v_mfma_f32_16x16x32_bf16 v[132:135], a[68:71], a[176:179], v[132:135]
ds_read_b128 a[172:175], v2 offset:60416
v_mfma_f32_16x16x32_bf16 v[104:107], a[180:183], a[64:67], v[104:107]
buffer_load_dwordx4 v8, s[4:7], s45 offen offset:2048 sc1 lds
v_mov_b32 v76, v69
s_nop 1
v_permlane32_swap_b32 v69, v76
v_mfma_f32_16x16x32_bf16 v[136:139], a[180:183], a[68:71], v[136:139]
s_waitcnt vmcnt(14)
ds_read_b128 a[176:179], v2 offset:61440
s_waitcnt lgkmcnt(5)
v_mfma_f32_16x16x32_bf16 v[84:87], a[72:75], a[184:187], v[84:87]
buffer_load_dwordx4 v8, s[4:7], s45 offen offset:3072 sc1 lds
s_add_u32 s45, s45, 16384
v_add_f32 v69, v69, v76
v_mul_f32 v36, 0x3acccccd, v68
v_mfma_f32_16x16x32_bf16 v[116:119], a[76:79], a[184:187], v[116:119]
ds_read_b128 a[180:183], v2 offset:62464
v_mfma_f32_16x16x32_bf16 v[88:91], a[72:75], a[188:191], v[88:91]
v_mul_f32 v69, 0x3acccccd, v69
v_fma_f32 v69, -v36, v36, v69
v_mfma_f32_16x16x32_bf16 v[120:123], a[76:79], a[188:191], v[120:123]
ds_read_b128 a[184:187], v2 offset:63488
s_waitcnt lgkmcnt(5)
v_mfma_f32_16x16x32_bf16 v[92:95], a[72:75], a[160:163], v[92:95]
s_mov_b32 s20, 8192
buffer_load_dwordx4 a[104:107], v12, s[4:7], s20 offen offset:1024 sc1
v_max_f32 v69, 0, v69
v_add_f32 v69, 0x3727c5ac, v69
v_mfma_f32_16x16x32_bf16 v[124:127], a[76:79], a[160:163], v[124:127]
ds_read_b128 a[188:191], v2 offset:64512
v_mfma_f32_16x16x32_bf16 v[96:99], a[72:75], a[164:167], v[96:99]
v_rsq_f32 v38, v69
s_nop 0
v_mul_f32 v40, 0x3fb8aa3b, v38
v_mfma_f32_16x16x32_bf16 v[128:131], a[76:79], a[164:167], v[128:131]
s_waitcnt vmcnt(6)
s_barrier
ds_read_b128 a[160:163], v14 offset:0
s_waitcnt lgkmcnt(5)
v_mfma_f32_16x16x32_bf16 v[100:103], a[72:75], a[168:171], v[100:103]
buffer_load_dwordx4 a[108:111], v13, s[4:7], s20 offen offset:1024 sc1
v_add_f32 v72, v72, v74
v_add_f32 v73, v73, v75
v_mfma_f32_16x16x32_bf16 v[132:135], a[76:79], a[168:171], v[132:135]
ds_read_b128 a[164:167], v14 offset:1024
v_mfma_f32_16x16x32_bf16 v[104:107], a[172:175], a[72:75], v[104:107]
v_mov_b32 v76, v72
s_nop 1
v_permlane16_swap_b32 v72, v76
v_mfma_f32_16x16x32_bf16 v[136:139], a[172:175], a[76:79], v[136:139]
ds_read_b128 a[168:171], v14 offset:2048
s_waitcnt lgkmcnt(5)
v_mfma_f32_16x16x32_bf16 v[84:87], a[80:83], a[176:179], v[84:87]
buffer_load_dwordx4 a[112:115], v12, s[4:7], s20 offen offset:3072 sc1
v_add_f32 v72, v72, v76
v_mov_b32 v76, v72
v_mfma_f32_16x16x32_bf16 v[116:119], a[84:87], a[176:179], v[116:119]
ds_read_b128 a[172:175], v14 offset:3072
v_mfma_f32_16x16x32_bf16 v[88:91], a[80:83], a[180:183], v[88:91]
buffer_load_dwordx4 a[116:119], v13, s[4:7], s20 offen offset:3072 sc1
v_permlane32_swap_b32 v72, v76
v_add_f32 v72, v72, v76
v_mfma_f32_16x16x32_bf16 v[120:123], a[84:87], a[180:183], v[120:123]
ds_read_b128 a[176:179], v14 offset:4096
s_waitcnt lgkmcnt(5)
v_mfma_f32_16x16x32_bf16 v[92:95], a[80:83], a[184:187], v[92:95]
v_mov_b32 v76, v73
s_nop 1
v_permlane16_swap_b32 v73, v76
v_mfma_f32_16x16x32_bf16 v[124:127], a[84:87], a[184:187], v[124:127]
ds_read_b128 a[180:183], v14 offset:5120
v_mfma_f32_16x16x32_bf16 v[96:99], a[80:83], a[188:191], v[96:99]
s_mov_b32 s20, 12288
buffer_load_dwordx4 a[120:123], v12, s[4:7], s20 offen offset:0 sc1
v_add_f32 v73, v73, v76
v_mov_b32 v76, v73
v_mfma_f32_16x16x32_bf16 v[128:131], a[84:87], a[188:191], v[128:131]
ds_read_b128 a[184:187], v14 offset:6144
s_waitcnt lgkmcnt(5)
v_mfma_f32_16x16x32_bf16 v[100:103], a[80:83], a[160:163], v[100:103]
v_permlane32_swap_b32 v73, v76
v_add_f32 v73, v73, v76
v_mfma_f32_16x16x32_bf16 v[132:135], a[84:87], a[160:163], v[132:135]
ds_read_b128 a[188:191], v14 offset:7168
v_mfma_f32_16x16x32_bf16 v[104:107], a[164:167], a[80:83], v[104:107]
buffer_load_dwordx4 a[124:127], v13, s[4:7], s20 offen offset:0 sc1
v_mul_f32 v37, 0x3acccccd, v72
v_mul_f32 v73, 0x3acccccd, v73
v_mfma_f32_16x16x32_bf16 v[136:139], a[164:167], a[84:87], v[136:139]
ds_read_b128 a[160:163], v14 offset:8192
s_waitcnt lgkmcnt(5)
v_mfma_f32_16x16x32_bf16 v[84:87], a[88:91], a[168:171], v[84:87]
v_fma_f32 v73, -v37, v37, v73
v_max_f32 v73, 0, v73
v_mfma_f32_16x16x32_bf16 v[116:119], a[92:95], a[168:171], v[116:119]
ds_read_b128 a[164:167], v14 offset:9216
v_mfma_f32_16x16x32_bf16 v[88:91], a[88:91], a[172:175], v[88:91]
s_add_u32 m0, s44, s45
s_nop 0
buffer_load_dwordx4 v8, s[4:7], s45 offen offset:0 sc1 lds
v_add_f32 v73, 0x3727c5ac, v73
v_rsq_f32 v39, v73
v_mfma_f32_16x16x32_bf16 v[120:123], a[92:95], a[172:175], v[120:123]
ds_read_b128 a[168:171], v14 offset:10240
s_waitcnt lgkmcnt(5)
v_mfma_f32_16x16x32_bf16 v[92:95], a[88:91], a[176:179], v[92:95]
v_mul_f32 v41, 0x3fb8aa3b, v39
ds_bpermute_b32 v44, v197, v36
v_mfma_f32_16x16x32_bf16 v[124:127], a[92:95], a[176:179], v[124:127]
ds_read_b128 a[172:175], v14 offset:11264
v_mfma_f32_16x16x32_bf16 v[96:99], a[88:91], a[180:183], v[96:99]
buffer_load_dwordx4 v8, s[4:7], s45 offen offset:1024 sc1 lds
ds_bpermute_b32 v52, v197, v38
ds_bpermute_b32 v45, v198, v36
v_mfma_f32_16x16x32_bf16 v[128:131], a[92:95], a[180:183], v[128:131]
ds_read_b128 a[176:179], v14 offset:12288
s_waitcnt lgkmcnt(8)
v_mfma_f32_16x16x32_bf16 v[100:103], a[88:91], a[184:187], v[100:103]
buffer_load_dwordx4 v8, s[4:7], s45 offen offset:2048 sc1 lds
ds_bpermute_b32 v53, v198, v38
ds_bpermute_b32 v46, v199, v36
v_mfma_f32_16x16x32_bf16 v[132:135], a[92:95], a[184:187], v[132:135]
ds_read_b128 a[180:183], v14 offset:13312
v_mfma_f32_16x16x32_bf16 v[104:107], a[188:191], a[88:91], v[104:107]
ds_bpermute_b32 v54, v199, v38
ds_bpermute_b32 v47, v200, v36
v_mfma_f32_16x16x32_bf16 v[136:139], a[188:191], a[92:95], v[136:139]
s_waitcnt vmcnt(13)
ds_read_b128 a[184:187], v14 offset:14336
s_waitcnt lgkmcnt(12)
v_mfma_f32_16x16x32_bf16 v[84:87], a[96:99], a[160:163], v[84:87]
buffer_load_dwordx4 v8, s[4:7], s45 offen offset:3072 sc1 lds
s_add_u32 s45, s45, 16384
ds_bpermute_b32 v55, v200, v38
ds_bpermute_b32 v48, v197, v37
v_mfma_f32_16x16x32_bf16 v[116:119], a[100:103], a[160:163], v[116:119]
ds_read_b128 a[188:191], v14 offset:15360
v_mfma_f32_16x16x32_bf16 v[88:91], a[96:99], a[164:167], v[88:91]
ds_bpermute_b32 v56, v197, v39
ds_bpermute_b32 v49, v198, v37
v_mfma_f32_16x16x32_bf16 v[120:123], a[100:103], a[164:167], v[120:123]
s_waitcnt vmcnt(10)
s_barrier
ds_read_b128 a[160:163], v14 offset:16384
s_waitcnt lgkmcnt(15)
v_mfma_f32_16x16x32_bf16 v[92:95], a[96:99], a[168:171], v[92:95]
buffer_load_dwordx4 a[128:131], v12, s[4:7], s20 offen offset:2048 sc1
ds_bpermute_b32 v57, v198, v39
ds_bpermute_b32 v50, v199, v37
v_mfma_f32_16x16x32_bf16 v[124:127], a[100:103], a[168:171], v[124:127]
ds_read_b128 a[164:167], v14 offset:17408
v_mfma_f32_16x16x32_bf16 v[96:99], a[96:99], a[172:175], v[96:99]
ds_bpermute_b32 v58, v199, v39
ds_bpermute_b32 v51, v200, v37
v_mfma_f32_16x16x32_bf16 v[128:131], a[100:103], a[172:175], v[128:131]
ds_read_b128 a[168:171], v14 offset:18432
s_waitcnt lgkmcnt(15)
v_mfma_f32_16x16x32_bf16 v[100:103], a[96:99], a[176:179], v[100:103]
buffer_load_dwordx4 a[132:135], v13, s[4:7], s20 offen offset:2048 sc1
ds_bpermute_b32 v59, v200, v39
v_mfma_f32_16x16x32_bf16 v[132:135], a[100:103], a[176:179], v[132:135]
ds_read_b128 a[172:175], v14 offset:19456
v_mfma_f32_16x16x32_bf16 v[104:107], a[180:183], a[96:99], v[104:107]
s_mov_b32 s20, 16384
buffer_load_dwordx4 a[136:139], v12, s[4:7], s20 offen offset:0 sc1
v_mfma_f32_16x16x32_bf16 v[136:139], a[180:183], a[100:103], v[136:139]
s_waitcnt vmcnt(11)
ds_read_b128 a[176:179], v14 offset:20480
s_waitcnt lgkmcnt(12)
v_mfma_f32_16x16x32_bf16 v[84:87], a[104:107], a[184:187], v[84:87]
v_mfma_f32_16x16x32_bf16 v[116:119], a[108:111], a[184:187], v[116:119]
ds_read_b128 a[180:183], v14 offset:21504
v_mfma_f32_16x16x32_bf16 v[88:91], a[104:107], a[188:191], v[88:91]
buffer_load_dwordx4 a[140:143], v13, s[4:7], s20 offen offset:0 sc1
s_waitcnt lgkmcnt(3)
v_mfma_f32_16x16x32_bf16 v[120:123], a[108:111], a[188:191], v[120:123]
ds_read_b128 a[184:187], v14 offset:22528
v_mfma_f32_16x16x32_bf16 v[92:95], a[104:107], a[160:163], v[92:95]
v_mul_f32 v60, 0x3fb8aa3b, v52
v_mul_f32 v61, 0x3fb8aa3b, v53
v_mfma_f32_16x16x32_bf16 v[124:127], a[108:111], a[160:163], v[124:127]
ds_read_b128 a[188:191], v14 offset:23552
v_mfma_f32_16x16x32_bf16 v[96:99], a[104:107], a[164:167], v[96:99]
s_add_u32 m0, s44, s45
s_nop 0
buffer_load_dwordx4 v8, s[4:7], s45 offen offset:0 sc1 lds
v_mul_f32 v62, 0x3fb8aa3b, v54
v_mul_f32 v63, 0x3fb8aa3b, v55
v_mfma_f32_16x16x32_bf16 v[128:131], a[108:111], a[164:167], v[128:131]
ds_read_b128 a[160:163], v14 offset:24576
s_waitcnt lgkmcnt(5)
v_mfma_f32_16x16x32_bf16 v[100:103], a[104:107], a[168:171], v[100:103]
v_mul_f32 v64, 0x3fb8aa3b, v56
v_mul_f32 v65, 0x3fb8aa3b, v57
v_mfma_f32_16x16x32_bf16 v[132:135], a[108:111], a[168:171], v[132:135]
ds_read_b128 a[164:167], v14 offset:25600
v_mfma_f32_16x16x32_bf16 v[104:107], a[172:175], a[104:107], v[104:107]
buffer_load_dwordx4 v8, s[4:7], s45 offen offset:1024 sc1 lds
v_mul_f32 v66, 0x3fb8aa3b, v58
v_mul_f32 v67, 0x3fb8aa3b, v59
v_mfma_f32_16x16x32_bf16 v[136:139], a[172:175], a[108:111], v[136:139]
s_waitcnt vmcnt(12)
ds_read_b128 a[168:171], v14 offset:26624
s_waitcnt lgkmcnt(5)
v_mfma_f32_16x16x32_bf16 v[84:87], a[112:115], a[176:179], v[84:87]
buffer_load_dwordx4 v8, s[4:7], s45 offen offset:2048 sc1 lds
s_mul_i32 s17, s14, 102400
s_mul_i32 s19, s10, 25600
v_mfma_f32_16x16x32_bf16 v[116:119], a[116:119], a[176:179], v[116:119]
ds_read_b128 a[172:175], v14 offset:27648
v_mfma_f32_16x16x32_bf16 v[88:91], a[112:115], a[180:183], v[88:91]
s_add_u32 s17, s17, s19
s_add_u32 s17, s17, 2621440
v_mfma_f32_16x16x32_bf16 v[120:123], a[116:119], a[180:183], v[120:123]
ds_read_b128 a[176:179], v14 offset:28672
s_waitcnt lgkmcnt(5)
v_mfma_f32_16x16x32_bf16 v[92:95], a[112:115], a[184:187], v[92:95]
buffer_load_dwordx4 v8, s[4:7], s45 offen offset:3072 sc1 lds
s_add_u32 s45, s45, 16384
v_add_u32 v10, s17, v2
v_mfma_f32_16x16x32_bf16 v[124:127], a[116:119], a[184:187], v[124:127]
ds_read_b128 a[180:183], v14 offset:29696
v_mfma_f32_16x16x32_bf16 v[96:99], a[112:115], a[188:191], v[96:99]
v_mfma_f32_16x16x32_bf16 v[128:131], a[116:119], a[188:191], v[128:131]
ds_read_b128 a[184:187], v14 offset:30720
s_waitcnt lgkmcnt(5)
v_mfma_f32_16x16x32_bf16 v[100:103], a[112:115], a[160:163], v[100:103]
buffer_load_dwordx4 a[144:147], v12, s[4:7], s20 offen offset:1024 sc1
v_mfma_f32_16x16x32_bf16 v[132:135], a[116:119], a[160:163], v[132:135]
ds_read_b128 a[188:191], v14 offset:31744
v_mfma_f32_16x16x32_bf16 v[104:107], a[164:167], a[112:115], v[104:107]
v_mfma_f32_16x16x32_bf16 v[136:139], a[164:167], a[116:119], v[136:139]
s_waitcnt vmcnt(13)
s_waitcnt vmcnt(9)
s_barrier
ds_read_b128 a[160:163], v14 offset:32768
s_waitcnt lgkmcnt(5)
v_mfma_f32_16x16x32_bf16 v[84:87], a[120:123], a[168:171], v[84:87]
buffer_load_dwordx4 a[148:151], v13, s[4:7], s20 offen offset:1024 sc1
v_mfma_f32_16x16x32_bf16 v[116:119], a[124:127], a[168:171], v[116:119]
ds_read_b128 a[164:167], v14 offset:33792
v_mfma_f32_16x16x32_bf16 v[88:91], a[120:123], a[172:175], v[88:91]
v_mfma_f32_16x16x32_bf16 v[120:123], a[124:127], a[172:175], v[120:123]
ds_read_b128 a[168:171], v14 offset:34816
s_waitcnt lgkmcnt(5)
v_mfma_f32_16x16x32_bf16 v[92:95], a[120:123], a[176:179], v[92:95]
buffer_load_dwordx4 a[152:155], v12, s[4:7], s20 offen offset:3072 sc1
v_mfma_f32_16x16x32_bf16 v[124:127], a[124:127], a[176:179], v[124:127]
ds_read_b128 a[172:175], v14 offset:35840
v_mfma_f32_16x16x32_bf16 v[96:99], a[120:123], a[180:183], v[96:99]
buffer_load_dwordx4 a[156:159], v13, s[4:7], s20 offen offset:3072 sc1
v_mfma_f32_16x16x32_bf16 v[128:131], a[124:127], a[180:183], v[128:131]
ds_read_b128 a[176:179], v14 offset:36864
s_waitcnt lgkmcnt(5)
v_mfma_f32_16x16x32_bf16 v[100:103], a[120:123], a[184:187], v[100:103]
v_mfma_f32_16x16x32_bf16 v[132:135], a[124:127], a[184:187], v[132:135]
ds_read_b128 a[180:183], v14 offset:37888
v_mfma_f32_16x16x32_bf16 v[104:107], a[188:191], a[120:123], v[104:107]
buffer_load_dword v148, v17, s[4:7], 0 offen offset:0
v_mfma_f32_16x16x32_bf16 v[136:139], a[188:191], a[124:127], v[136:139]
s_waitcnt vmcnt(11)
ds_read_b128 a[184:187], v14 offset:38912
s_waitcnt lgkmcnt(5)
v_mfma_f32_16x16x32_bf16 v[84:87], a[128:131], a[160:163], v[84:87]
v_mfma_f32_16x16x32_bf16 v[116:119], a[132:135], a[160:163], v[116:119]
ds_read_b128 a[188:191], v14 offset:39936
v_mfma_f32_16x16x32_bf16 v[88:91], a[128:131], a[164:167], v[88:91]
buffer_load_dword v149, v17, s[4:7], 0 offen offset:64
v_mfma_f32_16x16x32_bf16 v[120:123], a[132:135], a[164:167], v[120:123]
ds_read_b128 a[160:163], v14 offset:40960
s_waitcnt lgkmcnt(5)
v_mfma_f32_16x16x32_bf16 v[92:95], a[128:131], a[168:171], v[92:95]
v_mfma_f32_16x16x32_bf16 v[124:127], a[132:135], a[168:171], v[124:127]
ds_read_b128 a[164:167], v14 offset:41984
v_mfma_f32_16x16x32_bf16 v[96:99], a[128:131], a[172:175], v[96:99]
buffer_load_dword v150, v17, s[4:7], 0 offen offset:128
v_mfma_f32_16x16x32_bf16 v[128:131], a[132:135], a[172:175], v[128:131]
ds_read_b128 a[168:171], v14 offset:43008
s_waitcnt lgkmcnt(5)
v_mfma_f32_16x16x32_bf16 v[100:103], a[128:131], a[176:179], v[100:103]
buffer_load_dword v151, v17, s[4:7], 0 offen offset:192
v_mfma_f32_16x16x32_bf16 v[132:135], a[132:135], a[176:179], v[132:135]
ds_read_b128 a[172:175], v14 offset:44032
v_mfma_f32_16x16x32_bf16 v[104:107], a[180:183], a[128:131], v[104:107]
v_mfma_f32_16x16x32_bf16 v[136:139], a[180:183], a[132:135], v[136:139]
s_waitcnt vmcnt(12)
ds_read_b128 a[176:179], v14 offset:45056
s_waitcnt lgkmcnt(5)
v_mfma_f32_16x16x32_bf16 v[84:87], a[136:139], a[184:187], v[84:87]
buffer_load_dword v152, v17, s[4:7], 0 offen offset:256
v_mfma_f32_16x16x32_bf16 v[116:119], a[140:143], a[184:187], v[116:119]
ds_read_b128 a[180:183], v14 offset:46080
v_mfma_f32_16x16x32_bf16 v[88:91], a[136:139], a[188:191], v[88:91]
v_mfma_f32_16x16x32_bf16 v[120:123], a[140:143], a[188:191], v[120:123]
ds_read_b128 a[184:187], v14 offset:47104
s_waitcnt lgkmcnt(5)
v_mfma_f32_16x16x32_bf16 v[92:95], a[136:139], a[160:163], v[92:95]
buffer_load_dwordx4 v[156:159], v18, s[4:7], 0 offen offset:320
v_mfma_f32_16x16x32_bf16 v[124:127], a[140:143], a[160:163], v[124:127]
ds_read_b128 a[188:191], v14 offset:48128
v_mfma_f32_16x16x32_bf16 v[96:99], a[136:139], a[164:167], v[96:99]
v_mfma_f32_16x16x32_bf16 v[128:131], a[140:143], a[164:167], v[128:131]
s_waitcnt vmcnt(10)
s_barrier
ds_read_b128 a[160:163], v14 offset:49152
s_waitcnt lgkmcnt(5)
v_mfma_f32_16x16x32_bf16 v[100:103], a[136:139], a[168:171], v[100:103]
buffer_load_dwordx4 v[160:163], v18, s[4:7], 0 offen offset:384
v_mfma_f32_16x16x32_bf16 v[132:135], a[140:143], a[168:171], v[132:135]
ds_read_b128 a[164:167], v14 offset:50176
v_mfma_f32_16x16x32_bf16 v[104:107], a[172:175], a[136:139], v[104:107]
v_mfma_f32_16x16x32_bf16 v[136:139], a[172:175], a[140:143], v[136:139]
s_waitcnt vmcnt(9)
ds_read_b128 a[168:171], v14 offset:51200
s_waitcnt lgkmcnt(5)
v_mfma_f32_16x16x32_bf16 v[84:87], a[144:147], a[176:179], v[84:87]
buffer_load_dwordx4 v[164:167], v18, s[4:7], 0 offen offset:448
v_mfma_f32_16x16x32_bf16 v[116:119], a[148:151], a[176:179], v[116:119]
ds_read_b128 a[172:175], v14 offset:52224
v_mfma_f32_16x16x32_bf16 v[88:91], a[144:147], a[180:183], v[88:91]
v_mfma_f32_16x16x32_bf16 v[120:123], a[148:151], a[180:183], v[120:123]
ds_read_b128 a[176:179], v14 offset:53248
s_waitcnt lgkmcnt(5)
v_mfma_f32_16x16x32_bf16 v[92:95], a[144:147], a[184:187], v[92:95]
buffer_store_dwordx4 a[192:195], v238, s[4:7], s82 offen sc1
v_mfma_f32_16x16x32_bf16 v[124:127], a[148:151], a[184:187], v[124:127]
ds_read_b128 a[180:183], v14 offset:54272
v_mfma_f32_16x16x32_bf16 v[96:99], a[144:147], a[188:191], v[96:99]
buffer_store_dwordx4 a[196:199], v238, s[4:7], s83 offen sc1
v_mfma_f32_16x16x32_bf16 v[128:131], a[148:151], a[188:191], v[128:131]
ds_read_b128 a[184:187], v14 offset:55296
s_waitcnt lgkmcnt(5)
v_mfma_f32_16x16x32_bf16 v[100:103], a[144:147], a[160:163], v[100:103]
buffer_store_dwordx4 a[200:203], v238, s[4:7], s86 offen sc1
v_mfma_f32_16x16x32_bf16 v[132:135], a[148:151], a[160:163], v[132:135]
ds_read_b128 a[188:191], v14 offset:56320
v_mfma_f32_16x16x32_bf16 v[104:107], a[164:167], a[144:147], v[104:107]
buffer_store_dwordx4 a[204:207], v238, s[4:7], s87 offen sc1
v_mfma_f32_16x16x32_bf16 v[136:139], a[164:167], a[148:151], v[136:139]
s_waitcnt vmcnt(12)
ds_read_b128 a[160:163], v14 offset:57344
s_waitcnt lgkmcnt(5)
v_mfma_f32_16x16x32_bf16 v[84:87], a[152:155], a[168:171], v[84:87]
buffer_store_dwordx4 a[208:211], v238, s[4:7], s88 offen sc1
v_mfma_f32_16x16x32_bf16 v[116:119], a[156:159], a[168:171], v[116:119]
ds_read_b128 a[164:167], v14 offset:58368
v_mfma_f32_16x16x32_bf16 v[88:91], a[152:155], a[172:175], v[88:91]
buffer_store_dwordx4 a[212:215], v238, s[4:7], s89 offen sc1
v_mfma_f32_16x16x32_bf16 v[120:123], a[156:159], a[172:175], v[120:123]
ds_read_b128 a[168:171], v14 offset:59392
s_waitcnt lgkmcnt(5)
v_mfma_f32_16x16x32_bf16 v[92:95], a[152:155], a[176:179], v[92:95]
buffer_store_dwordx4 a[216:219], v238, s[4:7], s98 offen sc1
v_mfma_f32_16x16x32_bf16 v[124:127], a[156:159], a[176:179], v[124:127]
ds_read_b128 a[172:175], v14 offset:60416
v_mfma_f32_16x16x32_bf16 v[96:99], a[152:155], a[180:183], v[96:99]
buffer_store_dwordx4 a[220:223], v238, s[4:7], s99 offen sc1
v_mfma_f32_16x16x32_bf16 v[128:131], a[156:159], a[180:183], v[128:131]
ds_read_b128 a[176:179], v14 offset:61440
s_waitcnt lgkmcnt(5)
v_mfma_f32_16x16x32_bf16 v[100:103], a[152:155], a[184:187], v[100:103]
buffer_atomic_add_f32 v234, v236, s[4:7], 0 offen
v_mfma_f32_16x16x32_bf16 v[132:135], a[156:159], a[184:187], v[132:135]
ds_read_b128 a[180:183], v14 offset:62464
v_mfma_f32_16x16x32_bf16 v[104:107], a[188:191], a[152:155], v[104:107]
buffer_atomic_add_f32 v239, v237, s[4:7], 0 offen
v_mfma_f32_16x16x32_bf16 v[136:139], a[188:191], a[156:159], v[136:139]
s_waitcnt vmcnt(10)
s_mov_b32 s24, 0x358637bd
v_pk_fma_f32 v[96:97], v[44:45], v[150:151], v[96:97] op_sel:[0,1,0] op_sel_hi:[1,1,1] neg_lo:[1,0,0] neg_hi:[1,0,0]
v_pk_fma_f32 v[98:99], v[46:47], v[150:151], v[98:99] op_sel:[0,1,0] op_sel_hi:[1,1,1] neg_lo:[1,0,0] neg_hi:[1,0,0]
v_pk_mul_f32 v[96:97], v[96:97], v[52:53] op_sel:[0,0] op_sel_hi:[1,1]
v_pk_mul_f32 v[98:99], v[98:99], v[54:55] op_sel:[0,0] op_sel_hi:[1,1]
v_cvt_pk_bf16_f32 v180, v96, v97
v_cvt_pk_bf16_f32 v181, v98, v99
v_pk_fma_f32 v[128:129], v[48:49], v[150:151], v[128:129] op_sel:[0,1,0] op_sel_hi:[1,1,1] neg_lo:[1,0,0] neg_hi:[1,0,0]
v_pk_fma_f32 v[130:131], v[50:51], v[150:151], v[130:131] op_sel:[0,1,0] op_sel_hi:[1,1,1] neg_lo:[1,0,0] neg_hi:[1,0,0]
v_pk_mul_f32 v[128:129], v[128:129], v[56:57] op_sel:[0,0] op_sel_hi:[1,1]
v_pk_mul_f32 v[130:131], v[130:131], v[58:59] op_sel:[0,0] op_sel_hi:[1,1]
s_add_u32 m0, s44, s45
s_nop 0
buffer_load_dwordx4 v8, s[4:7], s45 offen offset:0 sc1 lds
v_cvt_pk_bf16_f32 v182, v128, v129
v_cvt_pk_bf16_f32 v183, v130, v131
v_pk_fma_f32 v[92:93], v[44:45], v[150:151], v[92:93] op_sel:[0,0,0] op_sel_hi:[1,0,1] neg_lo:[1,0,0] neg_hi:[1,0,0]
v_pk_fma_f32 v[94:95], v[46:47], v[150:151], v[94:95] op_sel:[0,0,0] op_sel_hi:[1,0,1] neg_lo:[1,0,0] neg_hi:[1,0,0]
v_pk_mul_f32 v[68:69], v[92:93], v[60:61] op_sel:[0,0] op_sel_hi:[1,1]
v_pk_mul_f32 v[70:71], v[94:95], v[62:63] op_sel:[0,0] op_sel_hi:[1,1]
v_pk_mul_f32 v[72:73], v[92:93], v[52:53] op_sel:[0,0] op_sel_hi:[1,1]
v_pk_mul_f32 v[74:75], v[94:95], v[54:55] op_sel:[0,0] op_sel_hi:[1,1]
v_pk_fma_f32 v[92:93], v[92:93], v[52:53], s[24:25] op_sel:[0,0,0] op_sel_hi:[1,1,0]
v_pk_fma_f32 v[94:95], v[94:95], v[54:55], s[24:25] op_sel:[0,0,0] op_sel_hi:[1,1,0]
buffer_load_dwordx4 v8, s[4:7], s45 offen offset:1024 sc1 lds
v_exp_f32 v68, v68 clamp
v_exp_f32 v69, v69 clamp
v_exp_f32 v70, v70 clamp
v_exp_f32 v71, v71 clamp
v_max_f32 v92, s24, v92
v_max_f32 v93, s24, v93
v_max_f32 v94, s24, v94
v_max_f32 v95, s24, v95
v_pk_add_f32 v[92:93], v[92:93], v[68:69] op_sel:[0,0] op_sel_hi:[1,1]
v_pk_add_f32 v[94:95], v[94:95], v[70:71] op_sel:[0,0] op_sel_hi:[1,1]
buffer_load_dwordx4 v8, s[4:7], s45 offen offset:2048 sc1 lds
v_cndmask_b32 v92, v72, v92, s[26:27]
v_cndmask_b32 v93, v73, v93, s[26:27]
v_cndmask_b32 v94, v74, v94, s[26:27]
v_cndmask_b32 v95, v75, v95, s[26:27]
v_cvt_pk_bf16_f32 v176, v92, v93
v_cvt_pk_bf16_f32 v177, v94, v95
v_pk_fma_f32 v[124:125], v[48:49], v[150:151], v[124:125] op_sel:[0,0,0] op_sel_hi:[1,0,1] neg_lo:[1,0,0] neg_hi:[1,0,0]
v_pk_fma_f32 v[126:127], v[50:51], v[150:151], v[126:127] op_sel:[0,0,0] op_sel_hi:[1,0,1] neg_lo:[1,0,0] neg_hi:[1,0,0]
v_pk_mul_f32 v[68:69], v[124:125], v[64:65] op_sel:[0,0] op_sel_hi:[1,1]
v_pk_mul_f32 v[70:71], v[126:127], v[66:67] op_sel:[0,0] op_sel_hi:[1,1]
buffer_load_dwordx4 v8, s[4:7], s45 offen offset:3072 sc1 lds
s_add_u32 s45, s45, 16384
v_pk_mul_f32 v[72:73], v[124:125], v[56:57] op_sel:[0,0] op_sel_hi:[1,1]
v_pk_mul_f32 v[74:75], v[126:127], v[58:59] op_sel:[0,0] op_sel_hi:[1,1]
v_pk_fma_f32 v[124:125], v[124:125], v[56:57], s[24:25] op_sel:[0,0,0] op_sel_hi:[1,1,0]
v_pk_fma_f32 v[126:127], v[126:127], v[58:59], s[24:25] op_sel:[0,0,0] op_sel_hi:[1,1,0]
v_exp_f32 v68, v68 clamp
v_exp_f32 v69, v69 clamp
v_exp_f32 v70, v70 clamp
v_exp_f32 v71, v71 clamp
v_max_f32 v124, s24, v124
v_max_f32 v125, s24, v125
s_add_u32 m0, s44, s45
s_nop 0
buffer_load_dwordx4 v8, s[4:7], s45 offen offset:0 sc1 lds
v_max_f32 v126, s24, v126
v_max_f32 v127, s24, v127
v_pk_add_f32 v[124:125], v[124:125], v[68:69] op_sel:[0,0] op_sel_hi:[1,1]
v_pk_add_f32 v[126:127], v[126:127], v[70:71] op_sel:[0,0] op_sel_hi:[1,1]
v_cndmask_b32 v124, v72, v124, s[26:27]
v_cndmask_b32 v125, v73, v125, s[26:27]
v_cndmask_b32 v126, v74, v126, s[26:27]
v_cndmask_b32 v127, v75, v127, s[26:27]
v_cvt_pk_bf16_f32 v178, v124, v125
v_cvt_pk_bf16_f32 v179, v126, v127
buffer_load_dwordx4 v8, s[4:7], s45 offen offset:1024 sc1 lds
v_mov_b32 v68, 0x3f803f80
v_cndmask_b32 v188, v176, v68, s[26:27]
v_cndmask_b32 v189, v177, v68, s[26:27]
v_cndmask_b32 v190, v178, v68, s[26:27]
v_cndmask_b32 v191, v179, v68, s[26:27]
s_nop 1
v_mfma_f32_16x16x32_bf16 v[212:215], v[176:179], v[188:191], 0
v_mfma_f32_16x16x32_bf16 v[216:219], v[176:179], v[180:183], 0
v_pk_fma_f32 v[84:85], v[44:45], v[148:149], v[84:85] op_sel:[0,0,0] op_sel_hi:[1,0,1] neg_lo:[1,0,0] neg_hi:[1,0,0]
v_pk_fma_f32 v[86:87], v[46:47], v[148:149], v[86:87] op_sel:[0,0,0] op_sel_hi:[1,0,1] neg_lo:[1,0,0] neg_hi:[1,0,0]
v_pk_mul_f32 v[68:69], v[84:85], v[60:61] op_sel:[0,0] op_sel_hi:[1,1]
v_pk_mul_f32 v[70:71], v[86:87], v[62:63] op_sel:[0,0] op_sel_hi:[1,1]
v_pk_fma_f32 v[84:85], v[84:85], v[52:53], s[24:25] op_sel:[0,0,0] op_sel_hi:[1,1,0]
s_nop 1
ds_write_b128 v29, v[212:215]
v_pk_fma_f32 v[86:87], v[86:87], v[54:55], s[24:25] op_sel:[0,0,0] op_sel_hi:[1,1,0]
v_exp_f32 v68, v68 clamp
v_exp_f32 v69, v69 clamp
v_exp_f32 v70, v70 clamp
v_exp_f32 v71, v71 clamp
v_max_f32 v84, s24, v84
v_max_f32 v85, s24, v85
v_max_f32 v86, s24, v86
v_max_f32 v87, s24, v87
v_pk_add_f32 v[84:85], v[84:85], v[68:69] op_sel:[0,0] op_sel_hi:[1,1]
ds_write_b128 v30, v[216:219]
v_pk_add_f32 v[86:87], v[86:87], v[70:71] op_sel:[0,0] op_sel_hi:[1,1]
v_cvt_pk_bf16_f32 v168, v84, v85
v_cvt_pk_bf16_f32 v169, v86, v87
v_pk_fma_f32 v[116:117], v[48:49], v[148:149], v[116:117] op_sel:[0,0,0] op_sel_hi:[1,0,1] neg_lo:[1,0,0] neg_hi:[1,0,0]
v_pk_fma_f32 v[118:119], v[50:51], v[148:149], v[118:119] op_sel:[0,0,0] op_sel_hi:[1,0,1] neg_lo:[1,0,0] neg_hi:[1,0,0]
v_pk_mul_f32 v[68:69], v[116:117], v[64:65] op_sel:[0,0] op_sel_hi:[1,1]
v_pk_mul_f32 v[70:71], v[118:119], v[66:67] op_sel:[0,0] op_sel_hi:[1,1]
v_pk_fma_f32 v[116:117], v[116:117], v[56:57], s[24:25] op_sel:[0,0,0] op_sel_hi:[1,1,0]
v_pk_fma_f32 v[118:119], v[118:119], v[58:59], s[24:25] op_sel:[0,0,0] op_sel_hi:[1,1,0]
v_exp_f32 v68, v68 clamp
buffer_load_dwordx4 v8, s[4:7], s45 offen offset:2048 sc1 lds
v_exp_f32 v69, v69 clamp
v_exp_f32 v70, v70 clamp
v_exp_f32 v71, v71 clamp
v_max_f32 v116, s24, v116
v_max_f32 v117, s24, v117
v_max_f32 v118, s24, v118
v_max_f32 v119, s24, v119
v_pk_add_f32 v[116:117], v[116:117], v[68:69] op_sel:[0,0] op_sel_hi:[1,1]
v_pk_add_f32 v[118:119], v[118:119], v[70:71] op_sel:[0,0] op_sel_hi:[1,1]
v_cvt_pk_bf16_f32 v170, v116, v117
buffer_load_dwordx4 v8, s[4:7], s45 offen offset:3072 sc1 lds
s_add_u32 s45, s45, 16384
v_cvt_pk_bf16_f32 v171, v118, v119
s_nop 1
v_mfma_f32_16x16x32_bf16 v[192:195], v[168:171], v[188:191], 0
v_mfma_f32_16x16x32_bf16 v[196:199], v[168:171], v[180:183], 0
s_nop 0
v_pk_fma_f32 v[100:101], v[44:45], v[152:153], v[100:101] op_sel:[0,0,0] op_sel_hi:[1,0,1] neg_lo:[1,0,0] neg_hi:[1,0,0]
v_pk_fma_f32 v[102:103], v[46:47], v[152:153], v[102:103] op_sel:[0,0,0] op_sel_hi:[1,0,1] neg_lo:[1,0,0] neg_hi:[1,0,0]
v_pk_mul_f32 v[100:101], v[100:101], v[52:53] op_sel:[0,0] op_sel_hi:[1,1]
v_pk_mul_f32 v[102:103], v[102:103], v[54:55] op_sel:[0,0] op_sel_hi:[1,1]
v_cvt_pk_bf16_f32 v184, v100, v101
v_cvt_pk_bf16_f32 v185, v102, v103
v_pk_fma_f32 v[132:133], v[48:49], v[152:153], v[132:133] op_sel:[0,0,0] op_sel_hi:[1,0,1] neg_lo:[1,0,0] neg_hi:[1,0,0]
v_pk_fma_f32 v[134:135], v[50:51], v[152:153], v[134:135] op_sel:[0,0,0] op_sel_hi:[1,0,1] neg_lo:[1,0,0] neg_hi:[1,0,0]
v_pk_mul_f32 v[132:133], v[132:133], v[56:57] op_sel:[0,0] op_sel_hi:[1,1]
ds_write_b128 v24, v[192:195]
v_pk_mul_f32 v[134:135], v[134:135], v[58:59] op_sel:[0,0] op_sel_hi:[1,1]
v_cvt_pk_bf16_f32 v186, v132, v133
v_cvt_pk_bf16_f32 v187, v134, v135
s_nop 1
v_mfma_f32_16x16x32_bf16 v[220:223], v[176:179], v[184:187], 0
s_nop 0
v_pk_fma_f32 v[88:89], v[44:45], v[148:149], v[88:89] op_sel:[0,1,0] op_sel_hi:[1,1,1] neg_lo:[1,0,0] neg_hi:[1,0,0]
v_pk_fma_f32 v[90:91], v[46:47], v[148:149], v[90:91] op_sel:[0,1,0] op_sel_hi:[1,1,1] neg_lo:[1,0,0] neg_hi:[1,0,0]
v_pk_mul_f32 v[68:69], v[88:89], v[60:61] op_sel:[0,0] op_sel_hi:[1,1]
v_pk_mul_f32 v[70:71], v[90:91], v[62:63] op_sel:[0,0] op_sel_hi:[1,1]
v_pk_fma_f32 v[88:89], v[88:89], v[52:53], s[24:25] op_sel:[0,0,0] op_sel_hi:[1,1,0]
v_pk_fma_f32 v[90:91], v[90:91], v[54:55], s[24:25] op_sel:[0,0,0] op_sel_hi:[1,1,0]
v_exp_f32 v68, v68 clamp
s_nop 0
ds_write_b128 v31, v[220:223]
v_exp_f32 v69, v69 clamp
v_exp_f32 v70, v70 clamp
v_exp_f32 v71, v71 clamp
v_max_f32 v88, s24, v88
v_max_f32 v89, s24, v89
v_max_f32 v90, s24, v90
v_max_f32_e64 v91, s24, v91
v_pk_add_f32 v[88:89], v[88:89], v[68:69] op_sel:[0,0] op_sel_hi:[1,1]
v_pk_add_f32 v[90:91], v[90:91], v[70:71] op_sel:[0,0] op_sel_hi:[1,1]
v_cvt_pk_bf16_f32 v172, v88, v89
ds_write_b128 v25, v[196:199]
v_cvt_pk_bf16_f32 v173, v90, v91
v_pk_fma_f32 v[120:121], v[48:49], v[148:149], v[120:121] op_sel:[0,1,0] op_sel_hi:[1,1,1] neg_lo:[1,0,0] neg_hi:[1,0,0]
v_pk_fma_f32 v[122:123], v[50:51], v[148:149], v[122:123] op_sel:[0,1,0] op_sel_hi:[1,1,1] neg_lo:[1,0,0] neg_hi:[1,0,0]
v_pk_mul_f32 v[68:69], v[120:121], v[64:65] op_sel:[0,0] op_sel_hi:[1,1]
v_pk_mul_f32 v[70:71], v[122:123], v[66:67] op_sel:[0,0] op_sel_hi:[1,1]
v_pk_fma_f32 v[120:121], v[120:121], v[56:57], s[24:25] op_sel:[0,0,0] op_sel_hi:[1,1,0]
v_pk_fma_f32 v[122:123], v[122:123], v[58:59], s[24:25] op_sel:[0,0,0] op_sel_hi:[1,1,0]
v_exp_f32 v68, v68 clamp
v_exp_f32 v69, v69 clamp
v_exp_f32 v70, v70 clamp
v_exp_f32 v71, v71 clamp
v_max_f32 v120, s24, v120
v_max_f32 v121, s24, v121
v_max_f32 v122, s24, v122
v_max_f32 v123, s24, v123
v_pk_add_f32 v[120:121], v[120:121], v[68:69] op_sel:[0,0] op_sel_hi:[1,1]
v_pk_add_f32 v[122:123], v[122:123], v[70:71] op_sel:[0,0] op_sel_hi:[1,1]
v_cvt_pk_bf16_f32 v174, v120, v121
v_cvt_pk_bf16_f32 v175, v122, v123
s_nop 1
v_mfma_f32_16x16x32_bf16 v[200:203], v[172:175], v[188:191], 0
v_mfma_f32_16x16x32_bf16 v[204:207], v[172:175], v[180:183], 0
v_mfma_f32_16x16x32_bf16 v[208:211], v[172:175], v[184:187], 0
s_nop 5
ds_write_b128 v26, v[200:203]
ds_write_b128 v27, v[204:207]
ds_write_b128 v28, v[208:211]
v_pk_fma_f32 v[104:105], v[36:37], v[156:157], v[104:105] op_sel:[0,0,0] op_sel_hi:[0,1,1] neg_lo:[1,0,0] neg_hi:[1,0,0]
v_pk_fma_f32 v[106:107], v[36:37], v[158:159], v[106:107] op_sel:[0,0,0] op_sel_hi:[0,1,1] neg_lo:[1,0,0] neg_hi:[1,0,0]
v_pk_mul_f32 v[68:69], v[104:105], v[40:41] op_sel:[0,0] op_sel_hi:[1,0]
v_pk_mul_f32 v[70:71], v[106:107], v[40:41] op_sel:[0,0] op_sel_hi:[1,0]
v_pk_fma_f32 v[104:105], v[104:105], v[38:39], s[24:25] op_sel:[0,0,0] op_sel_hi:[1,0,0]
v_pk_fma_f32 v[106:107], v[106:107], v[38:39], s[24:25] op_sel:[0,0,0] op_sel_hi:[1,0,0]
v_exp_f32 v68, v68 clamp
v_exp_f32 v69, v69 clamp
v_exp_f32 v70, v70 clamp
v_exp_f32 v71, v71 clamp
v_max_f32 v104, s24, v104
v_max_f32 v105, s24, v105
v_max_f32 v106, s24, v106
v_max_f32 v107, s24, v107
v_pk_add_f32 v[104:105], v[104:105], v[68:69] op_sel:[0,0] op_sel_hi:[1,1]
v_pk_add_f32 v[106:107], v[106:107], v[70:71] op_sel:[0,0] op_sel_hi:[1,1]
v_cvt_pk_bf16_f32 v168, v104, v105
v_cvt_pk_bf16_f32 v169, v106, v107
s_waitcnt lgkmcnt(0)
s_barrier
ds_read_b32 v192, v33 offset:0
ds_read_b32 v193, v33 offset:3584
ds_read_b32 v194, v33 offset:7168
ds_read_b32 v195, v33 offset:10752
ds_read_b32 v196, v33 offset:1024
ds_read_b32 v197, v33 offset:4608
ds_read_b32 v198, v33 offset:8192
ds_read_b32 v199, v33 offset:11776
ds_read_b32 v200, v33 offset:2048
ds_read_b32 v201, v33 offset:5632
ds_read_b32 v202, v33 offset:9216
ds_read_b32 v203, v33 offset:12800
ds_read_b32 v204, v33 offset:3072
ds_read_b32 v205, v33 offset:6656
ds_read_b32 v206, v33 offset:10240
ds_read_b32 v207, v33 offset:13824
v_mov_b32 v209, 0x40000000
v_cmp_gt_u32 vcc, 72, v0
s_nop 1
v_cndmask_b32 v208, v209, v32, vcc
s_waitcnt lgkmcnt(12)
v_pk_add_f32 v[192:193], v[192:193], v[194:195] op_sel:[0,0] op_sel_hi:[1,1]
v_add_f32 v192, v192, v193
buffer_atomic_add_f32 v192, v32, s[4:7], 0 offen offset:0
s_waitcnt lgkmcnt(8)
v_pk_add_f32 v[196:197], v[196:197], v[198:199] op_sel:[0,0] op_sel_hi:[1,1]
v_add_f32 v196, v196, v197
buffer_atomic_add_f32 v196, v32, s[4:7], 0 offen offset:1024
s_waitcnt lgkmcnt(4)
v_pk_add_f32 v[200:201], v[200:201], v[202:203] op_sel:[0,0] op_sel_hi:[1,1]
v_add_f32 v200, v200, v201
buffer_atomic_add_f32 v200, v32, s[4:7], 0 offen offset:2048
s_waitcnt lgkmcnt(0)
v_pk_add_f32 v[204:205], v[204:205], v[206:207] op_sel:[0,0] op_sel_hi:[1,1]
v_add_f32 v204, v204, v205
buffer_atomic_add_f32 v204, v208, s[4:7], 0 offen offset:3072
v_mov_b32 v35, 1
ds_read_b128 a[184:187], v14 offset:63488
v_mfma_f32_16x16x32_bf16 v[108:111], a[160:163], a[0:3], 0
v_cmp_lt_u32 s[36:37], 0, v4
v_mov_b32 v120, s24
v_mfma_f32_16x16x32_bf16 v[140:143], a[160:163], a[4:7], 0
ds_read_b128 a[188:191], v14 offset:64512
v_mfma_f32_16x16x32_bf16 v[112:115], a[164:167], a[0:3], 0
v_mov_b32 v121, s24
v_mov_b32 v122, s24
v_mfma_f32_16x16x32_bf16 v[144:147], a[164:167], a[4:7], 0
s_waitcnt vmcnt(8)
s_barrier
ds_read_b128 a[160:163], v15 offset:0
v_mfma_f32_16x16x32_bf16 v[108:111], a[168:171], a[8:11], v[108:111]
s_mov_b32 s47, 0
buffer_load_dwordx4 a[192:195], v10, s[4:7], s47 offen offset:0 sc1
v_mfma_f32_16x16x32_bf16 v[140:143], a[168:171], a[12:15], v[140:143]
ds_read_b128 a[164:167], v15 offset:1024
v_mfma_f32_16x16x32_bf16 v[112:115], a[172:175], a[8:11], v[112:115]
v_mov_b32 v123, s24
v_mfma_f32_16x16x32_bf16 v[144:147], a[172:175], a[12:15], v[144:147]
ds_read_b128 a[168:171], v15 offset:2048
v_mfma_f32_16x16x32_bf16 v[108:111], a[176:179], a[16:19], v[108:111]
v_mfma_f32_16x16x32_bf16 v[140:143], a[176:179], a[20:23], v[140:143]
ds_read_b128 a[172:175], v15 offset:3072
v_mfma_f32_16x16x32_bf16 v[112:115], a[180:183], a[16:19], v[112:115]
buffer_load_dwordx4 a[196:199], v10, s[4:7], s47 offen offset:1024 sc1
v_mfma_f32_16x16x32_bf16 v[144:147], a[180:183], a[20:23], v[144:147]
ds_read_b128 a[176:179], v15 offset:4096
s_waitcnt lgkmcnt(5)
v_mfma_f32_16x16x32_bf16 v[108:111], a[184:187], a[24:27], v[108:111]
v_mfma_f32_16x16x32_bf16 v[140:143], a[184:187], a[28:31], v[140:143]
ds_read_b128 a[180:183], v15 offset:5120
v_mfma_f32_16x16x32_bf16 v[112:115], a[188:191], a[24:27], v[112:115]
v_mfma_f32_16x16x32_bf16 v[144:147], a[188:191], a[28:31], v[144:147]
ds_read_b128 a[184:187], v15 offset:6144
s_waitcnt lgkmcnt(5)
v_mfma_f32_16x16x32_bf16 v[108:111], a[160:163], a[32:35], v[108:111]
buffer_load_dwordx4 a[200:203], v10, s[4:7], s47 offen offset:2048 sc1
v_mfma_f32_16x16x32_bf16 v[140:143], a[160:163], a[36:39], v[140:143]
ds_read_b128 a[188:191], v15 offset:7168
v_mfma_f32_16x16x32_bf16 v[112:115], a[164:167], a[32:35], v[112:115]
v_mfma_f32_16x16x32_bf16 v[144:147], a[164:167], a[36:39], v[144:147]
ds_read_b128 a[160:163], v15 offset:8192
s_waitcnt lgkmcnt(5)
v_mfma_f32_16x16x32_bf16 v[108:111], a[168:171], a[40:43], v[108:111]
v_mfma_f32_16x16x32_bf16 v[140:143], a[168:171], a[44:47], v[140:143]
ds_read_b128 a[164:167], v15 offset:9216
v_mfma_f32_16x16x32_bf16 v[112:115], a[172:175], a[40:43], v[112:115]
buffer_load_dwordx4 a[204:207], v10, s[4:7], s47 offen offset:3072 sc1
v_mfma_f32_16x16x32_bf16 v[144:147], a[172:175], a[44:47], v[144:147]
ds_read_b128 a[168:171], v15 offset:10240
s_waitcnt lgkmcnt(5)
v_mfma_f32_16x16x32_bf16 v[108:111], a[176:179], a[48:51], v[108:111]
v_mfma_f32_16x16x32_bf16 v[140:143], a[176:179], a[52:55], v[140:143]
ds_read_b128 a[172:175], v15 offset:11264
v_mfma_f32_16x16x32_bf16 v[112:115], a[180:183], a[48:51], v[112:115]
v_mfma_f32_16x16x32_bf16 v[144:147], a[180:183], a[52:55], v[144:147]
ds_read_b128 a[176:179], v15 offset:12288
s_waitcnt lgkmcnt(5)
v_mfma_f32_16x16x32_bf16 v[108:111], a[184:187], a[56:59], v[108:111]
s_mov_b32 s47, 4096
buffer_load_dwordx4 a[208:211], v10, s[4:7], s47 offen offset:0 sc1
v_mfma_f32_16x16x32_bf16 v[140:143], a[184:187], a[60:63], v[140:143]
ds_read_b128 a[180:183], v15 offset:13312
v_mfma_f32_16x16x32_bf16 v[112:115], a[188:191], a[56:59], v[112:115]
v_mfma_f32_16x16x32_bf16 v[144:147], a[188:191], a[60:63], v[144:147]
ds_read_b128 a[184:187], v15 offset:14336
s_waitcnt lgkmcnt(5)
v_mfma_f32_16x16x32_bf16 v[108:111], a[160:163], a[64:67], v[108:111]
v_mfma_f32_16x16x32_bf16 v[140:143], a[160:163], a[68:71], v[140:143]
ds_read_b128 a[188:191], v15 offset:15360
v_mfma_f32_16x16x32_bf16 v[112:115], a[164:167], a[64:67], v[112:115]
s_mov_b32 s47, 5120
buffer_load_dwordx4 a[212:215], v10, s[4:7], s47 offen offset:0 sc1
v_mfma_f32_16x16x32_bf16 v[144:147], a[164:167], a[68:71], v[144:147]
s_waitcnt vmcnt(10)
s_barrier
ds_read_b128 a[160:163], v15 offset:16384
s_waitcnt lgkmcnt(5)
v_mfma_f32_16x16x32_bf16 v[108:111], a[168:171], a[72:75], v[108:111]
v_mfma_f32_16x16x32_bf16 v[140:143], a[168:171], a[76:79], v[140:143]
ds_read_b128 a[164:167], v15 offset:17408
v_mfma_f32_16x16x32_bf16 v[112:115], a[172:175], a[72:75], v[112:115]
v_mfma_f32_16x16x32_bf16 v[144:147], a[172:175], a[76:79], v[144:147]
ds_read_b128 a[168:171], v15 offset:18432
s_waitcnt lgkmcnt(5)
v_mfma_f32_16x16x32_bf16 v[108:111], a[176:179], a[80:83], v[108:111]
buffer_load_dwordx4 a[216:219], v10, s[4:7], s47 offen offset:1024 sc1
v_mfma_f32_16x16x32_bf16 v[140:143], a[176:179], a[84:87], v[140:143]
ds_read_b128 a[172:175], v15 offset:19456
v_mfma_f32_16x16x32_bf16 v[112:115], a[180:183], a[80:83], v[112:115]
v_mfma_f32_16x16x32_bf16 v[144:147], a[180:183], a[84:87], v[144:147]
ds_read_b128 a[176:179], v15 offset:20480
s_waitcnt lgkmcnt(5)
v_mfma_f32_16x16x32_bf16 v[108:111], a[184:187], a[88:91], v[108:111]
v_mfma_f32_16x16x32_bf16 v[140:143], a[184:187], a[92:95], v[140:143]
ds_read_b128 a[180:183], v15 offset:21504
v_mfma_f32_16x16x32_bf16 v[112:115], a[188:191], a[88:91], v[112:115]
buffer_load_dwordx4 a[220:223], v10, s[4:7], s47 offen offset:2048 sc1
v_mfma_f32_16x16x32_bf16 v[144:147], a[188:191], a[92:95], v[144:147]
s_waitcnt vmcnt(8)
s_barrier
buffer_atomic_add v35, v34, s[4:7], 0 offen
ds_read_b128 a[184:187], v15 offset:22528
s_waitcnt lgkmcnt(5)
v_mfma_f32_16x16x32_bf16 v[108:111], a[160:163], a[96:99], v[108:111]
v_mfma_f32_16x16x32_bf16 v[140:143], a[160:163], a[100:103], v[140:143]
ds_read_b128 a[188:191], v15 offset:23552
v_mfma_f32_16x16x32_bf16 v[112:115], a[164:167], a[96:99], v[112:115]
v_mfma_f32_16x16x32_bf16 v[144:147], a[164:167], a[100:103], v[144:147]
ds_read_b128 a[160:163], v15 offset:24576
s_waitcnt lgkmcnt(5)
v_mfma_f32_16x16x32_bf16 v[108:111], a[168:171], a[104:107], v[108:111]
buffer_load_dwordx4 a[224:227], v10, s[4:7], s47 offen offset:3072 sc1
v_mfma_f32_16x16x32_bf16 v[140:143], a[168:171], a[108:111], v[140:143]
ds_read_b128 a[164:167], v15 offset:25600
v_mfma_f32_16x16x32_bf16 v[112:115], a[172:175], a[104:107], v[112:115]
v_mfma_f32_16x16x32_bf16 v[144:147], a[172:175], a[108:111], v[144:147]
ds_read_b128 a[168:171], v15 offset:26624
s_waitcnt lgkmcnt(5)
v_mfma_f32_16x16x32_bf16 v[108:111], a[176:179], a[112:115], v[108:111]
v_mfma_f32_16x16x32_bf16 v[140:143], a[176:179], a[116:119], v[140:143]
ds_read_b128 a[172:175], v15 offset:27648
v_mfma_f32_16x16x32_bf16 v[112:115], a[180:183], a[112:115], v[112:115]
s_mov_b32 s47, 9216
buffer_load_dwordx4 a[228:231], v10, s[4:7], s47 offen offset:0 sc1
v_mfma_f32_16x16x32_bf16 v[144:147], a[180:183], a[116:119], v[144:147]
ds_read_b128 a[176:179], v15 offset:28672
s_waitcnt lgkmcnt(5)
v_mfma_f32_16x16x32_bf16 v[108:111], a[184:187], a[120:123], v[108:111]
v_mfma_f32_16x16x32_bf16 v[140:143], a[184:187], a[124:127], v[140:143]
ds_read_b128 a[180:183], v15 offset:29696
v_mfma_f32_16x16x32_bf16 v[112:115], a[188:191], a[120:123], v[112:115]
v_mfma_f32_16x16x32_bf16 v[144:147], a[188:191], a[124:127], v[144:147]
ds_read_b128 a[184:187], v15 offset:30720
s_waitcnt lgkmcnt(5)
v_mfma_f32_16x16x32_bf16 v[108:111], a[160:163], a[128:131], v[108:111]
s_mov_b32 s47, 10240
buffer_load_dwordx4 a[232:235], v10, s[4:7], s47 offen offset:0 sc1
v_mfma_f32_16x16x32_bf16 v[140:143], a[160:163], a[132:135], v[140:143]
ds_read_b128 a[188:191], v15 offset:31744
v_mfma_f32_16x16x32_bf16 v[112:115], a[164:167], a[128:131], v[112:115]
v_mfma_f32_16x16x32_bf16 v[144:147], a[164:167], a[132:135], v[144:147]
s_waitcnt lgkmcnt(4)
v_mfma_f32_16x16x32_bf16 v[108:111], a[168:171], a[136:139], v[108:111]
v_mfma_f32_16x16x32_bf16 v[140:143], a[168:171], a[140:143], v[140:143]
v_mfma_f32_16x16x32_bf16 v[112:115], a[172:175], a[136:139], v[112:115]
buffer_load_dwordx4 a[236:239], v10, s[4:7], s47 offen offset:1024 sc1
v_mfma_f32_16x16x32_bf16 v[144:147], a[172:175], a[140:143], v[144:147]
s_waitcnt lgkmcnt(2)
v_mfma_f32_16x16x32_bf16 v[108:111], a[176:179], a[144:147], v[108:111]
v_mfma_f32_16x16x32_bf16 v[140:143], a[176:179], a[148:151], v[140:143]
v_mfma_f32_16x16x32_bf16 v[112:115], a[180:183], a[144:147], v[112:115]
v_mfma_f32_16x16x32_bf16 v[144:147], a[180:183], a[148:151], v[144:147]
s_waitcnt lgkmcnt(0)
v_mfma_f32_16x16x32_bf16 v[108:111], a[184:187], a[152:155], v[108:111]
buffer_load_dwordx4 a[240:243], v10, s[4:7], s47 offen offset:2048 sc1
v_mfma_f32_16x16x32_bf16 v[140:143], a[184:187], a[156:159], v[140:143]
v_mfma_f32_16x16x32_bf16 v[112:115], a[188:191], a[152:155], v[112:115]
v_mfma_f32_16x16x32_bf16 v[144:147], a[188:191], a[156:159], v[144:147]
v_mov_b32 v252, 0
v_mov_b32 v253, 0
buffer_atomic_add v253, v153, s[4:7], 0 offen sc0
v_pk_fma_f32 v[136:137], v[36:37], v[156:157], v[136:137] op_sel:[1,0,0] op_sel_hi:[1,1,1] neg_lo:[1,0,0] neg_hi:[1,0,0]
v_pk_fma_f32 v[138:139], v[36:37], v[158:159], v[138:139] op_sel:[1,0,0] op_sel_hi:[1,1,1] neg_lo:[1,0,0] neg_hi:[1,0,0]
v_pk_mul_f32 v[68:69], v[136:137], v[40:41] op_sel:[0,1] op_sel_hi:[1,1]
v_pk_mul_f32 v[70:71], v[138:139], v[40:41] op_sel:[0,1] op_sel_hi:[1,1]
v_pk_fma_f32 v[136:137], v[136:137], v[38:39], s[24:25] op_sel:[0,1,0] op_sel_hi:[1,1,0]
v_pk_fma_f32 v[138:139], v[138:139], v[38:39], s[24:25] op_sel:[0,1,0] op_sel_hi:[1,1,0]
v_exp_f32 v68, v68 clamp
v_exp_f32 v69, v69 clamp
v_exp_f32 v70, v70 clamp
v_exp_f32 v71, v71 clamp
v_max_f32 v136, s24, v136
v_max_f32 v137, s24, v137
v_max_f32 v138, s24, v138
v_max_f32 v139, s24, v139
v_pk_add_f32 v[136:137], v[136:137], v[68:69] op_sel:[0,0] op_sel_hi:[1,1]
v_pk_add_f32 v[138:139], v[138:139], v[70:71] op_sel:[0,0] op_sel_hi:[1,1]
buffer_load_dwordx4 a[244:247], v10, s[4:7], s47 offen offset:3072 sc1
v_cvt_pk_bf16_f32 v172, v136, v137
v_cvt_pk_bf16_f32 v173, v138, v139
v_pk_fma_f32 v[108:109], v[36:37], v[160:161], v[108:109] op_sel:[0,0,0] op_sel_hi:[0,1,1] neg_lo:[1,0,0] neg_hi:[1,0,0]
v_pk_fma_f32 v[110:111], v[36:37], v[162:163], v[110:111] op_sel:[0,0,0] op_sel_hi:[0,1,1] neg_lo:[1,0,0] neg_hi:[1,0,0]
v_pk_mul_f32 v[68:69], v[108:109], v[40:41] op_sel:[0,0] op_sel_hi:[1,0]
v_pk_mul_f32 v[70:71], v[110:111], v[40:41] op_sel:[0,0] op_sel_hi:[1,0]
v_pk_fma_f32 v[108:109], v[108:109], v[38:39], s[24:25] op_sel:[0,0,0] op_sel_hi:[1,0,0]
v_pk_fma_f32 v[110:111], v[110:111], v[38:39], s[24:25] op_sel:[0,0,0] op_sel_hi:[1,0,0]
v_exp_f32 v68, v68 clamp
v_exp_f32 v69, v69 clamp
v_exp_f32 v70, v70 clamp
v_exp_f32 v71, v71 clamp
v_max_f32 v108, s24, v108
v_max_f32 v109, s24, v109
v_max_f32 v110, s24, v110
v_max_f32 v111, s24, v111
s_mov_b32 s47, 14336
buffer_load_dwordx4 a[248:251], v10, s[4:7], s47 offen offset:0 sc1
v_pk_add_f32 v[108:109], v[108:109], v[68:69] op_sel:[0,0] op_sel_hi:[1,1]
v_pk_add_f32 v[110:111], v[110:111], v[70:71] op_sel:[0,0] op_sel_hi:[1,1]
v_cvt_pk_bf16_f32 v170, v108, v109
v_cvt_pk_bf16_f32 v171, v110, v111
buffer_atomic_add v252, v153, s[4:7], 0 offen sc0
v_pk_fma_f32 v[140:141], v[36:37], v[160:161], v[140:141] op_sel:[1,0,0] op_sel_hi:[1,1,1] neg_lo:[1,0,0] neg_hi:[1,0,0]
v_pk_fma_f32 v[142:143], v[36:37], v[162:163], v[142:143] op_sel:[1,0,0] op_sel_hi:[1,1,1] neg_lo:[1,0,0] neg_hi:[1,0,0]
v_pk_mul_f32 v[68:69], v[140:141], v[40:41] op_sel:[0,1] op_sel_hi:[1,1]
v_pk_mul_f32 v[70:71], v[142:143], v[40:41] op_sel:[0,1] op_sel_hi:[1,1]
v_pk_fma_f32 v[140:141], v[140:141], v[38:39], s[24:25] op_sel:[0,1,0] op_sel_hi:[1,1,0]
v_pk_fma_f32 v[142:143], v[142:143], v[38:39], s[24:25] op_sel:[0,1,0] op_sel_hi:[1,1,0]
v_exp_f32 v68, v68 clamp
v_exp_f32 v69, v69 clamp
v_exp_f32 v70, v70 clamp
v_exp_f32 v71, v71 clamp
v_max_f32 v140, s24, v140
v_max_f32 v141, s24, v141
s_mov_b32 s47, 15360
buffer_load_dwordx4 a[252:255], v10, s[4:7], s47 offen offset:0 sc1
v_max_f32 v142, s24, v142
v_max_f32 v143, s24, v143
v_pk_add_f32 v[140:141], v[140:141], v[68:69] op_sel:[0,0] op_sel_hi:[1,1]
v_pk_add_f32 v[142:143], v[142:143], v[70:71] op_sel:[0,0] op_sel_hi:[1,1]
v_cvt_pk_bf16_f32 v174, v140, v141
v_cvt_pk_bf16_f32 v175, v142, v143
v_pk_fma_f32 v[112:113], v[36:37], v[164:165], v[112:113] op_sel:[0,0,0] op_sel_hi:[0,1,1] neg_lo:[1,0,0] neg_hi:[1,0,0]
v_pk_fma_f32 v[114:115], v[36:37], v[166:167], v[114:115] op_sel:[0,0,0] op_sel_hi:[0,1,1] neg_lo:[1,0,0] neg_hi:[1,0,0]
v_pk_mul_f32 v[68:69], v[112:113], v[40:41] op_sel:[0,0] op_sel_hi:[1,0]
v_pk_mul_f32 v[70:71], v[114:115], v[40:41] op_sel:[0,0] op_sel_hi:[1,0]
v_pk_fma_f32 v[112:113], v[112:113], v[38:39], s[24:25] op_sel:[0,0,0] op_sel_hi:[1,0,0]
v_pk_fma_f32 v[114:115], v[114:115], v[38:39], s[24:25] op_sel:[0,0,0] op_sel_hi:[1,0,0]
v_exp_f32 v68, v68 clamp
v_exp_f32 v69, v69 clamp
v_exp_f32 v70, v70 clamp
v_exp_f32 v71, v71 clamp
buffer_load_dwordx4 a[156:159], v10, s[4:7], s47 offen offset:1024 sc1
v_max_f32 v112, s24, v112
v_max_f32 v113, s24, v113
v_max_f32 v114, s24, v114
v_max_f32 v115, s24, v115
v_pk_add_f32 v[112:113], v[112:113], v[68:69] op_sel:[0,0] op_sel_hi:[1,1]
v_pk_add_f32 v[114:115], v[114:115], v[70:71] op_sel:[0,0] op_sel_hi:[1,1]
v_cvt_pk_bf16_f32 v176, v112, v113
v_cvt_pk_bf16_f32 v177, v114, v115
v_pk_fma_f32 v[144:145], v[36:37], v[164:165], v[144:145] op_sel:[1,0,0] op_sel_hi:[1,1,1] neg_lo:[1,0,0] neg_hi:[1,0,0]
v_pk_fma_f32 v[146:147], v[36:37], v[166:167], v[146:147] op_sel:[1,0,0] op_sel_hi:[1,1,1] neg_lo:[1,0,0] neg_hi:[1,0,0]
v_pk_mul_f32 v[68:69], v[144:145], v[40:41] op_sel:[0,1] op_sel_hi:[1,1]
v_pk_mul_f32 v[70:71], v[146:147], v[40:41] op_sel:[0,1] op_sel_hi:[1,1]
v_pk_fma_f32 v[144:145], v[144:145], v[38:39], s[24:25] op_sel:[0,1,0] op_sel_hi:[1,1,0]
v_pk_fma_f32 v[146:147], v[146:147], v[38:39], s[24:25] op_sel:[0,1,0] op_sel_hi:[1,1,0]
v_exp_f32 v68, v68 clamp
v_exp_f32 v69, v69 clamp
buffer_load_dwordx4 a[160:163], v10, s[4:7], s47 offen offset:2048 sc1
v_exp_f32 v70, v70 clamp
v_exp_f32 v71, v71 clamp
v_max_f32 v144, s24, v144
v_max_f32 v145, s24, v145
v_max_f32 v146, s24, v146
v_max_f32 v147, s24, v147
v_pk_add_f32 v[144:145], v[144:145], v[68:69] op_sel:[0,0] op_sel_hi:[1,1]
v_pk_add_f32 v[146:147], v[146:147], v[70:71] op_sel:[0,0] op_sel_hi:[1,1]
v_cvt_pk_bf16_f32 v180, v144, v145
v_cvt_pk_bf16_f32 v181, v146, v147
buffer_load_dwordx4 a[164:167], v10, s[4:7], s47 offen offset:3072 sc1
s_mov_b32 s47, 19456
buffer_load_dwordx4 a[168:171], v10, s[4:7], s47 offen offset:0 sc1
s_mov_b32 s47, 20480
buffer_load_dwordx4 a[172:175], v10, s[4:7], s47 offen offset:0 sc1
s_add_u32 s49, s49, 16
s_cmp_lg_u32 s10, 1
s_cbranch_scc1 L_gd_2
s_mov_b32 s42, 200000
s_waitcnt vmcnt(9)
v_cmp_le_u32 vcc, s49, v253
s_cmp_eq_u32 vcc_lo, 0xffff
s_cbranch_scc1 L_gd_2
s_waitcnt vmcnt(6)
L_gp_1:
v_cmp_le_u32 vcc, s49, v252
s_cmp_eq_u32 vcc_lo, 0xffff
s_cbranch_scc1 L_gd_2
v_mov_b32 v252, 0
buffer_atomic_add v252, v153, s[4:7], 0 offen sc0
s_sub_u32 s42, s42, 1
s_waitcnt vmcnt(0)
s_cbranch_scc0 L_gp_1
L_gd_2:
s_barrier
buffer_load_dwordx4 v[192:195], v224, s[4:7], s3 offen sc1
buffer_load_dwordx4 v[196:199], v225, s[4:7], s3 offen sc1
buffer_load_dwordx4 v[200:203], v226, s[4:7], s3 offen sc1
buffer_load_dwordx4 v[204:207], v227, s[4:7], s3 offen sc1
s_mul_i32 s17, s12, 245760
s_mul_i32 s44, s10, 6144
s_add_u32 s17, s17, s44
s_add_u32 s17, s17, 3440640
v_add_u32 v8, s17, v2
s_mul_i32 s45, s8, 24576
s_add_u32 s46, s45, 3072
s_mul_i32 s17, s14, 245760
s_mul_i32 s19, s10, 61440
s_add_u32 s17, s17, s19
s_add_u32 s17, s17, 7372800
v_add_u32 v11, s17, v2
v_mov_b32 v178, 0
v_mov_b32 v179, 0
v_mov_b32 v182, 0
v_mov_b32 v183, 0
buffer_load_dwordx4 a[176:179], v10, s[4:7], s47 offen offset:1024 sc1
buffer_load_dwordx4 a[180:183], v10, s[4:7], s47 offen offset:2048 sc1
buffer_load_dwordx4 a[184:187], v10, s[4:7], s47 offen offset:3072 sc1
s_mov_b32 s47, 24576
buffer_load_dwordx4 a[188:191], v10, s[4:7], s47 offen offset:0 sc1
s_add_u32 m0, s44, 0
s_nop 0
buffer_load_dwordx4 v8, s[4:7], s45 offen offset:0 sc1 lds
buffer_load_dwordx4 v8, s[4:7], s45 offen offset:1024 sc1 lds
buffer_load_dwordx4 v8, s[4:7], s45 offen offset:2048 sc1 lds
s_add_u32 m0, s44, 3072
s_nop 0
buffer_load_dwordx4 v8, s[4:7], s46 offen offset:0 sc1 lds
buffer_load_dwordx4 v8, s[4:7], s46 offen offset:1024 sc1 lds
s_waitcnt vmcnt(9)
v_cvt_pk_bf16_f32 v72, v192, v193
v_cvt_pk_bf16_f32 v73, v194, v195
v_cvt_pk_bf16_f32 v74, v196, v197
v_cvt_pk_bf16_f32 v75, v198, v199
ds_write_b128 v154, v[72:75] offset:0
v_cvt_pk_bf16_f32 v76, v200, v201
v_cvt_pk_bf16_f32 v77, v202, v203
v_cvt_pk_bf16_f32 v78, v204, v205
v_cvt_pk_bf16_f32 v79, v206, v207
ds_write_b128 v154, v[76:79] offset:1024
s_waitcnt lgkmcnt(0)
s_barrier
buffer_load_dwordx4 v8, s[4:7], s46 offen offset:2048 sc1 lds
s_add_u32 s45, s45, 24576
s_add_u32 s46, s45, 3072
ds_read_b128 v[212:215], v155 offset:5120
ds_read_b128 v[216:219], v155 offset:6144
ds_read_b128 v[192:195], v155 offset:0
ds_read_b128 v[196:199], v155 offset:1024
ds_read_b128 v[200:203], v155 offset:2048
ds_read_b128 v[204:207], v155 offset:3072
ds_read_b128 v[208:211], v155 offset:4096
s_waitcnt lgkmcnt(6)
v_mfma_f32_16x16x32_bf16 v[104:107], v[212:215], v[168:171], v[120:123]
v_mfma_f32_16x16x32_bf16 v[136:139], v[212:215], v[172:175], v[120:123]
s_waitcnt lgkmcnt(5)
v_mfma_f32_16x16x32_bf16 v[104:107], v[216:219], v[176:179], v[104:107]
v_mfma_f32_16x16x32_bf16 v[136:139], v[216:219], v[180:183], v[136:139]
s_waitcnt lgkmcnt(4)
v_mfma_f32_16x16x32_bf16 v[92:95], v[192:195], v[168:171], 0
v_mfma_f32_16x16x32_bf16 v[124:127], v[192:195], v[172:175], 0
s_waitcnt lgkmcnt(3)
v_mfma_f32_16x16x32_bf16 v[96:99], v[196:199], v[168:171], 0
v_mfma_f32_16x16x32_bf16 v[128:131], v[196:199], v[172:175], 0
s_waitcnt lgkmcnt(2)
v_mfma_f32_16x16x32_bf16 v[96:99], v[200:203], v[176:179], v[96:99]
v_mfma_f32_16x16x32_bf16 v[128:131], v[200:203], v[180:183], v[128:131]
s_waitcnt lgkmcnt(1)
v_mfma_f32_16x16x32_bf16 v[100:103], v[204:207], v[168:171], 0
v_mfma_f32_16x16x32_bf16 v[132:135], v[204:207], v[172:175], 0
s_waitcnt lgkmcnt(0)
v_mfma_f32_16x16x32_bf16 v[100:103], v[208:211], v[176:179], v[100:103]
v_mfma_f32_16x16x32_bf16 v[132:135], v[208:211], v[180:183], v[132:135]
s_add_u32 m0, s44, 24576
s_nop 0
buffer_load_dwordx4 v8, s[4:7], s45 offen offset:0 sc1 lds
buffer_load_dwordx4 v8, s[4:7], s45 offen offset:1024 sc1 lds
v_rcp_f32 v104, v104
v_rcp_f32 v105, v105
v_rcp_f32 v136, v136
v_rcp_f32 v137, v137
v_cndmask_b32 v106, v104, v105, s[36:37]
v_cndmask_b32 v138, v136, v137, s[36:37]
v_pk_mul_f32 v[92:93], v[92:93], v[104:105] op_sel:[0,0] op_sel_hi:[1,0]
v_pk_mul_f32 v[94:95], v[94:95], v[104:105] op_sel:[0,0] op_sel_hi:[1,0]
v_cvt_pk_bf16_f32 v168, v92, v93
v_cvt_pk_bf16_f32 v169, v94, v95
v_pk_mul_f32 v[96:97], v[96:97], v[106:107] op_sel:[0,0] op_sel_hi:[1,0]
v_pk_mul_f32 v[98:99], v[98:99], v[106:107] op_sel:[0,0] op_sel_hi:[1,0]
v_cvt_pk_bf16_f32 v170, v96, v97
v_cvt_pk_bf16_f32 v171, v98, v99
buffer_store_dwordx4 v[168:171], v19, s[4:7], 0 offen sc1
v_pk_mul_f32 v[124:125], v[124:125], v[136:137] op_sel:[0,0] op_sel_hi:[1,0]
v_pk_mul_f32 v[126:127], v[126:127], v[136:137] op_sel:[0,0] op_sel_hi:[1,0]
v_cvt_pk_bf16_f32 v172, v124, v125
v_cvt_pk_bf16_f32 v173, v126, v127
v_pk_mul_f32 v[128:129], v[128:129], v[138:139] op_sel:[0,0] op_sel_hi:[1,0]
v_pk_mul_f32 v[130:131], v[130:131], v[138:139] op_sel:[0,0] op_sel_hi:[1,0]
v_cvt_pk_bf16_f32 v174, v128, v129
v_cvt_pk_bf16_f32 v175, v130, v131
buffer_store_dwordx4 v[172:175], v19, s[4:7], s23 offen sc1
v_pk_mul_f32 v[100:101], v[100:101], v[104:105] op_sel:[0,1] op_sel_hi:[1,1]
v_pk_mul_f32 v[102:103], v[102:103], v[104:105] op_sel:[0,1] op_sel_hi:[1,1]
v_cvt_pk_bf16_f32 v176, v100, v101
v_cvt_pk_bf16_f32 v177, v102, v103
v_mov_b32 v178, v176
v_mov_b32 v179, v177
s_nop 0
v_permlane16_swap_b32 v176, v178
v_permlane16_swap_b32 v177, v179
buffer_store_dwordx4 v[176:179], v20, s[4:7], 0 offen sc1
v_pk_mul_f32 v[132:133], v[132:133], v[136:137] op_sel:[0,1] op_sel_hi:[1,1]
v_pk_mul_f32 v[134:135], v[134:135], v[136:137] op_sel:[0,1] op_sel_hi:[1,1]
v_cvt_pk_bf16_f32 v180, v132, v133
v_cvt_pk_bf16_f32 v181, v134, v135
v_mov_b32 v182, v180
v_mov_b32 v183, v181
s_nop 0
v_permlane16_swap_b32 v180, v182
v_permlane16_swap_b32 v181, v183
buffer_store_dwordx4 v[180:183], v20, s[4:7], s23 offen sc1
L_mid:
s_lshl_b32 s16, s13, 2
s_mul_i32 s16, s16, 20480
s_mul_i32 s19, s10, 5120
s_add_u32 s16, s16, s19
s_add_u32 s16, s16, s15
s_add_u32 s16, s16, 12554240
s_add_u32 s17, s10, 0
s_and_b32 s17, s17, 3
buffer_load_dwordx4 v8, s[4:7], s45 offen offset:2048 sc1 lds
s_mul_i32 s17, s17, 20480
s_add_u32 s17, s17, s16
v_add_u32 v240, s17, v2
s_add_u32 s17, s10, 1
s_and_b32 s17, s17, 3
s_mul_i32 s17, s17, 20480
s_add_u32 s17, s17, s16
v_add_u32 v241, s17, v2
s_add_u32 m0, s44, 27648
s_nop 0
buffer_load_dwordx4 v8, s[4:7], s46 offen offset:0 sc1 lds
s_add_u32 s17, s10, 2
s_and_b32 s17, s17, 3
s_mul_i32 s17, s17, 20480
s_add_u32 s17, s17, s16
v_add_u32 v242, s17, v2
s_add_u32 s17, s10, 3
s_and_b32 s17, s17, 3
s_mul_i32 s17, s17, 20480
buffer_load_dwordx4 v8, s[4:7], s46 offen offset:1024 sc1 lds
s_add_u32 s17, s17, s16
v_add_u32 v243, s17, v2
s_add_u32 s17, s10, 3
s_and_b32 s17, s17, 3
s_mul_i32 s17, s17, 10240
s_add_u32 s17, s17, 122880
v_add_u32 v244, s17, v2
s_mul_i32 s17, s10, 10240
buffer_load_dwordx4 v8, s[4:7], s46 offen offset:2048 sc1 lds
s_add_u32 s45, s45, 24576
s_add_u32 s46, s45, 3072
s_add_u32 s17, s17, 122880
v_add_u32 v245, s17, v2
s_lshl_b32 s16, s13, 2
s_add_u32 s16, s16, s10
s_and_b32 s19, s14, 1
s_mul_i32 s29, s14, 5
s_add_u32 s30, s29, s19
s_xor_b32 s19, s19, 1
s_add_u32 m0, s44, 49152
s_nop 0
buffer_load_dwordx4 v8, s[4:7], s45 offen offset:0 sc1 lds
s_lshl_b32 s19, s19, 2
s_add_u32 s29, s29, s19
s_mul_i32 s17, s16, 20480
s_add_u32 s17, s17, s15
s_add_u32 s17, s17, 9744384
s_lshl_b32 s19, s30, 9
s_add_u32 s19, s19, s17
v_add_u32 v246, s19, v2
buffer_load_dwordx4 v8, s[4:7], s45 offen offset:1024 sc1 lds
v_lshrrev_b32 v250, 1, v4
v_lshlrev_b32 v250, 8, v250
v_lshl_add_u32 v250, v3, 4, v250
s_lshl_b32 s19, s29, 9
s_add_u32 s19, s19, s17
v_add_u32 v248, s19, v250
v_add_u32 v247, s17, v250
v_and_b32 v250, 1, v4
buffer_load_dwordx4 v8, s[4:7], s45 offen offset:2048 sc1 lds
v_lshl_add_u32 v247, v250, 3, v247
v_lshl_add_u32 v248, v250, 30, v248
s_mov_b32 s32, s4
s_mov_b32 s33, s5
s_mov_b32 s34, s6
s_mov_b32 s35, 0x20000
s_mov_b32 s31, 512
s_mul_i32 s38, s30, s31
s_add_u32 m0, s44, 52224
s_nop 0
buffer_load_dwordx4 v8, s[4:7], s46 offen offset:0 sc1 lds
s_mul_i32 s39, s29, s31
s_lshl_b32 s17, s16, 10
s_add_u32 s17, s17, s15
s_add_u32 s17, s17, 17797120
s_lshl_b32 s19, s14, 7
s_add_u32 s17, s17, s19
v_lshl_add_u32 v249, v3, 3, s17
v_mov_b32 v250, 0x40000000
v_and_b32 v250, v250, v5
v_or_b32 v249, v250, v249
s_cmp_lg_u32 s15, 0
s_cbranch_scc1 L_res_3
buffer_load_dwordx2 v[228:229], v247, s[32:35], s38 offen sc1
s_add_u32 s38, s38, s31
buffer_load_dwordx2 v[230:231], v247, s[32:35], s38 offen sc1
s_add_u32 s38, s38, s31
buffer_load_dwordx2 v[232:233], v247, s[32:35], s38 offen sc1
s_add_u32 s38, s38, s31
buffer_load_dwordx2 v[234:235], v247, s[32:35], s38 offen sc1
buffer_load_dwordx2 v[236:237], v247, s[32:35], s39 offen sc1
L_res_3:
s_waitcnt vmcnt(8)
s_waitcnt lgkmcnt(0)
s_add_u32 s40, s40, 16
s_barrier
s_cmp_lg_u32 s10, 0
s_cbranch_scc1 L_arr_4
v_mov_b32 v255, 1
buffer_atomic_add v255, v5, s[4:7], 0 offen
L_arr_4:
s_cmp_lg_u32 s10, 1
s_cbranch_scc1 L_other_6
v_mov_b32 v255, 0
buffer_atomic_add v255, v6, s[4:7], 0 offen sc0
buffer_load_dwordx4 v8, s[4:7], s46 offen offset:1024 sc1 lds
buffer_load_dwordx4 v8, s[4:7], s46 offen offset:2048 sc1 lds
s_add_u32 s45, s45, 24576
s_add_u32 s46, s45, 3072
v_mov_b32 v254, 0
buffer_atomic_add v254, v6, s[4:7], 0 offen sc0
s_add_u32 m0, s44, 73728
s_nop 0
buffer_load_dwordx4 v8, s[4:7], s45 offen offset:0 sc1 lds
buffer_load_dwordx4 v8, s[4:7], s45 offen offset:1024 sc1 lds
v_mov_b32 v253, 0
buffer_atomic_add v253, v6, s[4:7], 0 offen sc0
buffer_load_dwordx4 v8, s[4:7], s45 offen offset:2048 sc1 lds
s_sleep 2
v_mov_b32 v252, 0
buffer_atomic_add v252, v6, s[4:7], 0 offen sc0
s_waitcnt vmcnt(8)
v_readfirstlane_b32 s43, v255
s_cmp_ge_u32 s43, s40
s_cbranch_scc1 L_pdone_5
v_mov_b32 v255, 0
buffer_atomic_add v255, v6, s[4:7], 0 offen sc0
s_waitcnt vmcnt(6)
v_readfirstlane_b32 s43, v254
s_cmp_ge_u32 s43, s40
s_cbranch_scc1 L_pdone_5
v_mov_b32 v254, 0
buffer_atomic_add v254, v6, s[4:7], 0 offen sc0
s_waitcnt vmcnt(4)
v_readfirstlane_b32 s43, v253
s_cmp_ge_u32 s43, s40
s_cbranch_scc1 L_pdone_5
s_mov_b32 s42, 200000
L_poll_7:
v_mov_b32 v253, 0
buffer_atomic_add v253, v6, s[4:7], 0 offen sc0
s_waitcnt vmcnt(3)
v_readfirstlane_b32 s43, v252
s_cmp_ge_u32 s43, s40
s_cbranch_scc1 L_pdone_5
v_mov_b32 v252, 0
buffer_atomic_add v252, v6, s[4:7], 0 offen sc0
s_waitcnt vmcnt(3)
v_readfirstlane_b32 s43, v255
s_cmp_ge_u32 s43, s40
s_cbranch_scc1 L_pdone_5
v_mov_b32 v255, 0
buffer_atomic_add v255, v6, s[4:7], 0 offen sc0
s_waitcnt vmcnt(3)
v_readfirstlane_b32 s43, v254
s_cmp_ge_u32 s43, s40
s_cbranch_scc1 L_pdone_5
v_mov_b32 v254, 0
buffer_atomic_add v254, v6, s[4:7], 0 offen sc0
s_waitcnt vmcnt(3)
v_readfirstlane_b32 s43, v253
s_cmp_ge_u32 s43, s40
s_cbranch_scc1 L_pdone_5
s_sub_u32 s42, s42, 1
s_cbranch_scc0 L_poll_7
s_branch L_pdone_5
L_other_6:
buffer_load_dwordx4 v8, s[4:7], s46 offen offset:1024 sc1 lds
buffer_load_dwordx4 v8, s[4:7], s46 offen offset:2048 sc1 lds
s_add_u32 s45, s45, 24576
s_add_u32 s46, s45, 3072
s_add_u32 m0, s44, 73728
s_nop 0
buffer_load_dwordx4 v8, s[4:7], s45 offen offset:0 sc1 lds
buffer_load_dwordx4 v8, s[4:7], s45 offen offset:1024 sc1 lds
buffer_load_dwordx4 v8, s[4:7], s45 offen offset:2048 sc1 lds
L_pdone_5:
s_barrier
s_mov_b32 s20, 0
buffer_load_dwordx4 v[124:127], v241, s[4:7], s20 offen offset:0 sc1
buffer_load_dwordx4 v[128:131], v241, s[4:7], s20 offen offset:1024 sc1
buffer_load_dwordx4 v[132:135], v241, s[4:7], s20 offen offset:2048 sc1
buffer_load_dwordx4 v[136:139], v241, s[4:7], s20 offen offset:3072 sc1
s_mov_b32 s20, 4096
buffer_load_dwordx4 v[140:143], v241, s[4:7], s20 offen offset:0 sc1
s_mov_b32 s20, 0
buffer_load_dwordx4 v[144:147], v242, s[4:7], s20 offen offset:0 sc1
buffer_load_dwordx4 v[148:151], v242, s[4:7], s20 offen offset:1024 sc1
buffer_load_dwordx4 v[152:155], v242, s[4:7], s20 offen offset:2048 sc1
buffer_load_dwordx4 v[156:159], v242, s[4:7], s20 offen offset:3072 sc1
s_mov_b32 s20, 4096
buffer_load_dwordx4 v[160:163], v242, s[4:7], s20 offen offset:0 sc1
s_waitcnt vmcnt(9)
v_mfma_f32_16x16x32_bf16 v[64:67], a[192:195], v[124:127], 0
v_mfma_f32_16x16x32_bf16 v[68:71], a[196:199], v[124:127], 0
v_mfma_f32_16x16x32_bf16 v[72:75], a[200:203], v[124:127], 0
v_mfma_f32_16x16x32_bf16 v[76:79], a[204:207], v[124:127], 0
s_mov_b32 s20, 0
buffer_load_dwordx4 v[164:167], v243, s[4:7], s20 offen offset:0 sc1
v_mfma_f32_16x16x32_bf16 v[80:83], a[208:211], v[124:127], 0
s_waitcnt vmcnt(9)
s_cmp_eq_u32 s15, 0
s_cbranch_scc1 L_unsw_8
v_permlane16_swap_b32 v228, v230
v_permlane16_swap_b32 v229, v231
v_permlane16_swap_b32 v232, v234
v_permlane16_swap_b32 v233, v235
v_permlane32_swap_b32 v228, v230
v_permlane32_swap_b32 v229, v231
v_permlane32_swap_b32 v232, v234
v_permlane32_swap_b32 v233, v235
L_unsw_8:
s_nop 0
v_lshlrev_b32 v44, 16, v228
v_and_b32 v45, 0xffff0000, v228
v_lshlrev_b32 v46, 16, v229
v_and_b32 v47, 0xffff0000, v229
v_lshlrev_b32 v48, 16, v230
v_and_b32 v49, 0xffff0000, v230
v_lshlrev_b32 v50, 16, v231
v_and_b32 v51, 0xffff0000, v231
v_lshlrev_b32 v52, 16, v232
v_and_b32 v53, 0xffff0000, v232
v_lshlrev_b32 v54, 16, v233
v_and_b32 v55, 0xffff0000, v233
v_lshlrev_b32 v56, 16, v234
v_and_b32 v57, 0xffff0000, v234
v_lshlrev_b32 v58, 16, v235
v_and_b32 v59, 0xffff0000, v235
v_lshlrev_b32 v60, 16, v236
v_and_b32 v61, 0xffff0000, v236
v_lshlrev_b32 v62, 16, v237
v_and_b32 v63, 0xffff0000, v237
v_mfma_f32_16x16x32_bf16 v[64:67], a[212:215], v[128:131], v[64:67]
v_mfma_f32_16x16x32_bf16 v[68:71], a[216:219], v[128:131], v[68:71]
v_mfma_f32_16x16x32_bf16 v[72:75], a[220:223], v[128:131], v[72:75]
buffer_load_dwordx4 v[168:171], v243, s[4:7], s20 offen offset:1024 sc1
v_mfma_f32_16x16x32_bf16 v[76:79], a[224:227], v[128:131], v[76:79]
v_mfma_f32_16x16x32_bf16 v[80:83], a[228:231], v[128:131], v[80:83]
s_waitcnt vmcnt(9)
v_mfma_f32_16x16x32_bf16 v[64:67], a[232:235], v[132:135], v[64:67]
v_mfma_f32_16x16x32_bf16 v[68:71], a[236:239], v[132:135], v[68:71]
buffer_load_dwordx4 v[172:175], v243, s[4:7], s20 offen offset:2048 sc1
v_mfma_f32_16x16x32_bf16 v[72:75], a[240:243], v[132:135], v[72:75]
v_mfma_f32_16x16x32_bf16 v[76:79], a[244:247], v[132:135], v[76:79]
v_mfma_f32_16x16x32_bf16 v[80:83], a[248:251], v[132:135], v[80:83]
s_waitcnt vmcnt(9)
v_mfma_f32_16x16x32_bf16 v[64:67], a[252:255], v[136:139], v[64:67]
buffer_load_dwordx4 v[176:179], v243, s[4:7], s20 offen offset:3072 sc1
v_mfma_f32_16x16x32_bf16 v[68:71], a[156:159], v[136:139], v[68:71]
v_mfma_f32_16x16x32_bf16 v[72:75], a[160:163], v[136:139], v[72:75]
v_mfma_f32_16x16x32_bf16 v[76:79], a[164:167], v[136:139], v[76:79]
v_mfma_f32_16x16x32_bf16 v[80:83], a[168:171], v[136:139], v[80:83]
s_mov_b32 s20, 4096
buffer_load_dwordx4 v[180:183], v243, s[4:7], s20 offen offset:0 sc1
s_waitcnt vmcnt(10)
v_mfma_f32_16x16x32_bf16 v[64:67], a[172:175], v[140:143], v[64:67]
v_mfma_f32_16x16x32_bf16 v[68:71], a[176:179], v[140:143], v[68:71]
v_mfma_f32_16x16x32_bf16 v[72:75], a[180:183], v[140:143], v[72:75]
v_mfma_f32_16x16x32_bf16 v[76:79], a[184:187], v[140:143], v[76:79]
s_mov_b32 s20, 0
buffer_load_dwordx4 v[184:187], v240, s[4:7], s20 offen offset:0 sc1
v_mfma_f32_16x16x32_bf16 v[80:83], a[188:191], v[140:143], v[80:83]
s_waitcnt vmcnt(10)
v_mfma_f32_16x16x32_bf16 v[84:87], a[192:195], v[144:147], 0
v_mfma_f32_16x16x32_bf16 v[88:91], a[196:199], v[144:147], 0
ds_write_b128 v244, v[64:67] offset:0
ds_write_b128 v244, v[68:71] offset:1024
v_mfma_f32_16x16x32_bf16 v[92:95], a[200:203], v[144:147], 0
buffer_load_dwordx4 v[188:191], v240, s[4:7], s20 offen offset:1024 sc1
v_mfma_f32_16x16x32_bf16 v[96:99], a[204:207], v[144:147], 0
ds_write_b128 v244, v[72:75] offset:2048
ds_write_b128 v244, v[76:79] offset:3072
ds_write_b128 v244, v[80:83] offset:4096
v_mfma_f32_16x16x32_bf16 v[100:103], a[208:211], v[144:147], 0
s_waitcnt vmcnt(10)
v_mfma_f32_16x16x32_bf16 v[84:87], a[212:215], v[148:151], v[84:87]
v_mfma_f32_16x16x32_bf16 v[88:91], a[216:219], v[148:151], v[88:91]
buffer_load_dwordx4 v[192:195], v240, s[4:7], s20 offen offset:2048 sc1
v_mfma_f32_16x16x32_bf16 v[92:95], a[220:223], v[148:151], v[92:95]
s_waitcnt lgkmcnt(0)
s_barrier
ds_read_b128 v[204:207], v245 offset:0
ds_read_b128 v[208:211], v245 offset:1024
ds_read_b128 v[212:215], v245 offset:2048
ds_read_b128 v[216:219], v245 offset:3072
ds_read_b128 v[220:223], v245 offset:4096
v_mfma_f32_16x16x32_bf16 v[96:99], a[224:227], v[148:151], v[96:99]
v_mfma_f32_16x16x32_bf16 v[100:103], a[228:231], v[148:151], v[100:103]
s_waitcnt vmcnt(10)
v_mfma_f32_16x16x32_bf16 v[84:87], a[232:235], v[152:155], v[84:87]
buffer_load_dwordx4 v[196:199], v240, s[4:7], s20 offen offset:3072 sc1
v_mfma_f32_16x16x32_bf16 v[88:91], a[236:239], v[152:155], v[88:91]
v_mfma_f32_16x16x32_bf16 v[92:95], a[240:243], v[152:155], v[92:95]
v_mfma_f32_16x16x32_bf16 v[96:99], a[244:247], v[152:155], v[96:99]
v_mfma_f32_16x16x32_bf16 v[100:103], a[248:251], v[152:155], v[100:103]
s_mov_b32 s20, 4096
buffer_load_dwordx4 v[200:203], v240, s[4:7], s20 offen offset:0 sc1
s_waitcnt vmcnt(11)
v_mfma_f32_16x16x32_bf16 v[84:87], a[252:255], v[156:159], v[84:87]
v_mfma_f32_16x16x32_bf16 v[88:91], a[156:159], v[156:159], v[88:91]
v_mfma_f32_16x16x32_bf16 v[92:95], a[160:163], v[156:159], v[92:95]
v_mfma_f32_16x16x32_bf16 v[96:99], a[164:167], v[156:159], v[96:99]
s_add_u32 m0, s44, 76800
s_nop 0
buffer_load_dwordx4 v8, s[4:7], s46 offen offset:0 sc1 lds
v_mfma_f32_16x16x32_bf16 v[100:103], a[168:171], v[156:159], v[100:103]
s_waitcnt vmcnt(11)
v_mfma_f32_16x16x32_bf16 v[84:87], a[172:175], v[160:163], v[84:87]
v_mfma_f32_16x16x32_bf16 v[88:91], a[176:179], v[160:163], v[88:91]
v_mfma_f32_16x16x32_bf16 v[92:95], a[180:183], v[160:163], v[92:95]
buffer_load_dwordx4 v8, s[4:7], s46 offen offset:1024 sc1 lds
v_mfma_f32_16x16x32_bf16 v[96:99], a[184:187], v[160:163], v[96:99]
v_mfma_f32_16x16x32_bf16 v[100:103], a[188:191], v[160:163], v[100:103]
s_waitcnt vmcnt(11)
v_mfma_f32_16x16x32_bf16 v[104:107], a[192:195], v[164:167], 0
v_mfma_f32_16x16x32_bf16 v[108:111], a[196:199], v[164:167], 0
buffer_load_dwordx4 v8, s[4:7], s46 offen offset:2048 sc1 lds
s_add_u32 s45, s45, 24576
s_add_u32 s46, s45, 3072
v_mfma_f32_16x16x32_bf16 v[112:115], a[200:203], v[164:167], 0
s_waitcnt lgkmcnt(4)
v_add_f32 v84, v84, v204
v_mfma_f32_16x16x32_bf16 v[116:119], a[204:207], v[164:167], 0
v_add_f32 v85, v85, v205
v_add_f32 v86, v86, v206
v_add_f32 v87, v87, v207
v_mfma_f32_16x16x32_bf16 v[120:123], a[208:211], v[164:167], 0
ds_write_b128 v244, v[84:87] offset:5120
s_waitcnt lgkmcnt(4)
v_add_f32 v88, v88, v208
s_waitcnt vmcnt(11)
v_mfma_f32_16x16x32_bf16 v[104:107], a[212:215], v[168:171], v[104:107]
s_mov_b32 s58, 0
buffer_load_dwordx4 a[0:3], v11, s[4:7], s58 offen offset:0 sc1
v_mfma_f32_16x16x32_bf16 v[108:111], a[216:219], v[168:171], v[108:111]
v_add_f32 v89, v89, v209
v_add_f32 v90, v90, v210
v_add_f32 v91, v91, v211
v_mfma_f32_16x16x32_bf16 v[112:115], a[220:223], v[168:171], v[112:115]
ds_write_b128 v244, v[88:91] offset:6144
s_waitcnt lgkmcnt(4)
v_add_f32 v92, v92, v212
v_mfma_f32_16x16x32_bf16 v[116:119], a[224:227], v[168:171], v[116:119]
v_add_f32 v93, v93, v213
v_add_f32 v94, v94, v214
v_add_f32 v95, v95, v215
v_mfma_f32_16x16x32_bf16 v[120:123], a[228:231], v[168:171], v[120:123]
buffer_load_dwordx4 a[4:7], v11, s[4:7], s58 offen offset:1024 sc1
s_waitcnt vmcnt(12)
v_mfma_f32_16x16x32_bf16 v[104:107], a[232:235], v[172:175], v[104:107]
ds_write_b128 v244, v[92:95] offset:7168
s_waitcnt lgkmcnt(4)
v_add_f32 v96, v96, v216
v_mfma_f32_16x16x32_bf16 v[108:111], a[236:239], v[172:175], v[108:111]
v_add_f32 v97, v97, v217
v_add_f32 v98, v98, v218
v_add_f32 v99, v99, v219
v_mfma_f32_16x16x32_bf16 v[112:115], a[240:243], v[172:175], v[112:115]
ds_write_b128 v244, v[96:99] offset:8192
s_waitcnt lgkmcnt(4)
v_add_f32 v100, v100, v220
v_mfma_f32_16x16x32_bf16 v[116:119], a[244:247], v[172:175], v[116:119]
buffer_load_dwordx4 a[8:11], v11, s[4:7], s58 offen offset:2048 sc1
v_mfma_f32_16x16x32_bf16 v[120:123], a[248:251], v[172:175], v[120:123]
v_add_f32 v101, v101, v221
v_add_f32 v102, v102, v222
v_add_f32 v103, v103, v223
s_waitcnt vmcnt(12)
v_mfma_f32_16x16x32_bf16 v[104:107], a[252:255], v[176:179], v[104:107]
ds_write_b128 v244, v[100:103] offset:9216
v_mfma_f32_16x16x32_bf16 v[108:111], a[156:159], v[176:179], v[108:111]
v_mfma_f32_16x16x32_bf16 v[112:115], a[160:163], v[176:179], v[112:115]
buffer_load_dwordx4 a[12:15], v11, s[4:7], s58 offen offset:3072 sc1
v_mfma_f32_16x16x32_bf16 v[116:119], a[164:167], v[176:179], v[116:119]
v_mfma_f32_16x16x32_bf16 v[120:123], a[168:171], v[176:179], v[120:123]
s_waitcnt lgkmcnt(0)
s_barrier
ds_read_b128 v[204:207], v245 offset:5120
ds_read_b128 v[208:211], v245 offset:6144
ds_read_b128 v[212:215], v245 offset:7168
ds_read_b128 v[216:219], v245 offset:8192
ds_read_b128 v[220:223], v245 offset:9216
s_waitcnt vmcnt(12)
v_mfma_f32_16x16x32_bf16 v[104:107], a[172:175], v[180:183], v[104:107]
v_mfma_f32_16x16x32_bf16 v[108:111], a[176:179], v[180:183], v[108:111]
s_mov_b32 s58, 4096
buffer_load_dwordx4 a[16:19], v11, s[4:7], s58 offen offset:0 sc1
v_mfma_f32_16x16x32_bf16 v[112:115], a[180:183], v[180:183], v[112:115]
v_mfma_f32_16x16x32_bf16 v[116:119], a[184:187], v[180:183], v[116:119]
v_mfma_f32_16x16x32_bf16 v[120:123], a[188:191], v[180:183], v[120:123]
s_waitcnt vmcnt(12)
v_mfma_f32_16x16x32_bf16 v[44:47], a[192:195], v[184:187], v[44:47]
s_mov_b32 s58, 15360
buffer_load_dwordx4 a[20:23], v11, s[4:7], s58 offen offset:0 sc1
v_mfma_f32_16x16x32_bf16 v[48:51], a[196:199], v[184:187], v[48:51]
v_mfma_f32_16x16x32_bf16 v[52:55], a[200:203], v[184:187], v[52:55]
s_waitcnt lgkmcnt(4)
v_add_f32 v104, v104, v204
v_mfma_f32_16x16x32_bf16 v[56:59], a[204:207], v[184:187], v[56:59]
v_add_f32 v105, v105, v205
v_add_f32 v106, v106, v206
v_add_f32 v107, v107, v207
v_mfma_f32_16x16x32_bf16 v[60:63], a[208:211], v[184:187], v[60:63]
buffer_load_dwordx4 a[24:27], v11, s[4:7], s58 offen offset:1024 sc1
s_waitcnt vmcnt(13)
v_mfma_f32_16x16x32_bf16 v[44:47], a[212:215], v[188:191], v[44:47]
ds_write_b128 v244, v[104:107] offset:0
s_waitcnt lgkmcnt(4)
v_add_f32 v108, v108, v208
v_mfma_f32_16x16x32_bf16 v[48:51], a[216:219], v[188:191], v[48:51]
v_add_f32 v109, v109, v209
v_add_f32 v110, v110, v210
v_add_f32 v111, v111, v211
v_mfma_f32_16x16x32_bf16 v[52:55], a[220:223], v[188:191], v[52:55]
ds_write_b128 v244, v[108:111] offset:1024
s_waitcnt lgkmcnt(4)
v_add_f32 v112, v112, v212
v_mfma_f32_16x16x32_bf16 v[56:59], a[224:227], v[188:191], v[56:59]
buffer_load_dwordx4 a[28:31], v11, s[4:7], s58 offen offset:2048 sc1
v_mfma_f32_16x16x32_bf16 v[60:63], a[228:231], v[188:191], v[60:63]
v_add_f32 v113, v113, v213
v_add_f32 v114, v114, v214
v_add_f32 v115, v115, v215
s_waitcnt vmcnt(13)
v_mfma_f32_16x16x32_bf16 v[44:47], a[232:235], v[192:195], v[44:47]
ds_write_b128 v244, v[112:115] offset:2048
s_waitcnt lgkmcnt(4)
v_add_f32 v116, v116, v216
v_mfma_f32_16x16x32_bf16 v[48:51], a[236:239], v[192:195], v[48:51]
v_add_f32 v117, v117, v217
v_add_f32 v118, v118, v218
v_add_f32 v119, v119, v219
v_mfma_f32_16x16x32_bf16 v[52:55], a[240:243], v[192:195], v[52:55]
buffer_load_dwordx4 a[32:35], v11, s[4:7], s58 offen offset:3072 sc1
v_mfma_f32_16x16x32_bf16 v[56:59], a[244:247], v[192:195], v[56:59]
ds_write_b128 v244, v[116:119] offset:3072
s_waitcnt lgkmcnt(4)
v_add_f32 v120, v120, v220
v_mfma_f32_16x16x32_bf16 v[60:63], a[248:251], v[192:195], v[60:63]
v_add_f32 v121, v121, v221
v_add_f32 v122, v122, v222
v_add_f32 v123, v123, v223
s_waitcnt vmcnt(13)
v_mfma_f32_16x16x32_bf16 v[44:47], a[252:255], v[196:199], v[44:47]
ds_write_b128 v244, v[120:123] offset:4096
v_mfma_f32_16x16x32_bf16 v[48:51], a[156:159], v[196:199], v[48:51]
s_mov_b32 s58, 19456
buffer_load_dwordx4 a[36:39], v11, s[4:7], s58 offen offset:0 sc1
v_mfma_f32_16x16x32_bf16 v[52:55], a[160:163], v[196:199], v[52:55]
v_mfma_f32_16x16x32_bf16 v[56:59], a[164:167], v[196:199], v[56:59]
v_mfma_f32_16x16x32_bf16 v[60:63], a[168:171], v[196:199], v[60:63]
s_waitcnt lgkmcnt(0)
s_barrier
ds_read_b128 v[204:207], v245 offset:0
ds_read_b128 v[208:211], v245 offset:1024
ds_read_b128 v[212:215], v245 offset:2048
ds_read_b128 v[216:219], v245 offset:3072
ds_read_b128 v[220:223], v245 offset:4096
s_waitcnt vmcnt(13)
v_mfma_f32_16x16x32_bf16 v[44:47], a[172:175], v[200:203], v[44:47]
v_mfma_f32_16x16x32_bf16 v[48:51], a[176:179], v[200:203], v[48:51]
v_mfma_f32_16x16x32_bf16 v[52:55], a[180:183], v[200:203], v[52:55]
v_mfma_f32_16x16x32_bf16 v[56:59], a[184:187], v[200:203], v[56:59]
v_mfma_f32_16x16x32_bf16 v[60:63], a[188:191], v[200:203], v[60:63]
s_mov_b32 s28, 5431296
s_waitcnt lgkmcnt(4)
s_nop 1
v_pk_add_f32 v[44:45], v[44:45], v[204:205] op_sel:[0,0] op_sel_hi:[1,1]
v_pk_add_f32 v[46:47], v[46:47], v[206:207] op_sel:[0,0] op_sel_hi:[1,1]
s_waitcnt lgkmcnt(3)
v_pk_add_f32 v[48:49], v[48:49], v[208:209] op_sel:[0,0] op_sel_hi:[1,1]
v_pk_add_f32 v[50:51], v[50:51], v[210:211] op_sel:[0,0] op_sel_hi:[1,1]
s_waitcnt lgkmcnt(2)
v_pk_add_f32 v[52:53], v[52:53], v[212:213] op_sel:[0,0] op_sel_hi:[1,1]
v_pk_add_f32 v[54:55], v[54:55], v[214:215] op_sel:[0,0] op_sel_hi:[1,1]
s_waitcnt lgkmcnt(1)
v_pk_add_f32 v[56:57], v[56:57], v[216:217] op_sel:[0,0] op_sel_hi:[1,1]
v_pk_add_f32 v[58:59], v[58:59], v[218:219] op_sel:[0,0] op_sel_hi:[1,1]
s_waitcnt lgkmcnt(0)
s_nop 0
v_pk_add_f32 v[60:61], v[60:61], v[220:221] op_sel:[0,0] op_sel_hi:[1,1]
v_pk_add_f32 v[62:63], v[62:63], v[222:223] op_sel:[0,0] op_sel_hi:[1,1]
v_cvt_pk_bf16_f32 v228, v44, v45
v_cvt_pk_bf16_f32 v229, v46, v47
v_cvt_pk_bf16_f32 v230, v48, v49
v_cvt_pk_bf16_f32 v231, v50, v51
v_cvt_pk_bf16_f32 v232, v52, v53
v_cvt_pk_bf16_f32 v233, v54, v55
v_cvt_pk_bf16_f32 v234, v56, v57
v_cvt_pk_bf16_f32 v235, v58, v59
v_cvt_pk_bf16_f32 v236, v60, v61
v_cvt_pk_bf16_f32 v237, v62, v63
v_mov_b32 v28, v236
v_mov_b32 v29, v237
v_mov_b32 v30, v236
v_mov_b32 v31, v237
v_permlane32_swap_b32 v228, v230
v_permlane32_swap_b32 v229, v231
s_nop 0
v_permlane16_swap_b32 v228, v230
v_permlane16_swap_b32 v229, v231
buffer_store_dwordx4 v[228:231], v246, s[4:7], s28 offen sc1
v_permlane32_swap_b32 v232, v234
v_permlane32_swap_b32 v233, v235
s_nop 0
v_permlane16_swap_b32 v232, v234
v_permlane16_swap_b32 v233, v235
v_permlane16_swap_b32 v28, v30
v_permlane16_swap_b32 v29, v31
buffer_store_dwordx4 v[232:235], v246, s[4:7], s28 offen offset:1024 sc1
buffer_store_dwordx4 v[28:31], v248, s[4:7], s28 offen sc1
s_mov_b32 s24, 0x3f803f80
v_mov_b32 v24, 0
v_mov_b32 v25, 0
v_mov_b32 v26, 0
v_mov_b32 v27, 0
v_dot2c_f32_bf16 v24, s24, v228
v_dot2c_f32_bf16 v25, v228, v228
v_dot2c_f32_bf16 v26, s24, v229
v_dot2c_f32_bf16 v27, v229, v229
v_dot2c_f32_bf16 v24, s24, v230
v_dot2c_f32_bf16 v25, v230, v230
v_dot2c_f32_bf16 v26, s24, v231
v_dot2c_f32_bf16 v27, v231, v231
v_dot2c_f32_bf16 v24, s24, v232
v_dot2c_f32_bf16 v25, v232, v232
v_dot2c_f32_bf16 v26, s24, v233
v_dot2c_f32_bf16 v27, v233, v233
v_dot2c_f32_bf16 v24, s24, v234
v_dot2c_f32_bf16 v25, v234, v234
v_dot2c_f32_bf16 v26, s24, v235
v_dot2c_f32_bf16 v27, v235, v235
v_dot2c_f32_bf16 v24, s24, v236
v_dot2c_f32_bf16 v25, v236, v236
v_dot2c_f32_bf16 v26, s24, v237
v_dot2c_f32_bf16 v27, v237, v237
s_nop 2
v_pk_add_f32 v[26:27], v[26:27], v[24:25] op_sel:[0,0] op_sel_hi:[1,1]
v_mov_b32 v24, v26
v_mov_b32 v25, v27
s_nop 0
v_permlane16_swap_b32 v26, v24
v_permlane16_swap_b32 v27, v25
v_pk_add_f32 v[26:27], v[26:27], v[24:25] op_sel:[0,0] op_sel_hi:[1,1]
v_mov_b32 v24, v26
v_mov_b32 v25, v27
s_nop 0
v_permlane32_swap_b32 v26, v24
v_permlane32_swap_b32 v27, v25
v_pk_add_f32 v[26:27], v[26:27], v[24:25] op_sel:[0,0] op_sel_hi:[1,1]
buffer_store_dwordx2 v[26:27], v249, s[4:7], 0 offen sc1
s_lshl_b32 s16, s11, 3
s_lshl_b32 s17, s10, 1
s_add_u32 s16, s16, s17
s_mul_i32 s17, s16, 20480
s_add_u32 s17, s17, s15
s_add_u32 s17, s17, 15175680
v_add_u32 v12, s17, v2
v_add_u32 v13, 20480, v12
v_add_u32 v14, 0x10000, v2
v_add_u32 v15, 0x20000, v2
v_lshlrev_b32 v28, 3, v3
v_lshl_add_u32 v28, v4, 8, v28
s_lshl_b32 s17, s16, 10
s_add_u32 s17, s17, s15
s_add_u32 s17, s17, 17797120
v_add_u32 v16, s17, v28
s_mul_i32 s17, s12, 768
s_add_u32 s17, s17, 9502720
v_lshl_add_u32 v17, v4, 4, s17
s_mul_i32 s17, s16, 49152
s_mul_i32 s19, s12, 3072
s_add_u32 s17, s17, s19
s_add_u32 s17, s17, s15
s_add_u32 s17, s17, 17928192
v_add_u32 v18, s17, v2
s_mov_b32 s23, 49152
s_lshl_b32 s20, s8, 11
s_mov_b32 s24, 0xbdd2d3e8
v_mov_b32 v43, 0xc0135761
s_waitcnt vmcnt(0)
s_waitcnt lgkmcnt(0)
s_add_u32 s40, s40, 16
s_barrier
s_cmp_lg_u32 s10, 0
s_cbranch_scc1 L_arr_9
v_mov_b32 v255, 1
buffer_atomic_add v255, v5, s[4:7], 0 offen
L_arr_9:
s_cmp_lg_u32 s10, 1
s_cbranch_scc1 L_other_11
v_mov_b32 v255, 0
buffer_atomic_add v255, v6, s[4:7], 0 offen sc0
s_add_u32 m0, s44, 98304
s_nop 0
buffer_load_dwordx4 v8, s[4:7], s45 offen offset:0 sc1 lds
buffer_load_dwordx4 v8, s[4:7], s45 offen offset:1024 sc1 lds
v_mov_b32 v254, 0
buffer_atomic_add v254, v6, s[4:7], 0 offen sc0
buffer_load_dwordx4 v8, s[4:7], s45 offen offset:2048 sc1 lds
s_add_u32 m0, s44, 101376
s_nop 0
buffer_load_dwordx4 v8, s[4:7], s46 offen offset:0 sc1 lds
v_mov_b32 v253, 0
buffer_atomic_add v253, v6, s[4:7], 0 offen sc0
buffer_load_dwordx4 v8, s[4:7], s46 offen offset:1024 sc1 lds
buffer_load_dwordx4 v8, s[4:7], s46 offen offset:2048 sc1 lds
s_add_u32 s45, s45, 24576
s_add_u32 s46, s45, 3072
v_mov_b32 v252, 0
buffer_atomic_add v252, v6, s[4:7], 0 offen sc0
s_waitcnt vmcnt(9)
v_readfirstlane_b32 s43, v255
s_cmp_ge_u32 s43, s40
s_cbranch_scc1 L_pdone_10
v_mov_b32 v255, 0
buffer_atomic_add v255, v6, s[4:7], 0 offen sc0
s_waitcnt vmcnt(7)
v_readfirstlane_b32 s43, v254
s_cmp_ge_u32 s43, s40
s_cbranch_scc1 L_pdone_10
v_mov_b32 v254, 0
buffer_atomic_add v254, v6, s[4:7], 0 offen sc0
s_waitcnt vmcnt(5)
v_readfirstlane_b32 s43, v253
s_cmp_ge_u32 s43, s40
s_cbranch_scc1 L_pdone_10
s_mov_b32 s42, 200000
L_poll_12:
v_mov_b32 v253, 0
buffer_atomic_add v253, v6, s[4:7], 0 offen sc0
s_waitcnt vmcnt(3)
v_readfirstlane_b32 s43, v252
s_cmp_ge_u32 s43, s40
s_cbranch_scc1 L_pdone_10
v_mov_b32 v252, 0
buffer_atomic_add v252, v6, s[4:7], 0 offen sc0
s_waitcnt vmcnt(3)
v_readfirstlane_b32 s43, v255
s_cmp_ge_u32 s43, s40
s_cbranch_scc1 L_pdone_10
v_mov_b32 v255, 0
buffer_atomic_add v255, v6, s[4:7], 0 offen sc0
s_waitcnt vmcnt(3)
v_readfirstlane_b32 s43, v254
s_cmp_ge_u32 s43, s40
s_cbranch_scc1 L_pdone_10
v_mov_b32 v254, 0
buffer_atomic_add v254, v6, s[4:7], 0 offen sc0
s_waitcnt vmcnt(3)
v_readfirstlane_b32 s43, v253
s_cmp_ge_u32 s43, s40
s_cbranch_scc1 L_pdone_10
s_sub_u32 s42, s42, 1
s_cbranch_scc0 L_poll_12
s_branch L_pdone_10
L_other_11:
s_add_u32 m0, s44, 98304
s_nop 0
buffer_load_dwordx4 v8, s[4:7], s45 offen offset:0 sc1 lds
buffer_load_dwordx4 v8, s[4:7], s45 offen offset:1024 sc1 lds
buffer_load_dwordx4 v8, s[4:7], s45 offen offset:2048 sc1 lds
s_add_u32 m0, s44, 101376
s_nop 0
buffer_load_dwordx4 v8, s[4:7], s46 offen offset:0 sc1 lds
buffer_load_dwordx4 v8, s[4:7], s46 offen offset:1024 sc1 lds
buffer_load_dwordx4 v8, s[4:7], s46 offen offset:2048 sc1 lds
s_add_u32 s45, s45, 24576
s_add_u32 s46, s45, 3072
L_pdone_10:
s_barrier
s_mov_b32 s20, 0
buffer_load_dwordx4 a[160:163], v12, s[4:7], s20 offen offset:0 sc1
buffer_load_dwordx4 a[164:167], v13, s[4:7], s20 offen offset:0 sc1
buffer_load_dwordx4 a[168:171], v12, s[4:7], s20 offen offset:3072 sc1
buffer_load_dwordx4 a[172:175], v13, s[4:7], s20 offen offset:3072 sc1
s_mov_b32 s20, 4096
buffer_load_dwordx4 a[176:179], v12, s[4:7], s20 offen offset:1024 sc1
buffer_load_dwordx4 a[180:183], v13, s[4:7], s20 offen offset:1024 sc1
s_mov_b32 s20, 8192
buffer_load_dwordx4 a[184:187], v12, s[4:7], s20 offen offset:0 sc1
buffer_load_dwordx4 a[188:191], v13, s[4:7], s20 offen offset:0 sc1
buffer_load_dwordx2 v[28:29], v16, s[4:7], 0 offen offset:0 sc1
buffer_load_dwordx2 v[30:31], v16, s[4:7], 0 offen offset:128 sc1
buffer_load_dwordx2 v[32:33], v16, s[4:7], 0 offen offset:1024 sc1
buffer_load_dwordx2 v[34:35], v16, s[4:7], 0 offen offset:1152 sc1
buffer_load_dwordx4 a[192:195], v12, s[4:7], s20 offen offset:2048 sc1
buffer_load_dwordx4 a[196:199], v13, s[4:7], s20 offen offset:2048 sc1
s_mov_b32 s20, 12288
buffer_load_dwordx4 a[200:203], v12, s[4:7], s20 offen offset:1024 sc1
buffer_load_dwordx4 a[204:207], v13, s[4:7], s20 offen offset:1024 sc1
s_waitcnt vmcnt(14)
s_barrier
ds_read_b128 a[224:227], v2 offset:0
ds_read_b128 a[228:231], v2 offset:1024
ds_read_b128 a[232:235], v2 offset:2048
ds_read_b128 a[236:239], v2 offset:3072
ds_read_b128 a[240:243], v2 offset:4096
ds_read_b128 a[244:247], v2 offset:5120
s_waitcnt lgkmcnt(4)
v_mfma_f32_16x16x32_bf16 v[44:47], a[224:227], a[160:163], 0
v_mfma_f32_16x16x32_bf16 v[92:95], a[224:227], a[164:167], 0
ds_read_b128 a[248:251], v2 offset:6144
v_mfma_f32_16x16x32_bf16 v[48:51], a[228:231], a[160:163], 0
v_mfma_f32_16x16x32_bf16 v[96:99], a[228:231], a[164:167], 0
ds_read_b128 a[252:255], v2 offset:7168
s_waitcnt lgkmcnt(4)
v_mfma_f32_16x16x32_bf16 v[52:55], a[232:235], a[160:163], 0
buffer_load_dwordx4 v[140:143], v17, s[4:7], 0 offen offset:0 sc1
v_mfma_f32_16x16x32_bf16 v[100:103], a[232:235], a[164:167], 0
ds_read_b128 a[224:227], v2 offset:8192
v_mfma_f32_16x16x32_bf16 v[56:59], a[236:239], a[160:163], 0
v_mfma_f32_16x16x32_bf16 v[104:107], a[236:239], a[164:167], 0
ds_read_b128 a[228:231], v2 offset:9216
s_waitcnt lgkmcnt(4)
v_mfma_f32_16x16x32_bf16 v[60:63], a[240:243], a[160:163], 0
buffer_load_dwordx4 v[144:147], v17, s[4:7], 0 offen offset:64 sc1
v_mfma_f32_16x16x32_bf16 v[108:111], a[240:243], a[164:167], 0
ds_read_b128 a[232:235], v2 offset:10240
v_mfma_f32_16x16x32_bf16 v[64:67], a[244:247], a[160:163], 0
v_mfma_f32_16x16x32_bf16 v[112:115], a[244:247], a[164:167], 0
ds_read_b128 a[236:239], v2 offset:11264
s_waitcnt lgkmcnt(4)
v_mfma_f32_16x16x32_bf16 v[68:71], a[248:251], a[160:163], 0
v_mfma_f32_16x16x32_bf16 v[116:119], a[248:251], a[164:167], 0
ds_read_b128 a[240:243], v2 offset:12288
v_mfma_f32_16x16x32_bf16 v[72:75], a[252:255], a[160:163], 0
buffer_load_dwordx4 v[148:151], v17, s[4:7], 0 offen offset:128 sc1
v_mfma_f32_16x16x32_bf16 v[120:123], a[252:255], a[164:167], 0
ds_read_b128 a[244:247], v2 offset:13312
s_waitcnt lgkmcnt(4)
v_mfma_f32_16x16x32_bf16 v[76:79], a[224:227], a[160:163], 0
v_mfma_f32_16x16x32_bf16 v[124:127], a[224:227], a[164:167], 0
ds_read_b128 a[248:251], v2 offset:14336
v_mfma_f32_16x16x32_bf16 v[80:83], a[228:231], a[160:163], 0
buffer_load_dwordx4 v[152:155], v17, s[4:7], 0 offen offset:192 sc1
v_mfma_f32_16x16x32_bf16 v[128:131], a[228:231], a[164:167], 0
ds_read_b128 a[252:255], v2 offset:15360
s_waitcnt lgkmcnt(4)
v_mfma_f32_16x16x32_bf16 v[84:87], a[232:235], a[160:163], 0
v_mfma_f32_16x16x32_bf16 v[132:135], a[232:235], a[164:167], 0
ds_read_b128 a[224:227], v2 offset:16384
v_mfma_f32_16x16x32_bf16 v[88:91], a[236:239], a[160:163], 0
v_mfma_f32_16x16x32_bf16 v[136:139], a[236:239], a[164:167], 0
s_waitcnt vmcnt(16)
ds_read_b128 a[228:231], v2 offset:17408
s_waitcnt lgkmcnt(4)
v_mfma_f32_16x16x32_bf16 v[44:47], a[240:243], a[168:171], v[44:47]
buffer_load_dwordx4 v[156:159], v17, s[4:7], 0 offen offset:256 sc1
v_mfma_f32_16x16x32_bf16 v[92:95], a[240:243], a[172:175], v[92:95]
ds_read_b128 a[232:235], v2 offset:18432
v_mfma_f32_16x16x32_bf16 v[48:51], a[244:247], a[168:171], v[48:51]
v_mfma_f32_16x16x32_bf16 v[96:99], a[244:247], a[172:175], v[96:99]
ds_read_b128 a[236:239], v2 offset:19456
s_waitcnt lgkmcnt(4)
v_mfma_f32_16x16x32_bf16 v[52:55], a[248:251], a[168:171], v[52:55]
buffer_load_dwordx4 v[160:163], v17, s[4:7], 0 offen offset:320 sc1
v_mfma_f32_16x16x32_bf16 v[100:103], a[248:251], a[172:175], v[100:103]
ds_read_b128 a[240:243], v2 offset:20480
v_mfma_f32_16x16x32_bf16 v[56:59], a[252:255], a[168:171], v[56:59]
v_mfma_f32_16x16x32_bf16 v[104:107], a[252:255], a[172:175], v[104:107]
ds_read_b128 a[244:247], v2 offset:21504
s_waitcnt lgkmcnt(4)
v_mfma_f32_16x16x32_bf16 v[60:63], a[224:227], a[168:171], v[60:63]
v_mfma_f32_16x16x32_bf16 v[108:111], a[224:227], a[172:175], v[108:111]
ds_read_b128 a[248:251], v2 offset:22528
v_mfma_f32_16x16x32_bf16 v[64:67], a[228:231], a[168:171], v[64:67]
buffer_load_dwordx4 v[164:167], v17, s[4:7], 0 offen offset:384 sc1
v_mfma_f32_16x16x32_bf16 v[112:115], a[228:231], a[172:175], v[112:115]
ds_read_b128 a[252:255], v2 offset:23552
s_waitcnt lgkmcnt(4)
v_mfma_f32_16x16x32_bf16 v[68:71], a[232:235], a[168:171], v[68:71]
v_mfma_f32_16x16x32_bf16 v[116:119], a[232:235], a[172:175], v[116:119]
ds_read_b128 a[224:227], v2 offset:24576
v_mfma_f32_16x16x32_bf16 v[72:75], a[236:239], a[168:171], v[72:75]
buffer_load_dwordx4 v[168:171], v17, s[4:7], 0 offen offset:448 sc1
v_mfma_f32_16x16x32_bf16 v[120:123], a[236:239], a[172:175], v[120:123]
ds_read_b128 a[228:231], v2 offset:25600
s_waitcnt lgkmcnt(4)
v_mfma_f32_16x16x32_bf16 v[76:79], a[240:243], a[168:171], v[76:79]
v_mfma_f32_16x16x32_bf16 v[124:127], a[240:243], a[172:175], v[124:127]
ds_read_b128 a[232:235], v2 offset:26624
v_mfma_f32_16x16x32_bf16 v[80:83], a[244:247], a[168:171], v[80:83]
v_mfma_f32_16x16x32_bf16 v[128:131], a[244:247], a[172:175], v[128:131]
ds_read_b128 a[236:239], v2 offset:27648
s_waitcnt lgkmcnt(4)
v_mfma_f32_16x16x32_bf16 v[84:87], a[248:251], a[168:171], v[84:87]
buffer_load_dwordx4 v[172:175], v17, s[4:7], 0 offen offset:512 sc1
v_mfma_f32_16x16x32_bf16 v[132:135], a[248:251], a[172:175], v[132:135]
ds_read_b128 a[240:243], v2 offset:28672
v_mfma_f32_16x16x32_bf16 v[88:91], a[252:255], a[168:171], v[88:91]
v_mfma_f32_16x16x32_bf16 v[136:139], a[252:255], a[172:175], v[136:139]
s_waitcnt vmcnt(19)
ds_read_b128 a[244:247], v2 offset:29696
s_waitcnt lgkmcnt(4)
v_mfma_f32_16x16x32_bf16 v[44:47], a[224:227], a[176:179], v[44:47]
buffer_load_dwordx4 a[208:211], v12, s[4:7], s20 offen offset:3072 sc1
v_mfma_f32_16x16x32_bf16 v[92:95], a[224:227], a[180:183], v[92:95]
ds_read_b128 a[248:251], v2 offset:30720
v_mfma_f32_16x16x32_bf16 v[48:51], a[228:231], a[176:179], v[48:51]
v_mfma_f32_16x16x32_bf16 v[96:99], a[228:231], a[180:183], v[96:99]
ds_read_b128 a[252:255], v2 offset:31744
s_waitcnt lgkmcnt(4)
v_mfma_f32_16x16x32_bf16 v[52:55], a[232:235], a[176:179], v[52:55]
v_mfma_f32_16x16x32_bf16 v[100:103], a[232:235], a[180:183], v[100:103]
ds_read_b128 a[224:227], v2 offset:32768
v_mfma_f32_16x16x32_bf16 v[56:59], a[236:239], a[176:179], v[56:59]
buffer_load_dwordx4 a[212:215], v13, s[4:7], s20 offen offset:3072 sc1
v_mfma_f32_16x16x32_bf16 v[104:107], a[236:239], a[180:183], v[104:107]
ds_read_b128 a[228:231], v2 offset:33792
s_waitcnt lgkmcnt(4)
v_mfma_f32_16x16x32_bf16 v[60:63], a[240:243], a[176:179], v[60:63]
v_mfma_f32_16x16x32_bf16 v[108:111], a[240:243], a[180:183], v[108:111]
ds_read_b128 a[232:235], v2 offset:34816
v_mfma_f32_16x16x32_bf16 v[64:67], a[244:247], a[176:179], v[64:67]
s_mov_b32 s20, 16384
buffer_load_dwordx4 a[216:219], v12, s[4:7], s20 offen offset:2048 sc1
v_mfma_f32_16x16x32_bf16 v[112:115], a[244:247], a[180:183], v[112:115]
ds_read_b128 a[236:239], v2 offset:35840
s_waitcnt lgkmcnt(4)
v_mfma_f32_16x16x32_bf16 v[68:71], a[248:251], a[176:179], v[68:71]
v_mfma_f32_16x16x32_bf16 v[116:119], a[248:251], a[180:183], v[116:119]
ds_read_b128 a[240:243], v2 offset:36864
v_mfma_f32_16x16x32_bf16 v[72:75], a[252:255], a[176:179], v[72:75]
v_mfma_f32_16x16x32_bf16 v[120:123], a[252:255], a[180:183], v[120:123]
ds_read_b128 a[244:247], v2 offset:37888
s_waitcnt lgkmcnt(4)
v_mfma_f32_16x16x32_bf16 v[76:79], a[224:227], a[176:179], v[76:79]
buffer_load_dwordx4 a[220:223], v13, s[4:7], s20 offen offset:2048 sc1
v_mfma_f32_16x16x32_bf16 v[124:127], a[224:227], a[180:183], v[124:127]
ds_read_b128 a[248:251], v2 offset:38912
v_mfma_f32_16x16x32_bf16 v[80:83], a[228:231], a[176:179], v[80:83]
v_mfma_f32_16x16x32_bf16 v[128:131], a[228:231], a[180:183], v[128:131]
ds_read_b128 a[252:255], v2 offset:39936
s_waitcnt lgkmcnt(4)
v_mfma_f32_16x16x32_bf16 v[84:87], a[232:235], a[176:179], v[84:87]
buffer_load_dwordx4 v[176:179], v17, s[4:7], 0 offen offset:576 sc1
v_mfma_f32_16x16x32_bf16 v[132:135], a[232:235], a[180:183], v[132:135]
ds_read_b128 a[224:227], v2 offset:40960
v_mfma_f32_16x16x32_bf16 v[88:91], a[236:239], a[176:179], v[88:91]
v_mfma_f32_16x16x32_bf16 v[136:139], a[236:239], a[180:183], v[136:139]
s_waitcnt vmcnt(22)
ds_read_b128 a[228:231], v2 offset:41984
s_waitcnt lgkmcnt(4)
v_mfma_f32_16x16x32_bf16 v[44:47], a[240:243], a[184:187], v[44:47]
v_mfma_f32_16x16x32_bf16 v[92:95], a[240:243], a[188:191], v[92:95]
ds_read_b128 a[232:235], v2 offset:43008
v_mfma_f32_16x16x32_bf16 v[48:51], a[244:247], a[184:187], v[48:51]
buffer_load_dwordx4 v[180:183], v17, s[4:7], 0 offen offset:640 sc1
v_mfma_f32_16x16x32_bf16 v[96:99], a[244:247], a[188:191], v[96:99]
ds_read_b128 a[236:239], v2 offset:44032
s_waitcnt lgkmcnt(4)
v_mfma_f32_16x16x32_bf16 v[52:55], a[248:251], a[184:187], v[52:55]
v_mfma_f32_16x16x32_bf16 v[100:103], a[248:251], a[188:191], v[100:103]
ds_read_b128 a[240:243], v2 offset:45056
v_mfma_f32_16x16x32_bf16 v[56:59], a[252:255], a[184:187], v[56:59]
buffer_load_dwordx4 v[184:187], v17, s[4:7], 0 offen offset:704 sc1
v_mfma_f32_16x16x32_bf16 v[104:107], a[252:255], a[188:191], v[104:107]
ds_read_b128 a[244:247], v2 offset:46080
s_waitcnt lgkmcnt(4)
v_mfma_f32_16x16x32_bf16 v[60:63], a[224:227], a[184:187], v[60:63]
v_mfma_f32_16x16x32_bf16 v[108:111], a[224:227], a[188:191], v[108:111]
ds_read_b128 a[248:251], v2 offset:47104
v_mfma_f32_16x16x32_bf16 v[64:67], a[228:231], a[184:187], v[64:67]
v_mfma_f32_16x16x32_bf16 v[112:115], a[228:231], a[188:191], v[112:115]
ds_read_b128 a[252:255], v2 offset:48128
s_waitcnt lgkmcnt(4)
v_mfma_f32_16x16x32_bf16 v[68:71], a[232:235], a[184:187], v[68:71]
s_mov_b32 s58, 30720
buffer_load_dwordx4 a[40:43], v11, s[4:7], s58 offen offset:0 sc1
v_mfma_f32_16x16x32_bf16 v[116:119], a[232:235], a[188:191], v[116:119]
s_barrier
ds_read_b128 a[224:227], v2 offset:49152
v_mfma_f32_16x16x32_bf16 v[72:75], a[236:239], a[184:187], v[72:75]
v_mfma_f32_16x16x32_bf16 v[120:123], a[236:239], a[188:191], v[120:123]
ds_read_b128 a[228:231], v2 offset:50176
s_waitcnt lgkmcnt(4)
v_mfma_f32_16x16x32_bf16 v[76:79], a[240:243], a[184:187], v[76:79]
buffer_load_dwordx4 a[44:47], v11, s[4:7], s58 offen offset:1024 sc1
v_mfma_f32_16x16x32_bf16 v[124:127], a[240:243], a[188:191], v[124:127]
ds_read_b128 a[232:235], v2 offset:51200
v_mfma_f32_16x16x32_bf16 v[80:83], a[244:247], a[184:187], v[80:83]
v_mfma_f32_16x16x32_bf16 v[128:131], a[244:247], a[188:191], v[128:131]
ds_read_b128 a[236:239], v2 offset:52224
s_waitcnt lgkmcnt(4)
v_mfma_f32_16x16x32_bf16 v[84:87], a[248:251], a[184:187], v[84:87]
v_mfma_f32_16x16x32_bf16 v[132:135], a[248:251], a[188:191], v[132:135]
ds_read_b128 a[240:243], v2 offset:53248
v_mfma_f32_16x16x32_bf16 v[88:91], a[252:255], a[184:187], v[88:91]
buffer_load_dwordx4 a[48:51], v11, s[4:7], s58 offen offset:2048 sc1
v_mfma_f32_16x16x32_bf16 v[136:139], a[252:255], a[188:191], v[136:139]
s_waitcnt vmcnt(21)
ds_read_b128 a[244:247], v2 offset:54272
s_waitcnt lgkmcnt(4)
v_mfma_f32_16x16x32_bf16 v[44:47], a[224:227], a[192:195], v[44:47]
v_mfma_f32_16x16x32_bf16 v[92:95], a[224:227], a[196:199], v[92:95]
ds_read_b128 a[248:251], v2 offset:55296
v_mfma_f32_16x16x32_bf16 v[48:51], a[228:231], a[192:195], v[48:51]
s_mov_b32 s20, 0
buffer_load_dwordx4 a[160:163], v12, s[4:7], s20 offen offset:1024 sc1
v_mfma_f32_16x16x32_bf16 v[96:99], a[228:231], a[196:199], v[96:99]
ds_read_b128 a[252:255], v2 offset:56320
s_waitcnt lgkmcnt(4)
v_mfma_f32_16x16x32_bf16 v[52:55], a[232:235], a[192:195], v[52:55]
v_mfma_f32_16x16x32_bf16 v[100:103], a[232:235], a[196:199], v[100:103]
ds_read_b128 a[224:227], v2 offset:57344
v_mfma_f32_16x16x32_bf16 v[56:59], a[236:239], a[192:195], v[56:59]
v_mfma_f32_16x16x32_bf16 v[104:107], a[236:239], a[196:199], v[104:107]
ds_read_b128 a[228:231], v2 offset:58368
s_waitcnt lgkmcnt(4)
v_mfma_f32_16x16x32_bf16 v[60:63], a[240:243], a[192:195], v[60:63]
buffer_load_dwordx4 a[164:167], v13, s[4:7], s20 offen offset:1024 sc1
v_mfma_f32_16x16x32_bf16 v[108:111], a[240:243], a[196:199], v[108:111]
ds_read_b128 a[232:235], v2 offset:59392
v_mfma_f32_16x16x32_bf16 v[64:67], a[244:247], a[192:195], v[64:67]
v_mfma_f32_16x16x32_bf16 v[112:115], a[244:247], a[196:199], v[112:115]
ds_read_b128 a[236:239], v2 offset:60416
s_waitcnt lgkmcnt(4)
v_mfma_f32_16x16x32_bf16 v[68:71], a[248:251], a[192:195], v[68:71]
buffer_load_dwordx4 a[168:171], v12, s[4:7], s20 offen offset:2048 sc1
v_mfma_f32_16x16x32_bf16 v[116:119], a[248:251], a[196:199], v[116:119]
ds_read_b128 a[240:243], v2 offset:61440
v_mfma_f32_16x16x32_bf16 v[72:75], a[252:255], a[192:195], v[72:75]
v_mfma_f32_16x16x32_bf16 v[120:123], a[252:255], a[196:199], v[120:123]
ds_read_b128 a[244:247], v2 offset:62464
s_waitcnt lgkmcnt(4)
v_mfma_f32_16x16x32_bf16 v[76:79], a[224:227], a[192:195], v[76:79]
v_mfma_f32_16x16x32_bf16 v[124:127], a[224:227], a[196:199], v[124:127]
ds_read_b128 a[248:251], v2 offset:63488
v_mfma_f32_16x16x32_bf16 v[80:83], a[228:231], a[192:195], v[80:83]
buffer_load_dwordx4 a[172:175], v13, s[4:7], s20 offen offset:2048 sc1
v_mfma_f32_16x16x32_bf16 v[128:131], a[228:231], a[196:199], v[128:131]
ds_read_b128 a[252:255], v2 offset:64512
s_waitcnt lgkmcnt(4)
v_mfma_f32_16x16x32_bf16 v[84:87], a[232:235], a[192:195], v[84:87]
v_mfma_f32_16x16x32_bf16 v[132:135], a[232:235], a[196:199], v[132:135]
ds_read_b128 a[224:227], v14 offset:0
v_mfma_f32_16x16x32_bf16 v[88:91], a[236:239], a[192:195], v[88:91]
s_add_u32 m0, s44, 122880
s_nop 0
buffer_load_dwordx4 v8, s[4:7], s45 offen offset:0 sc1 lds
v_mfma_f32_16x16x32_bf16 v[136:139], a[236:239], a[196:199], v[136:139]
s_waitcnt vmcnt(24)
ds_read_b128 a[228:231], v14 offset:1024
s_waitcnt lgkmcnt(4)
v_mfma_f32_16x16x32_bf16 v[44:47], a[240:243], a[200:203], v[44:47]
v_mfma_f32_16x16x32_bf16 v[92:95], a[240:243], a[204:207], v[92:95]
ds_read_b128 a[232:235], v14 offset:2048
v_mfma_f32_16x16x32_bf16 v[48:51], a[244:247], a[200:203], v[48:51]
v_mfma_f32_16x16x32_bf16 v[96:99], a[244:247], a[204:207], v[96:99]
ds_read_b128 a[236:239], v14 offset:3072
s_waitcnt lgkmcnt(4)
v_mfma_f32_16x16x32_bf16 v[52:55], a[248:251], a[200:203], v[52:55]
buffer_load_dwordx4 v8, s[4:7], s45 offen offset:1024 sc1 lds
v_mfma_f32_16x16x32_bf16 v[100:103], a[248:251], a[204:207], v[100:103]
ds_read_b128 a[240:243], v14 offset:4096
v_mfma_f32_16x16x32_bf16 v[56:59], a[252:255], a[200:203], v[56:59]
v_mfma_f32_16x16x32_bf16 v[104:107], a[252:255], a[204:207], v[104:107]
ds_read_b128 a[244:247], v14 offset:5120
s_waitcnt lgkmcnt(4)
v_mfma_f32_16x16x32_bf16 v[60:63], a[224:227], a[200:203], v[60:63]
buffer_load_dwordx4 v8, s[4:7], s45 offen offset:2048 sc1 lds
v_mfma_f32_16x16x32_bf16 v[108:111], a[224:227], a[204:207], v[108:111]
ds_read_b128 a[248:251], v14 offset:6144
v_mfma_f32_16x16x32_bf16 v[64:67], a[228:231], a[200:203], v[64:67]
v_mfma_f32_16x16x32_bf16 v[112:115], a[228:231], a[204:207], v[112:115]
ds_read_b128 a[252:255], v14 offset:7168
s_waitcnt lgkmcnt(4)
v_mfma_f32_16x16x32_bf16 v[68:71], a[232:235], a[200:203], v[68:71]
v_mfma_f32_16x16x32_bf16 v[116:119], a[232:235], a[204:207], v[116:119]
s_barrier
ds_read_b128 a[224:227], v14 offset:8192
v_mfma_f32_16x16x32_bf16 v[72:75], a[236:239], a[200:203], v[72:75]
s_add_u32 m0, s44, 125952
s_nop 0
buffer_load_dwordx4 v8, s[4:7], s46 offen offset:0 sc1 lds
v_mfma_f32_16x16x32_bf16 v[120:123], a[236:239], a[204:207], v[120:123]
ds_read_b128 a[228:231], v14 offset:9216
s_waitcnt lgkmcnt(4)
v_mfma_f32_16x16x32_bf16 v[76:79], a[240:243], a[200:203], v[76:79]
v_mfma_f32_16x16x32_bf16 v[124:127], a[240:243], a[204:207], v[124:127]
ds_read_b128 a[232:235], v14 offset:10240
v_mfma_f32_16x16x32_bf16 v[80:83], a[244:247], a[200:203], v[80:83]
buffer_load_dwordx4 v8, s[4:7], s46 offen offset:1024 sc1 lds
v_mfma_f32_16x16x32_bf16 v[128:131], a[244:247], a[204:207], v[128:131]
ds_read_b128 a[236:239], v14 offset:11264
s_waitcnt lgkmcnt(4)
v_mfma_f32_16x16x32_bf16 v[84:87], a[248:251], a[200:203], v[84:87]
v_mfma_f32_16x16x32_bf16 v[132:135], a[248:251], a[204:207], v[132:135]
ds_read_b128 a[240:243], v14 offset:12288
v_mfma_f32_16x16x32_bf16 v[88:91], a[252:255], a[200:203], v[88:91]
v_mfma_f32_16x16x32_bf16 v[136:139], a[252:255], a[204:207], v[136:139]
s_waitcnt vmcnt(17)
ds_read_b128 a[244:247], v14 offset:13312
s_waitcnt lgkmcnt(4)
v_mfma_f32_16x16x32_bf16 v[44:47], a[224:227], a[208:211], v[44:47]
buffer_load_dwordx4 v8, s[4:7], s46 offen offset:2048 sc1 lds
s_add_u32 s45, s45, 24576
s_add_u32 s46, s45, 3072
v_mfma_f32_16x16x32_bf16 v[92:95], a[224:227], a[212:215], v[92:95]
ds_read_b128 a[248:251], v14 offset:14336
v_mfma_f32_16x16x32_bf16 v[48:51], a[228:231], a[208:211], v[48:51]
v_mfma_f32_16x16x32_bf16 v[96:99], a[228:231], a[212:215], v[96:99]
ds_read_b128 a[252:255], v14 offset:15360
s_waitcnt lgkmcnt(4)
v_mfma_f32_16x16x32_bf16 v[52:55], a[232:235], a[208:211], v[52:55]
s_mov_b32 s20, 4096
buffer_load_dwordx4 a[176:179], v12, s[4:7], s20 offen offset:0 sc1
v_mfma_f32_16x16x32_bf16 v[100:103], a[232:235], a[212:215], v[100:103]
ds_read_b128 a[224:227], v14 offset:16384
v_mfma_f32_16x16x32_bf16 v[56:59], a[236:239], a[208:211], v[56:59]
v_mfma_f32_16x16x32_bf16 v[104:107], a[236:239], a[212:215], v[104:107]
ds_read_b128 a[228:231], v14 offset:17408
s_waitcnt lgkmcnt(4)
v_mfma_f32_16x16x32_bf16 v[60:63], a[240:243], a[208:211], v[60:63]
v_mfma_f32_16x16x32_bf16 v[108:111], a[240:243], a[212:215], v[108:111]
ds_read_b128 a[232:235], v14 offset:18432
v_mfma_f32_16x16x32_bf16 v[64:67], a[244:247], a[208:211], v[64:67]
buffer_load_dwordx4 a[180:183], v13, s[4:7], s20 offen offset:0 sc1
v_mfma_f32_16x16x32_bf16 v[112:115], a[244:247], a[212:215], v[112:115]
ds_read_b128 a[236:239], v14 offset:19456
s_waitcnt lgkmcnt(4)
v_mfma_f32_16x16x32_bf16 v[68:71], a[248:251], a[208:211], v[68:71]
v_mfma_f32_16x16x32_bf16 v[116:119], a[248:251], a[212:215], v[116:119]
ds_read_b128 a[240:243], v14 offset:20480
v_mfma_f32_16x16x32_bf16 v[72:75], a[252:255], a[208:211], v[72:75]
buffer_load_dwordx4 a[184:187], v12, s[4:7], s20 offen offset:2048 sc1
v_mfma_f32_16x16x32_bf16 v[120:123], a[252:255], a[212:215], v[120:123]
ds_read_b128 a[244:247], v14 offset:21504
s_waitcnt lgkmcnt(4)
v_mfma_f32_16x16x32_bf16 v[76:79], a[224:227], a[208:211], v[76:79]
v_mfma_f32_16x16x32_bf16 v[124:127], a[224:227], a[212:215], v[124:127]
ds_read_b128 a[248:251], v14 offset:22528
v_mfma_f32_16x16x32_bf16 v[80:83], a[228:231], a[208:211], v[80:83]
v_mfma_f32_16x16x32_bf16 v[128:131], a[228:231], a[212:215], v[128:131]
ds_read_b128 a[252:255], v14 offset:23552
s_waitcnt lgkmcnt(4)
v_mfma_f32_16x16x32_bf16 v[84:87], a[232:235], a[208:211], v[84:87]
buffer_load_dwordx4 a[188:191], v13, s[4:7], s20 offen offset:2048 sc1
v_mfma_f32_16x16x32_bf16 v[132:135], a[232:235], a[212:215], v[132:135]
ds_read_b128 a[224:227], v14 offset:24576
v_mfma_f32_16x16x32_bf16 v[88:91], a[236:239], a[208:211], v[88:91]
v_mfma_f32_16x16x32_bf16 v[136:139], a[236:239], a[212:215], v[136:139]
s_waitcnt vmcnt(20)
ds_read_b128 a[228:231], v14 offset:25600
s_waitcnt lgkmcnt(4)
v_mfma_f32_16x16x32_bf16 v[44:47], a[240:243], a[216:219], v[44:47]
s_add_u32 m0, s44, 0
s_nop 0
buffer_load_dwordx4 v8, s[4:7], s45 offen offset:0 sc1 lds
v_mfma_f32_16x16x32_bf16 v[92:95], a[240:243], a[220:223], v[92:95]
ds_read_b128 a[232:235], v14 offset:26624
v_mfma_f32_16x16x32_bf16 v[48:51], a[244:247], a[216:219], v[48:51]
v_mfma_f32_16x16x32_bf16 v[96:99], a[244:247], a[220:223], v[96:99]
ds_read_b128 a[236:239], v14 offset:27648
s_waitcnt lgkmcnt(4)
v_mfma_f32_16x16x32_bf16 v[52:55], a[248:251], a[216:219], v[52:55]
v_mfma_f32_16x16x32_bf16 v[100:103], a[248:251], a[220:223], v[100:103]
ds_read_b128 a[240:243], v14 offset:28672
v_mfma_f32_16x16x32_bf16 v[56:59], a[252:255], a[216:219], v[56:59]
buffer_load_dwordx4 v8, s[4:7], s45 offen offset:1024 sc1 lds
v_mfma_f32_16x16x32_bf16 v[104:107], a[252:255], a[220:223], v[104:107]
ds_read_b128 a[244:247], v14 offset:29696
s_waitcnt lgkmcnt(4)
v_mfma_f32_16x16x32_bf16 v[60:63], a[224:227], a[216:219], v[60:63]
v_mfma_f32_16x16x32_bf16 v[108:111], a[224:227], a[220:223], v[108:111]
ds_read_b128 a[248:251], v14 offset:30720
v_mfma_f32_16x16x32_bf16 v[64:67], a[228:231], a[216:219], v[64:67]
buffer_load_dwordx4 v8, s[4:7], s45 offen offset:2048 sc1 lds
v_mfma_f32_16x16x32_bf16 v[112:115], a[228:231], a[220:223], v[112:115]
ds_read_b128 a[252:255], v14 offset:31744
s_waitcnt lgkmcnt(4)
v_mfma_f32_16x16x32_bf16 v[68:71], a[232:235], a[216:219], v[68:71]
v_mfma_f32_16x16x32_bf16 v[116:119], a[232:235], a[220:223], v[116:119]
s_barrier
ds_read_b128 a[224:227], v14 offset:32768
v_mfma_f32_16x16x32_bf16 v[72:75], a[236:239], a[216:219], v[72:75]
v_mfma_f32_16x16x32_bf16 v[120:123], a[236:239], a[220:223], v[120:123]
ds_read_b128 a[228:231], v14 offset:33792
s_waitcnt lgkmcnt(4)
v_mfma_f32_16x16x32_bf16 v[76:79], a[240:243], a[216:219], v[76:79]
s_add_u32 m0, s44, 3072
s_nop 0
buffer_load_dwordx4 v8, s[4:7], s46 offen offset:0 sc1 lds
v_mfma_f32_16x16x32_bf16 v[124:127], a[240:243], a[220:223], v[124:127]
ds_read_b128 a[232:235], v14 offset:34816
v_mfma_f32_16x16x32_bf16 v[80:83], a[244:247], a[216:219], v[80:83]
v_mfma_f32_16x16x32_bf16 v[128:131], a[244:247], a[220:223], v[128:131]
ds_read_b128 a[236:239], v14 offset:35840
s_waitcnt lgkmcnt(4)
v_mfma_f32_16x16x32_bf16 v[84:87], a[248:251], a[216:219], v[84:87]
buffer_load_dwordx4 v8, s[4:7], s46 offen offset:1024 sc1 lds
v_mfma_f32_16x16x32_bf16 v[132:135], a[248:251], a[220:223], v[132:135]
ds_read_b128 a[240:243], v14 offset:36864
v_mfma_f32_16x16x32_bf16 v[88:91], a[252:255], a[216:219], v[88:91]
v_mfma_f32_16x16x32_bf16 v[136:139], a[252:255], a[220:223], v[136:139]
s_waitcnt vmcnt(17)
ds_read_b128 a[244:247], v14 offset:37888
s_waitcnt lgkmcnt(4)
v_mfma_f32_16x16x32_bf16 v[44:47], a[224:227], a[160:163], v[44:47]
v_mfma_f32_16x16x32_bf16 v[92:95], a[224:227], a[164:167], v[92:95]
ds_read_b128 a[248:251], v14 offset:38912
v_mfma_f32_16x16x32_bf16 v[48:51], a[228:231], a[160:163], v[48:51]
buffer_load_dwordx4 v8, s[4:7], s46 offen offset:2048 sc1 lds
s_add_u32 s45, s45, 24576
s_add_u32 s46, s45, 3072
v_mfma_f32_16x16x32_bf16 v[96:99], a[228:231], a[164:167], v[96:99]
ds_read_b128 a[252:255], v14 offset:39936
s_waitcnt lgkmcnt(4)
v_mfma_f32_16x16x32_bf16 v[52:55], a[232:235], a[160:163], v[52:55]
v_add_f32 v28, v28, v30
v_mfma_f32_16x16x32_bf16 v[100:103], a[232:235], a[164:167], v[100:103]
ds_read_b128 a[224:227], v14 offset:40960
v_mfma_f32_16x16x32_bf16 v[56:59], a[236:239], a[160:163], v[56:59]
buffer_load_dwordx4 a[192:195], v12, s[4:7], s20 offen offset:3072 sc1
v_mfma_f32_16x16x32_bf16 v[104:107], a[236:239], a[164:167], v[104:107]
ds_read_b128 a[228:231], v14 offset:41984
s_waitcnt lgkmcnt(4)
v_mfma_f32_16x16x32_bf16 v[60:63], a[240:243], a[160:163], v[60:63]
v_add_f32 v29, v29, v31
v_mov_b32 v36, v28
v_mfma_f32_16x16x32_bf16 v[108:111], a[240:243], a[164:167], v[108:111]
ds_read_b128 a[232:235], v14 offset:43008
v_mfma_f32_16x16x32_bf16 v[64:67], a[244:247], a[160:163], v[64:67]
v_permlane16_swap_b32 v28, v36
v_add_f32 v28, v28, v36
v_mfma_f32_16x16x32_bf16 v[112:115], a[244:247], a[164:167], v[112:115]
ds_read_b128 a[236:239], v14 offset:44032
s_waitcnt lgkmcnt(4)
v_mfma_f32_16x16x32_bf16 v[68:71], a[248:251], a[160:163], v[68:71]
buffer_load_dwordx4 a[196:199], v13, s[4:7], s20 offen offset:3072 sc1
v_mfma_f32_16x16x32_bf16 v[116:119], a[248:251], a[164:167], v[116:119]
ds_read_b128 a[240:243], v14 offset:45056
v_mfma_f32_16x16x32_bf16 v[72:75], a[252:255], a[160:163], v[72:75]
v_mov_b32 v36, v28
s_nop 1
v_permlane32_swap_b32 v28, v36
v_mfma_f32_16x16x32_bf16 v[120:123], a[252:255], a[164:167], v[120:123]
ds_read_b128 a[244:247], v14 offset:46080
s_waitcnt lgkmcnt(4)
v_mfma_f32_16x16x32_bf16 v[76:79], a[224:227], a[160:163], v[76:79]
s_mov_b32 s20, 8192
buffer_load_dwordx4 a[200:203], v12, s[4:7], s20 offen offset:1024 sc1
v_mfma_f32_16x16x32_bf16 v[124:127], a[224:227], a[164:167], v[124:127]
ds_read_b128 a[248:251], v14 offset:47104
v_mfma_f32_16x16x32_bf16 v[80:83], a[228:231], a[160:163], v[80:83]
v_add_f32 v28, v28, v36
v_mov_b32 v36, v29
v_mfma_f32_16x16x32_bf16 v[128:131], a[228:231], a[164:167], v[128:131]
ds_read_b128 a[252:255], v14 offset:48128
s_waitcnt lgkmcnt(4)
v_mfma_f32_16x16x32_bf16 v[84:87], a[232:235], a[160:163], v[84:87]
v_permlane16_swap_b32 v29, v36
v_add_f32 v29, v29, v36
v_mfma_f32_16x16x32_bf16 v[132:135], a[232:235], a[164:167], v[132:135]
ds_read_b128 a[224:227], v14 offset:49152
v_mfma_f32_16x16x32_bf16 v[88:91], a[236:239], a[160:163], v[88:91]
buffer_load_dwordx4 a[204:207], v13, s[4:7], s20 offen offset:1024 sc1
v_mfma_f32_16x16x32_bf16 v[136:139], a[236:239], a[164:167], v[136:139]
s_waitcnt vmcnt(20)
ds_read_b128 a[228:231], v14 offset:50176
s_waitcnt lgkmcnt(4)
v_mfma_f32_16x16x32_bf16 v[44:47], a[240:243], a[168:171], v[44:47]
v_mov_b32 v36, v29
s_nop 1
v_permlane32_swap_b32 v29, v36
v_mfma_f32_16x16x32_bf16 v[92:95], a[240:243], a[172:175], v[92:95]
ds_read_b128 a[232:235], v14 offset:51200
v_mfma_f32_16x16x32_bf16 v[48:51], a[244:247], a[168:171], v[48:51]
s_add_u32 m0, s44, 24576
s_nop 0
buffer_load_dwordx4 v8, s[4:7], s45 offen offset:0 sc1 lds
v_mfma_f32_16x16x32_bf16 v[96:99], a[244:247], a[172:175], v[96:99]
ds_read_b128 a[236:239], v14 offset:52224
s_waitcnt lgkmcnt(4)
v_mfma_f32_16x16x32_bf16 v[52:55], a[248:251], a[168:171], v[52:55]
v_add_f32 v29, v29, v36
v_mul_f32 v19, 0x3acccccd, v28
v_mfma_f32_16x16x32_bf16 v[100:103], a[248:251], a[172:175], v[100:103]
ds_read_b128 a[240:243], v14 offset:53248
v_mfma_f32_16x16x32_bf16 v[56:59], a[252:255], a[168:171], v[56:59]
v_mul_f32 v29, 0x3acccccd, v29
v_fma_f32 v29, -v19, v19, v29
v_mfma_f32_16x16x32_bf16 v[104:107], a[252:255], a[172:175], v[104:107]
ds_read_b128 a[244:247], v14 offset:54272
s_waitcnt lgkmcnt(4)
v_mfma_f32_16x16x32_bf16 v[60:63], a[224:227], a[168:171], v[60:63]
buffer_load_dwordx4 v8, s[4:7], s45 offen offset:1024 sc1 lds
v_mfma_f32_16x16x32_bf16 v[108:111], a[224:227], a[172:175], v[108:111]
ds_read_b128 a[248:251], v14 offset:55296
v_mfma_f32_16x16x32_bf16 v[64:67], a[228:231], a[168:171], v[64:67]
v_max_f32 v29, 0, v29
v_add_f32 v29, 0x3727c5ac, v29
v_mfma_f32_16x16x32_bf16 v[112:115], a[228:231], a[172:175], v[112:115]
ds_read_b128 a[252:255], v14 offset:56320
s_waitcnt lgkmcnt(4)
v_mfma_f32_16x16x32_bf16 v[68:71], a[232:235], a[168:171], v[68:71]
buffer_load_dwordx4 v8, s[4:7], s45 offen offset:2048 sc1 lds
v_mfma_f32_16x16x32_bf16 v[116:119], a[232:235], a[172:175], v[116:119]
s_waitcnt vmcnt(17)
s_barrier
ds_read_b128 a[224:227], v14 offset:57344
v_mfma_f32_16x16x32_bf16 v[72:75], a[236:239], a[168:171], v[72:75]
v_rsq_f32 v21, v29
s_nop 0
v_mul_f32 v23, v21, v21
v_mfma_f32_16x16x32_bf16 v[120:123], a[236:239], a[172:175], v[120:123]
ds_read_b128 a[228:231], v14 offset:58368
s_waitcnt lgkmcnt(4)
v_mfma_f32_16x16x32_bf16 v[76:79], a[240:243], a[168:171], v[76:79]
v_mul_f32 v25, v43, v21
v_mul_f32 v21, v23, v21
v_mfma_f32_16x16x32_bf16 v[124:127], a[240:243], a[172:175], v[124:127]
ds_read_b128 a[232:235], v14 offset:59392
v_mfma_f32_16x16x32_bf16 v[80:83], a[244:247], a[168:171], v[80:83]
s_add_u32 m0, s44, 27648
s_nop 0
buffer_load_dwordx4 v8, s[4:7], s46 offen offset:0 sc1 lds
v_mfma_f32_16x16x32_bf16 v[128:131], a[244:247], a[172:175], v[128:131]
ds_read_b128 a[236:239], v14 offset:60416
s_waitcnt lgkmcnt(4)
v_mfma_f32_16x16x32_bf16 v[84:87], a[248:251], a[168:171], v[84:87]
v_rcp_f32 v23, v23
v_mul_f32 v21, s24, v21
v_mfma_f32_16x16x32_bf16 v[132:135], a[248:251], a[172:175], v[132:135]
ds_read_b128 a[240:243], v14 offset:61440
v_mfma_f32_16x16x32_bf16 v[88:91], a[252:255], a[168:171], v[88:91]
buffer_load_dwordx4 v8, s[4:7], s46 offen offset:1024 sc1 lds
v_mfma_f32_16x16x32_bf16 v[136:139], a[252:255], a[172:175], v[136:139]
s_waitcnt vmcnt(17)
ds_read_b128 a[244:247], v14 offset:62464
s_waitcnt lgkmcnt(4)
v_mfma_f32_16x16x32_bf16 v[44:47], a[224:227], a[176:179], v[44:47]
v_add_f32 v32, v32, v34
v_add_f32 v33, v33, v35
v_mfma_f32_16x16x32_bf16 v[92:95], a[224:227], a[180:183], v[92:95]
ds_read_b128 a[248:251], v14 offset:63488
v_mfma_f32_16x16x32_bf16 v[48:51], a[228:231], a[176:179], v[48:51]
v_mov_b32 v36, v32
s_nop 1
v_permlane16_swap_b32 v32, v36
v_mfma_f32_16x16x32_bf16 v[96:99], a[228:231], a[180:183], v[96:99]
ds_read_b128 a[252:255], v14 offset:64512
s_waitcnt lgkmcnt(4)
v_mfma_f32_16x16x32_bf16 v[52:55], a[232:235], a[176:179], v[52:55]
buffer_load_dwordx4 v8, s[4:7], s46 offen offset:2048 sc1 lds
s_add_u32 s45, s45, 24576
s_add_u32 s46, s45, 3072
v_mfma_f32_16x16x32_bf16 v[100:103], a[232:235], a[180:183], v[100:103]
ds_read_b128 a[224:227], v15 offset:0
v_mfma_f32_16x16x32_bf16 v[56:59], a[236:239], a[176:179], v[56:59]
v_add_f32 v32, v32, v36
v_mov_b32 v36, v32
v_mfma_f32_16x16x32_bf16 v[104:107], a[236:239], a[180:183], v[104:107]
ds_read_b128 a[228:231], v15 offset:1024
s_waitcnt lgkmcnt(4)
v_mfma_f32_16x16x32_bf16 v[60:63], a[240:243], a[176:179], v[60:63]
buffer_load_dwordx4 a[208:211], v12, s[4:7], s20 offen offset:3072 sc1
v_mfma_f32_16x16x32_bf16 v[108:111], a[240:243], a[180:183], v[108:111]
ds_read_b128 a[232:235], v15 offset:2048
v_mfma_f32_16x16x32_bf16 v[64:67], a[244:247], a[176:179], v[64:67]
v_permlane32_swap_b32 v32, v36
v_add_f32 v32, v32, v36
v_mfma_f32_16x16x32_bf16 v[112:115], a[244:247], a[180:183], v[112:115]
ds_read_b128 a[236:239], v15 offset:3072
s_waitcnt lgkmcnt(4)
v_mfma_f32_16x16x32_bf16 v[68:71], a[248:251], a[176:179], v[68:71]
v_mov_b32 v36, v33
s_nop 1
v_permlane16_swap_b32 v33, v36
v_mfma_f32_16x16x32_bf16 v[116:119], a[248:251], a[180:183], v[116:119]
ds_read_b128 a[240:243], v15 offset:4096
v_mfma_f32_16x16x32_bf16 v[72:75], a[252:255], a[176:179], v[72:75]
buffer_load_dwordx4 a[212:215], v13, s[4:7], s20 offen offset:3072 sc1
v_mfma_f32_16x16x32_bf16 v[120:123], a[252:255], a[180:183], v[120:123]
ds_read_b128 a[244:247], v15 offset:5120
s_waitcnt lgkmcnt(4)
v_mfma_f32_16x16x32_bf16 v[76:79], a[224:227], a[176:179], v[76:79]
v_add_f32 v33, v33, v36
v_mov_b32 v36, v33
v_mfma_f32_16x16x32_bf16 v[124:127], a[224:227], a[180:183], v[124:127]
ds_read_b128 a[248:251], v15 offset:6144
v_mfma_f32_16x16x32_bf16 v[80:83], a[228:231], a[176:179], v[80:83]
s_mov_b32 s20, 12288
buffer_load_dwordx4 a[216:219], v12, s[4:7], s20 offen offset:0 sc1
v_mfma_f32_16x16x32_bf16 v[128:131], a[228:231], a[180:183], v[128:131]
ds_read_b128 a[252:255], v15 offset:7168
s_waitcnt lgkmcnt(4)
v_mfma_f32_16x16x32_bf16 v[84:87], a[232:235], a[176:179], v[84:87]
v_permlane32_swap_b32 v33, v36
v_add_f32 v33, v33, v36
v_mfma_f32_16x16x32_bf16 v[132:135], a[232:235], a[180:183], v[132:135]
ds_read_b128 a[224:227], v15 offset:8192
v_mfma_f32_16x16x32_bf16 v[88:91], a[236:239], a[176:179], v[88:91]
v_mul_f32 v20, 0x3acccccd, v32
v_mul_f32 v33, 0x3acccccd, v33
v_mfma_f32_16x16x32_bf16 v[136:139], a[236:239], a[180:183], v[136:139]
s_waitcnt vmcnt(19)
ds_read_b128 a[228:231], v15 offset:9216
s_waitcnt lgkmcnt(4)
v_mfma_f32_16x16x32_bf16 v[44:47], a[240:243], a[184:187], v[44:47]
buffer_load_dwordx4 a[220:223], v13, s[4:7], s20 offen offset:0 sc1
v_mfma_f32_16x16x32_bf16 v[92:95], a[240:243], a[188:191], v[92:95]
ds_read_b128 a[232:235], v15 offset:10240
v_mfma_f32_16x16x32_bf16 v[48:51], a[244:247], a[184:187], v[48:51]
v_fma_f32 v33, -v20, v20, v33
v_max_f32 v33, 0, v33
v_mfma_f32_16x16x32_bf16 v[96:99], a[244:247], a[188:191], v[96:99]
ds_read_b128 a[236:239], v15 offset:11264
s_waitcnt lgkmcnt(4)
v_mfma_f32_16x16x32_bf16 v[52:55], a[248:251], a[184:187], v[52:55]
s_add_u32 m0, s44, 49152
s_nop 0
buffer_load_dwordx4 v8, s[4:7], s45 offen offset:0 sc1 lds
v_mfma_f32_16x16x32_bf16 v[100:103], a[248:251], a[188:191], v[100:103]
ds_read_b128 a[240:243], v15 offset:12288
v_mfma_f32_16x16x32_bf16 v[56:59], a[252:255], a[184:187], v[56:59]
v_add_f32 v33, 0x3727c5ac, v33
v_rsq_f32 v22, v33
v_mfma_f32_16x16x32_bf16 v[104:107], a[252:255], a[188:191], v[104:107]
ds_read_b128 a[244:247], v15 offset:13312
s_waitcnt lgkmcnt(4)
v_mfma_f32_16x16x32_bf16 v[60:63], a[224:227], a[184:187], v[60:63]
v_mul_f32 v24, v22, v22
v_mul_f32 v26, v43, v22
v_mfma_f32_16x16x32_bf16 v[108:111], a[224:227], a[188:191], v[108:111]
ds_read_b128 a[248:251], v15 offset:14336
v_mfma_f32_16x16x32_bf16 v[64:67], a[228:231], a[184:187], v[64:67]
buffer_load_dwordx4 v8, s[4:7], s45 offen offset:1024 sc1 lds
v_mfma_f32_16x16x32_bf16 v[112:115], a[228:231], a[188:191], v[112:115]
ds_read_b128 a[252:255], v15 offset:15360
s_waitcnt lgkmcnt(4)
v_mfma_f32_16x16x32_bf16 v[68:71], a[232:235], a[184:187], v[68:71]
v_mul_f32 v22, v24, v22
v_rcp_f32 v24, v24
v_mfma_f32_16x16x32_bf16 v[116:119], a[232:235], a[188:191], v[116:119]
s_waitcnt vmcnt(16)
s_barrier
ds_read_b128 a[224:227], v2 offset:0
v_mfma_f32_16x16x32_bf16 v[72:75], a[236:239], a[184:187], v[72:75]
buffer_load_dwordx4 v8, s[4:7], s45 offen offset:2048 sc1 lds
v_mfma_f32_16x16x32_bf16 v[120:123], a[236:239], a[188:191], v[120:123]
ds_read_b128 a[228:231], v2 offset:1024
s_waitcnt lgkmcnt(4)
v_mfma_f32_16x16x32_bf16 v[76:79], a[240:243], a[184:187], v[76:79]
v_mul_f32 v22, s24, v22
s_lshl_b32 s16, s13, 2
v_mfma_f32_16x16x32_bf16 v[124:127], a[240:243], a[188:191], v[124:127]
ds_read_b128 a[232:235], v2 offset:2048
v_mfma_f32_16x16x32_bf16 v[80:83], a[244:247], a[184:187], v[80:83]
s_mul_i32 s16, s16, 49152
s_mul_i32 s19, s10, 12288
v_mfma_f32_16x16x32_bf16 v[128:131], a[244:247], a[188:191], v[128:131]
ds_read_b128 a[236:239], v2 offset:3072
s_waitcnt lgkmcnt(4)
v_mfma_f32_16x16x32_bf16 v[84:87], a[248:251], a[184:187], v[84:87]
s_add_u32 m0, s44, 52224
s_nop 0
buffer_load_dwordx4 v8, s[4:7], s46 offen offset:0 sc1 lds
v_mfma_f32_16x16x32_bf16 v[132:135], a[248:251], a[188:191], v[132:135]
ds_read_b128 a[240:243], v2 offset:4096
v_mfma_f32_16x16x32_bf16 v[88:91], a[252:255], a[184:187], v[88:91]
s_add_u32 s16, s16, s19
s_add_u32 s16, s16, s15
v_mfma_f32_16x16x32_bf16 v[136:139], a[252:255], a[188:191], v[136:139]
s_waitcnt vmcnt(16)
ds_read_b128 a[244:247], v2 offset:5120
s_waitcnt lgkmcnt(4)
v_mfma_f32_16x16x32_bf16 v[44:47], a[224:227], a[192:195], v[44:47]
buffer_load_dwordx4 v8, s[4:7], s46 offen offset:1024 sc1 lds
v_mfma_f32_16x16x32_bf16 v[92:95], a[224:227], a[196:199], v[92:95]
ds_read_b128 a[248:251], v2 offset:6144
v_mfma_f32_16x16x32_bf16 v[48:51], a[228:231], a[192:195], v[48:51]
s_add_u32 s16, s16, 17928192
s_add_u32 s17, s10, 0
v_mfma_f32_16x16x32_bf16 v[96:99], a[228:231], a[196:199], v[96:99]
ds_read_b128 a[252:255], v2 offset:7168
s_waitcnt lgkmcnt(4)
v_mfma_f32_16x16x32_bf16 v[52:55], a[232:235], a[192:195], v[52:55]
s_and_b32 s17, s17, 3
s_mul_i32 s17, s17, 49152
v_mfma_f32_16x16x32_bf16 v[100:103], a[232:235], a[196:199], v[100:103]
ds_read_b128 a[224:227], v2 offset:8192
v_mfma_f32_16x16x32_bf16 v[56:59], a[236:239], a[192:195], v[56:59]
buffer_load_dwordx4 v8, s[4:7], s46 offen offset:2048 sc1 lds
s_add_u32 s45, s45, 24576
s_add_u32 s46, s45, 3072
v_mfma_f32_16x16x32_bf16 v[104:107], a[236:239], a[196:199], v[104:107]
ds_read_b128 a[228:231], v2 offset:9216
s_waitcnt lgkmcnt(4)
v_mfma_f32_16x16x32_bf16 v[60:63], a[240:243], a[192:195], v[60:63]
s_add_u32 s17, s17, s16
v_add_u32 v240, s17, v2
v_mfma_f32_16x16x32_bf16 v[108:111], a[240:243], a[196:199], v[108:111]
ds_read_b128 a[232:235], v2 offset:10240
v_mfma_f32_16x16x32_bf16 v[64:67], a[244:247], a[192:195], v[64:67]
buffer_load_dwordx4 a[160:163], v12, s[4:7], s20 offen offset:2048 sc1
v_mfma_f32_16x16x32_bf16 v[112:115], a[244:247], a[196:199], v[112:115]
ds_read_b128 a[236:239], v2 offset:11264
s_waitcnt lgkmcnt(4)
v_mfma_f32_16x16x32_bf16 v[68:71], a[248:251], a[192:195], v[68:71]
s_add_u32 s17, s10, 1
s_and_b32 s17, s17, 3
v_mfma_f32_16x16x32_bf16 v[116:119], a[248:251], a[196:199], v[116:119]
ds_read_b128 a[240:243], v2 offset:12288
v_mfma_f32_16x16x32_bf16 v[72:75], a[252:255], a[192:195], v[72:75]
s_mul_i32 s17, s17, 49152
s_add_u32 s17, s17, s16
v_mfma_f32_16x16x32_bf16 v[120:123], a[252:255], a[196:199], v[120:123]
ds_read_b128 a[244:247], v2 offset:13312
s_waitcnt lgkmcnt(4)
v_mfma_f32_16x16x32_bf16 v[76:79], a[224:227], a[192:195], v[76:79]
buffer_load_dwordx4 a[164:167], v13, s[4:7], s20 offen offset:2048 sc1
v_mfma_f32_16x16x32_bf16 v[124:127], a[224:227], a[196:199], v[124:127]
ds_read_b128 a[248:251], v2 offset:14336
v_mfma_f32_16x16x32_bf16 v[80:83], a[228:231], a[192:195], v[80:83]
v_add_u32 v241, s17, v2
s_add_u32 s17, s10, 2
v_mfma_f32_16x16x32_bf16 v[128:131], a[228:231], a[196:199], v[128:131]
ds_read_b128 a[252:255], v2 offset:15360
s_waitcnt lgkmcnt(4)
v_mfma_f32_16x16x32_bf16 v[84:87], a[232:235], a[192:195], v[84:87]
s_mov_b32 s20, 16384
buffer_load_dwordx4 a[168:171], v12, s[4:7], s20 offen offset:0 sc1
v_mfma_f32_16x16x32_bf16 v[132:135], a[232:235], a[196:199], v[132:135]
ds_read_b128 a[224:227], v2 offset:16384
v_mfma_f32_16x16x32_bf16 v[88:91], a[236:239], a[192:195], v[88:91]
s_and_b32 s17, s17, 3
s_mul_i32 s17, s17, 49152
v_mfma_f32_16x16x32_bf16 v[136:139], a[236:239], a[196:199], v[136:139]
s_waitcnt vmcnt(19)
ds_read_b128 a[228:231], v2 offset:17408
s_waitcnt lgkmcnt(4)
v_mfma_f32_16x16x32_bf16 v[44:47], a[240:243], a[200:203], v[44:47]
s_add_u32 s17, s17, s16
v_add_u32 v242, s17, v2
v_mfma_f32_16x16x32_bf16 v[92:95], a[240:243], a[204:207], v[92:95]
ds_read_b128 a[232:235], v2 offset:18432
v_mfma_f32_16x16x32_bf16 v[48:51], a[244:247], a[200:203], v[48:51]
buffer_load_dwordx4 a[172:175], v13, s[4:7], s20 offen offset:0 sc1
v_mfma_f32_16x16x32_bf16 v[96:99], a[244:247], a[204:207], v[96:99]
ds_read_b128 a[236:239], v2 offset:19456
s_waitcnt lgkmcnt(4)
v_mfma_f32_16x16x32_bf16 v[52:55], a[248:251], a[200:203], v[52:55]
s_add_u32 s17, s10, 3
s_and_b32 s17, s17, 3
v_mfma_f32_16x16x32_bf16 v[100:103], a[248:251], a[204:207], v[100:103]
ds_read_b128 a[240:243], v2 offset:20480
v_mfma_f32_16x16x32_bf16 v[56:59], a[252:255], a[200:203], v[56:59]
s_add_u32 m0, s44, 73728
s_nop 0
buffer_load_dwordx4 v8, s[4:7], s45 offen offset:0 sc1 lds
v_mfma_f32_16x16x32_bf16 v[104:107], a[252:255], a[204:207], v[104:107]
ds_read_b128 a[244:247], v2 offset:21504
s_waitcnt lgkmcnt(4)
v_mfma_f32_16x16x32_bf16 v[60:63], a[224:227], a[200:203], v[60:63]
s_mul_i32 s17, s17, 49152
s_add_u32 s17, s17, s16
v_mfma_f32_16x16x32_bf16 v[108:111], a[224:227], a[204:207], v[108:111]
ds_read_b128 a[248:251], v2 offset:22528
v_mfma_f32_16x16x32_bf16 v[64:67], a[228:231], a[200:203], v[64:67]
v_add_u32 v243, s17, v2
s_add_u32 s17, s10, 3
v_mfma_f32_16x16x32_bf16 v[112:115], a[228:231], a[204:207], v[112:115]
ds_read_b128 a[252:255], v2 offset:23552
s_waitcnt lgkmcnt(4)
v_mfma_f32_16x16x32_bf16 v[68:71], a[232:235], a[200:203], v[68:71]
buffer_load_dwordx4 v8, s[4:7], s45 offen offset:1024 sc1 lds
v_mfma_f32_16x16x32_bf16 v[116:119], a[232:235], a[204:207], v[116:119]
s_waitcnt vmcnt(16)
s_barrier
ds_read_b128 a[224:227], v2 offset:24576
v_mfma_f32_16x16x32_bf16 v[72:75], a[236:239], a[200:203], v[72:75]
s_and_b32 s17, s17, 3
s_mul_i32 s17, s17, 10240
v_mfma_f32_16x16x32_bf16 v[120:123], a[236:239], a[204:207], v[120:123]
ds_read_b128 a[228:231], v2 offset:25600
s_waitcnt lgkmcnt(4)
v_mfma_f32_16x16x32_bf16 v[76:79], a[240:243], a[200:203], v[76:79]
buffer_load_dwordx4 v8, s[4:7], s45 offen offset:2048 sc1 lds
v_mfma_f32_16x16x32_bf16 v[124:127], a[240:243], a[204:207], v[124:127]
ds_read_b128 a[232:235], v2 offset:26624
v_mfma_f32_16x16x32_bf16 v[80:83], a[244:247], a[200:203], v[80:83]
s_add_u32 s17, s17, 122880
v_add_u32 v244, s17, v2
v_mfma_f32_16x16x32_bf16 v[128:131], a[244:247], a[204:207], v[128:131]
ds_read_b128 a[236:239], v2 offset:27648
s_waitcnt lgkmcnt(4)
v_mfma_f32_16x16x32_bf16 v[84:87], a[248:251], a[200:203], v[84:87]
s_mul_i32 s17, s10, 10240
s_add_u32 s17, s17, 122880
v_mfma_f32_16x16x32_bf16 v[132:135], a[248:251], a[204:207], v[132:135]
ds_read_b128 a[240:243], v2 offset:28672
v_mfma_f32_16x16x32_bf16 v[88:91], a[252:255], a[200:203], v[88:91]
s_add_u32 m0, s44, 76800
s_nop 0
buffer_load_dwordx4 v8, s[4:7], s46 offen offset:0 sc1 lds
v_mfma_f32_16x16x32_bf16 v[136:139], a[252:255], a[204:207], v[136:139]
s_waitcnt vmcnt(16)
ds_read_b128 a[244:247], v2 offset:29696
s_waitcnt lgkmcnt(4)
v_mfma_f32_16x16x32_bf16 v[44:47], a[224:227], a[208:211], v[44:47]
v_add_u32 v245, s17, v2
s_lshl_b32 s16, s13, 2
v_mfma_f32_16x16x32_bf16 v[92:95], a[224:227], a[212:215], v[92:95]
ds_read_b128 a[248:251], v2 offset:30720
v_mfma_f32_16x16x32_bf16 v[48:51], a[228:231], a[208:211], v[48:51]
buffer_load_dwordx4 v8, s[4:7], s46 offen offset:1024 sc1 lds
v_mfma_f32_16x16x32_bf16 v[96:99], a[228:231], a[212:215], v[96:99]
ds_read_b128 a[252:255], v2 offset:31744
s_waitcnt lgkmcnt(4)
v_mfma_f32_16x16x32_bf16 v[52:55], a[232:235], a[208:211], v[52:55]
s_add_u32 s16, s16, s10
s_and_b32 s19, s14, 1
v_mfma_f32_16x16x32_bf16 v[100:103], a[232:235], a[212:215], v[100:103]
ds_read_b128 a[224:227], v2 offset:32768
v_mfma_f32_16x16x32_bf16 v[56:59], a[236:239], a[208:211], v[56:59]
s_mul_i32 s29, s14, 5
s_add_u32 s30, s29, s19
v_mfma_f32_16x16x32_bf16 v[104:107], a[236:239], a[212:215], v[104:107]
ds_read_b128 a[228:231], v2 offset:33792
s_waitcnt lgkmcnt(4)
v_mfma_f32_16x16x32_bf16 v[60:63], a[240:243], a[208:211], v[60:63]
buffer_load_dwordx4 v8, s[4:7], s46 offen offset:2048 sc1 lds
s_add_u32 s45, s45, 24576
s_add_u32 s46, s45, 3072
v_mfma_f32_16x16x32_bf16 v[108:111], a[240:243], a[212:215], v[108:111]
ds_read_b128 a[232:235], v2 offset:34816
v_mfma_f32_16x16x32_bf16 v[64:67], a[244:247], a[208:211], v[64:67]
s_xor_b32 s19, s19, 1
s_lshl_b32 s19, s19, 2
v_mfma_f32_16x16x32_bf16 v[112:115], a[244:247], a[212:215], v[112:115]
ds_read_b128 a[236:239], v2 offset:35840
s_waitcnt lgkmcnt(4)
v_mfma_f32_16x16x32_bf16 v[68:71], a[248:251], a[208:211], v[68:71]
buffer_load_dwordx4 a[176:179], v12, s[4:7], s20 offen offset:1024 sc1
v_mfma_f32_16x16x32_bf16 v[116:119], a[248:251], a[212:215], v[116:119]
ds_read_b128 a[240:243], v2 offset:36864
v_mfma_f32_16x16x32_bf16 v[72:75], a[252:255], a[208:211], v[72:75]
s_add_u32 s29, s29, s19
s_mul_i32 s17, s16, 20480
v_mfma_f32_16x16x32_bf16 v[120:123], a[252:255], a[212:215], v[120:123]
ds_read_b128 a[244:247], v2 offset:37888
s_waitcnt lgkmcnt(4)
v_mfma_f32_16x16x32_bf16 v[76:79], a[224:227], a[208:211], v[76:79]
s_add_u32 s17, s17, s15
s_add_u32 s17, s17, 15175680
v_mfma_f32_16x16x32_bf16 v[124:127], a[224:227], a[212:215], v[124:127]
ds_read_b128 a[248:251], v2 offset:38912
v_mfma_f32_16x16x32_bf16 v[80:83], a[228:231], a[208:211], v[80:83]
buffer_load_dwordx4 a[180:183], v13, s[4:7], s20 offen offset:1024 sc1
v_mfma_f32_16x16x32_bf16 v[128:131], a[228:231], a[212:215], v[128:131]
ds_read_b128 a[252:255], v2 offset:39936
s_waitcnt lgkmcnt(4)
v_mfma_f32_16x16x32_bf16 v[84:87], a[232:235], a[208:211], v[84:87]
s_lshl_b32 s19, s30, 9
s_add_u32 s19, s19, s17
v_mfma_f32_16x16x32_bf16 v[132:135], a[232:235], a[212:215], v[132:135]
ds_read_b128 a[224:227], v2 offset:40960
v_mfma_f32_16x16x32_bf16 v[88:91], a[236:239], a[208:211], v[88:91]
buffer_load_dwordx4 a[184:187], v12, s[4:7], s20 offen offset:3072 sc1
v_mfma_f32_16x16x32_bf16 v[136:139], a[236:239], a[212:215], v[136:139]
s_waitcnt vmcnt(19)
ds_read_b128 a[228:231], v2 offset:41984
s_waitcnt lgkmcnt(4)
v_mfma_f32_16x16x32_bf16 v[44:47], a[240:243], a[216:219], v[44:47]
v_add_u32 v246, s19, v2
v_lshrrev_b32 v250, 1, v4
v_mfma_f32_16x16x32_bf16 v[92:95], a[240:243], a[220:223], v[92:95]
ds_read_b128 a[232:235], v2 offset:43008
v_mfma_f32_16x16x32_bf16 v[48:51], a[244:247], a[216:219], v[48:51]
v_lshlrev_b32 v250, 8, v250
v_lshl_add_u32 v250, v3, 4, v250
v_mfma_f32_16x16x32_bf16 v[96:99], a[244:247], a[220:223], v[96:99]
ds_read_b128 a[236:239], v2 offset:44032
s_waitcnt lgkmcnt(4)
v_mfma_f32_16x16x32_bf16 v[52:55], a[248:251], a[216:219], v[52:55]
buffer_load_dwordx4 a[188:191], v13, s[4:7], s20 offen offset:3072 sc1
v_mfma_f32_16x16x32_bf16 v[100:103], a[248:251], a[220:223], v[100:103]
ds_read_b128 a[240:243], v2 offset:45056
v_mfma_f32_16x16x32_bf16 v[56:59], a[252:255], a[216:219], v[56:59]
s_lshl_b32 s19, s29, 9
s_add_u32 s19, s19, s17
v_mfma_f32_16x16x32_bf16 v[104:107], a[252:255], a[220:223], v[104:107]
ds_read_b128 a[244:247], v2 offset:46080
s_waitcnt lgkmcnt(4)
v_mfma_f32_16x16x32_bf16 v[60:63], a[224:227], a[216:219], v[60:63]
buffer_load_dwordx4 a[52:55], v11, s[4:7], s58 offen offset:3072 sc1
v_mfma_f32_16x16x32_bf16 v[108:111], a[224:227], a[220:223], v[108:111]
ds_read_b128 a[248:251], v2 offset:47104
v_mfma_f32_16x16x32_bf16 v[64:67], a[228:231], a[216:219], v[64:67]
v_add_u32 v248, s19, v250
v_add_u32 v247, s17, v250
v_mfma_f32_16x16x32_bf16 v[112:115], a[228:231], a[220:223], v[112:115]
ds_read_b128 a[252:255], v2 offset:48128
s_waitcnt lgkmcnt(4)
v_mfma_f32_16x16x32_bf16 v[68:71], a[232:235], a[216:219], v[68:71]
v_and_b32 v250, 1, v4
v_lshl_add_u32 v247, v250, 3, v247
v_mfma_f32_16x16x32_bf16 v[116:119], a[232:235], a[220:223], v[116:119]
s_waitcnt vmcnt(15)
s_barrier
ds_read_b128 a[224:227], v2 offset:49152
v_mfma_f32_16x16x32_bf16 v[72:75], a[236:239], a[216:219], v[72:75]
s_mov_b32 s58, 34816
buffer_load_dwordx4 a[56:59], v11, s[4:7], s58 offen offset:0 sc1
v_mfma_f32_16x16x32_bf16 v[120:123], a[236:239], a[220:223], v[120:123]
ds_read_b128 a[228:231], v2 offset:50176
s_waitcnt lgkmcnt(4)
v_mfma_f32_16x16x32_bf16 v[76:79], a[240:243], a[216:219], v[76:79]
v_lshl_add_u32 v248, v250, 30, v248
s_mov_b32 s32, s4
v_mfma_f32_16x16x32_bf16 v[124:127], a[240:243], a[220:223], v[124:127]
ds_read_b128 a[232:235], v2 offset:51200
v_mfma_f32_16x16x32_bf16 v[80:83], a[244:247], a[216:219], v[80:83]
s_mov_b32 s58, 46080
buffer_load_dwordx4 a[60:63], v11, s[4:7], s58 offen offset:0 sc1
v_mfma_f32_16x16x32_bf16 v[128:131], a[244:247], a[220:223], v[128:131]
ds_read_b128 a[236:239], v2 offset:52224
s_waitcnt lgkmcnt(4)
v_mfma_f32_16x16x32_bf16 v[84:87], a[248:251], a[216:219], v[84:87]
s_mov_b32 s33, s5
s_mov_b32 s34, s6
v_mfma_f32_16x16x32_bf16 v[132:135], a[248:251], a[220:223], v[132:135]
ds_read_b128 a[240:243], v2 offset:53248
v_mfma_f32_16x16x32_bf16 v[88:91], a[252:255], a[216:219], v[88:91]
s_mov_b32 s35, 0x20000
s_mov_b32 s31, 512
v_mfma_f32_16x16x32_bf16 v[136:139], a[252:255], a[220:223], v[136:139]
s_waitcnt vmcnt(15)
ds_read_b128 a[244:247], v2 offset:54272
s_waitcnt lgkmcnt(4)
v_mfma_f32_16x16x32_bf16 v[44:47], a[224:227], a[160:163], v[44:47]
buffer_load_dwordx4 a[64:67], v11, s[4:7], s58 offen offset:1024 sc1
v_mfma_f32_16x16x32_bf16 v[92:95], a[224:227], a[164:167], v[92:95]
ds_read_b128 a[248:251], v2 offset:55296
v_mfma_f32_16x16x32_bf16 v[48:51], a[228:231], a[160:163], v[48:51]
s_mul_i32 s38, s30, s31
s_mul_i32 s39, s29, s31
v_mfma_f32_16x16x32_bf16 v[96:99], a[228:231], a[164:167], v[96:99]
ds_read_b128 a[252:255], v2 offset:56320
s_waitcnt lgkmcnt(4)
v_mfma_f32_16x16x32_bf16 v[52:55], a[232:235], a[160:163], v[52:55]
buffer_load_dwordx4 a[68:71], v11, s[4:7], s58 offen offset:2048 sc1
v_mfma_f32_16x16x32_bf16 v[100:103], a[232:235], a[164:167], v[100:103]
ds_read_b128 a[224:227], v2 offset:57344
v_mfma_f32_16x16x32_bf16 v[56:59], a[236:239], a[160:163], v[56:59]
s_lshl_b32 s17, s16, 10
s_add_u32 s17, s17, s15
v_mfma_f32_16x16x32_bf16 v[104:107], a[236:239], a[164:167], v[104:107]
ds_read_b128 a[228:231], v2 offset:58368
s_waitcnt lgkmcnt(4)
v_mfma_f32_16x16x32_bf16 v[60:63], a[240:243], a[160:163], v[60:63]
s_add_u32 s17, s17, 26841088
s_lshl_b32 s19, s14, 7
v_mfma_f32_16x16x32_bf16 v[108:111], a[240:243], a[164:167], v[108:111]
ds_read_b128 a[232:235], v2 offset:59392
v_mfma_f32_16x16x32_bf16 v[64:67], a[244:247], a[160:163], v[64:67]
buffer_load_dwordx4 a[72:75], v11, s[4:7], s58 offen offset:3072 sc1
v_mfma_f32_16x16x32_bf16 v[112:115], a[244:247], a[164:167], v[112:115]
ds_read_b128 a[236:239], v2 offset:60416
s_waitcnt lgkmcnt(4)
v_mfma_f32_16x16x32_bf16 v[68:71], a[248:251], a[160:163], v[68:71]
s_add_u32 s17, s17, s19
v_lshl_add_u32 v249, v3, 3, s17
v_mfma_f32_16x16x32_bf16 v[116:119], a[248:251], a[164:167], v[116:119]
ds_read_b128 a[240:243], v2 offset:61440
v_mfma_f32_16x16x32_bf16 v[72:75], a[252:255], a[160:163], v[72:75]
s_mov_b32 s58, 50176
buffer_load_dwordx4 a[76:79], v11, s[4:7], s58 offen offset:0 sc1
v_mfma_f32_16x16x32_bf16 v[120:123], a[252:255], a[164:167], v[120:123]
ds_read_b128 a[244:247], v2 offset:62464
s_waitcnt lgkmcnt(4)
v_mfma_f32_16x16x32_bf16 v[76:79], a[224:227], a[160:163], v[76:79]
v_mov_b32 v250, 0x40000000
v_and_b32 v250, v250, v5
v_mfma_f32_16x16x32_bf16 v[124:127], a[224:227], a[164:167], v[124:127]
ds_read_b128 a[248:251], v2 offset:63488
v_mfma_f32_16x16x32_bf16 v[80:83], a[228:231], a[160:163], v[80:83]
v_or_b32 v249, v250, v249
v_mfma_f32_16x16x32_bf16 v[128:131], a[228:231], a[164:167], v[128:131]
ds_read_b128 a[252:255], v2 offset:64512
s_waitcnt lgkmcnt(4)
v_mfma_f32_16x16x32_bf16 v[84:87], a[232:235], a[160:163], v[84:87]
s_mov_b32 s58, 5120
buffer_load_dwordx4 a[80:83], v11, s[4:7], s58 offen offset:0 sc1
v_mfma_f32_16x16x32_bf16 v[132:135], a[232:235], a[164:167], v[132:135]
ds_read_b128 a[224:227], v14 offset:0
v_mfma_f32_16x16x32_bf16 v[88:91], a[236:239], a[160:163], v[88:91]
v_mfma_f32_16x16x32_bf16 v[136:139], a[236:239], a[164:167], v[136:139]
s_waitcnt vmcnt(18)
ds_read_b128 a[228:231], v14 offset:1024
s_waitcnt lgkmcnt(4)
v_mfma_f32_16x16x32_bf16 v[44:47], a[240:243], a[168:171], v[44:47]
buffer_load_dwordx4 a[84:87], v11, s[4:7], s58 offen offset:1024 sc1
v_mfma_f32_16x16x32_bf16 v[92:95], a[240:243], a[172:175], v[92:95]
ds_read_b128 a[232:235], v14 offset:2048
v_mfma_f32_16x16x32_bf16 v[48:51], a[244:247], a[168:171], v[48:51]
v_mfma_f32_16x16x32_bf16 v[96:99], a[244:247], a[172:175], v[96:99]
ds_read_b128 a[236:239], v14 offset:3072
s_waitcnt lgkmcnt(4)
v_mfma_f32_16x16x32_bf16 v[52:55], a[248:251], a[168:171], v[52:55]
v_mfma_f32_16x16x32_bf16 v[100:103], a[248:251], a[172:175], v[100:103]
ds_read_b128 a[240:243], v14 offset:4096
v_mfma_f32_16x16x32_bf16 v[56:59], a[252:255], a[168:171], v[56:59]
buffer_load_dwordx4 a[88:91], v11, s[4:7], s58 offen offset:2048 sc1
v_mfma_f32_16x16x32_bf16 v[104:107], a[252:255], a[172:175], v[104:107]
ds_read_b128 a[244:247], v14 offset:5120
s_waitcnt lgkmcnt(4)
v_mfma_f32_16x16x32_bf16 v[60:63], a[224:227], a[168:171], v[60:63]
v_mfma_f32_16x16x32_bf16 v[108:111], a[224:227], a[172:175], v[108:111]
ds_read_b128 a[248:251], v14 offset:6144
v_mfma_f32_16x16x32_bf16 v[64:67], a[228:231], a[168:171], v[64:67]
buffer_load_dwordx4 a[92:95], v11, s[4:7], s58 offen offset:3072 sc1
v_mfma_f32_16x16x32_bf16 v[112:115], a[228:231], a[172:175], v[112:115]
ds_read_b128 a[252:255], v14 offset:7168
s_waitcnt lgkmcnt(4)
v_mfma_f32_16x16x32_bf16 v[68:71], a[232:235], a[168:171], v[68:71]
v_mfma_f32_16x16x32_bf16 v[116:119], a[232:235], a[172:175], v[116:119]
s_waitcnt vmcnt(15)
s_barrier
ds_read_b128 a[224:227], v14 offset:8192
v_mfma_f32_16x16x32_bf16 v[72:75], a[236:239], a[168:171], v[72:75]
v_mfma_f32_16x16x32_bf16 v[120:123], a[236:239], a[172:175], v[120:123]
ds_read_b128 a[228:231], v14 offset:9216
s_waitcnt lgkmcnt(4)
v_mfma_f32_16x16x32_bf16 v[76:79], a[240:243], a[168:171], v[76:79]
s_mov_b32 s58, 9216
buffer_load_dwordx4 a[96:99], v11, s[4:7], s58 offen offset:0 sc1
v_mfma_f32_16x16x32_bf16 v[124:127], a[240:243], a[172:175], v[124:127]
ds_read_b128 a[232:235], v14 offset:10240
v_mfma_f32_16x16x32_bf16 v[80:83], a[244:247], a[168:171], v[80:83]
v_mfma_f32_16x16x32_bf16 v[128:131], a[244:247], a[172:175], v[128:131]
ds_read_b128 a[236:239], v14 offset:11264
s_waitcnt lgkmcnt(4)
v_mfma_f32_16x16x32_bf16 v[84:87], a[248:251], a[168:171], v[84:87]
s_mov_b32 s58, 20480
buffer_load_dwordx4 a[100:103], v11, s[4:7], s58 offen offset:0 sc1
v_mfma_f32_16x16x32_bf16 v[132:135], a[248:251], a[172:175], v[132:135]
ds_read_b128 a[240:243], v14 offset:12288
v_mfma_f32_16x16x32_bf16 v[88:91], a[252:255], a[168:171], v[88:91]
v_mfma_f32_16x16x32_bf16 v[136:139], a[252:255], a[172:175], v[136:139]
s_waitcnt vmcnt(15)
ds_read_b128 a[244:247], v14 offset:13312
s_waitcnt lgkmcnt(4)
v_mfma_f32_16x16x32_bf16 v[44:47], a[224:227], a[176:179], v[44:47]
v_mfma_f32_16x16x32_bf16 v[92:95], a[224:227], a[180:183], v[92:95]
ds_read_b128 a[248:251], v14 offset:14336
v_mfma_f32_16x16x32_bf16 v[48:51], a[228:231], a[176:179], v[48:51]
buffer_load_dwordx4 a[104:107], v11, s[4:7], s58 offen offset:1024 sc1
v_mfma_f32_16x16x32_bf16 v[96:99], a[228:231], a[180:183], v[96:99]
ds_read_b128 a[252:255], v14 offset:15360
s_waitcnt lgkmcnt(4)
v_mfma_f32_16x16x32_bf16 v[52:55], a[232:235], a[176:179], v[52:55]
v_mfma_f32_16x16x32_bf16 v[100:103], a[232:235], a[180:183], v[100:103]
ds_read_b128 a[224:227], v14 offset:16384
v_mfma_f32_16x16x32_bf16 v[56:59], a[236:239], a[176:179], v[56:59]
buffer_load_dwordx4 a[108:111], v11, s[4:7], s58 offen offset:2048 sc1
v_mfma_f32_16x16x32_bf16 v[104:107], a[236:239], a[180:183], v[104:107]
ds_read_b128 a[228:231], v14 offset:17408
s_waitcnt lgkmcnt(4)
v_mfma_f32_16x16x32_bf16 v[60:63], a[240:243], a[176:179], v[60:63]
v_mfma_f32_16x16x32_bf16 v[108:111], a[240:243], a[180:183], v[108:111]
ds_read_b128 a[232:235], v14 offset:18432
v_mfma_f32_16x16x32_bf16 v[64:67], a[244:247], a[176:179], v[64:67]
v_mfma_f32_16x16x32_bf16 v[112:115], a[244:247], a[180:183], v[112:115]
ds_read_b128 a[236:239], v14 offset:19456
s_waitcnt lgkmcnt(4)
v_mfma_f32_16x16x32_bf16 v[68:71], a[248:251], a[176:179], v[68:71]
buffer_load_dwordx4 a[112:115], v11, s[4:7], s58 offen offset:3072 sc1
v_mfma_f32_16x16x32_bf16 v[116:119], a[248:251], a[180:183], v[116:119]
ds_read_b128 a[240:243], v14 offset:20480
v_mfma_f32_16x16x32_bf16 v[72:75], a[252:255], a[176:179], v[72:75]
v_mfma_f32_16x16x32_bf16 v[120:123], a[252:255], a[180:183], v[120:123]
ds_read_b128 a[244:247], v14 offset:21504
s_waitcnt lgkmcnt(4)
v_mfma_f32_16x16x32_bf16 v[76:79], a[224:227], a[176:179], v[76:79]
s_mov_b32 s58, 24576
buffer_load_dwordx4 a[116:119], v11, s[4:7], s58 offen offset:0 sc1
v_mfma_f32_16x16x32_bf16 v[124:127], a[224:227], a[180:183], v[124:127]
ds_read_b128 a[248:251], v14 offset:22528
v_mfma_f32_16x16x32_bf16 v[80:83], a[228:231], a[176:179], v[80:83]
v_mfma_f32_16x16x32_bf16 v[128:131], a[228:231], a[180:183], v[128:131]
ds_read_b128 a[252:255], v14 offset:23552
s_waitcnt lgkmcnt(4)
v_mfma_f32_16x16x32_bf16 v[84:87], a[232:235], a[176:179], v[84:87]
v_mfma_f32_16x16x32_bf16 v[132:135], a[232:235], a[180:183], v[132:135]
ds_read_b128 a[224:227], v14 offset:24576
v_mfma_f32_16x16x32_bf16 v[88:91], a[236:239], a[176:179], v[88:91]
s_mov_b32 s58, 35840
buffer_load_dwordx4 a[120:123], v11, s[4:7], s58 offen offset:0 sc1
v_mfma_f32_16x16x32_bf16 v[136:139], a[236:239], a[180:183], v[136:139]
s_waitcnt vmcnt(18)
ds_read_b128 a[228:231], v14 offset:25600
s_waitcnt lgkmcnt(4)
v_mfma_f32_16x16x32_bf16 v[44:47], a[240:243], a[184:187], v[44:47]
v_mfma_f32_16x16x32_bf16 v[92:95], a[240:243], a[188:191], v[92:95]
ds_read_b128 a[232:235], v14 offset:26624
v_mfma_f32_16x16x32_bf16 v[48:51], a[244:247], a[184:187], v[48:51]
buffer_load_dwordx4 a[124:127], v11, s[4:7], s58 offen offset:1024 sc1
v_mfma_f32_16x16x32_bf16 v[96:99], a[244:247], a[188:191], v[96:99]
ds_read_b128 a[236:239], v14 offset:27648
s_waitcnt lgkmcnt(4)
v_mfma_f32_16x16x32_bf16 v[52:55], a[248:251], a[184:187], v[52:55]
v_mfma_f32_16x16x32_bf16 v[100:103], a[248:251], a[188:191], v[100:103]
ds_read_b128 a[240:243], v14 offset:28672
v_mfma_f32_16x16x32_bf16 v[56:59], a[252:255], a[184:187], v[56:59]
v_mfma_f32_16x16x32_bf16 v[104:107], a[252:255], a[188:191], v[104:107]
ds_read_b128 a[244:247], v14 offset:29696
s_waitcnt lgkmcnt(4)
v_mfma_f32_16x16x32_bf16 v[60:63], a[224:227], a[184:187], v[60:63]
buffer_load_dwordx4 a[128:131], v11, s[4:7], s58 offen offset:2048 sc1
v_mfma_f32_16x16x32_bf16 v[108:111], a[224:227], a[188:191], v[108:111]
ds_read_b128 a[248:251], v14 offset:30720
v_mfma_f32_16x16x32_bf16 v[64:67], a[228:231], a[184:187], v[64:67]
v_mfma_f32_16x16x32_bf16 v[112:115], a[228:231], a[188:191], v[112:115]
ds_read_b128 a[252:255], v14 offset:31744
s_waitcnt lgkmcnt(4)
v_mfma_f32_16x16x32_bf16 v[68:71], a[232:235], a[184:187], v[68:71]
buffer_load_dwordx4 a[132:135], v11, s[4:7], s58 offen offset:3072 sc1
v_mfma_f32_16x16x32_bf16 v[116:119], a[232:235], a[188:191], v[116:119]
v_mfma_f32_16x16x32_bf16 v[72:75], a[236:239], a[184:187], v[72:75]
v_mfma_f32_16x16x32_bf16 v[120:123], a[236:239], a[188:191], v[120:123]
s_waitcnt lgkmcnt(2)
v_mfma_f32_16x16x32_bf16 v[76:79], a[240:243], a[184:187], v[76:79]
v_mfma_f32_16x16x32_bf16 v[124:127], a[240:243], a[188:191], v[124:127]
v_mfma_f32_16x16x32_bf16 v[80:83], a[244:247], a[184:187], v[80:83]
s_mov_b32 s58, 39936
buffer_load_dwordx4 a[136:139], v11, s[4:7], s58 offen offset:0 sc1
v_mfma_f32_16x16x32_bf16 v[128:131], a[244:247], a[188:191], v[128:131]
s_waitcnt lgkmcnt(0)
v_mfma_f32_16x16x32_bf16 v[84:87], a[248:251], a[184:187], v[84:87]
v_mfma_f32_16x16x32_bf16 v[132:135], a[248:251], a[188:191], v[132:135]
v_mfma_f32_16x16x32_bf16 v[88:91], a[252:255], a[184:187], v[88:91]
s_mov_b32 s58, 51200
buffer_load_dwordx4 a[140:143], v11, s[4:7], s58 offen offset:0 sc1
v_mfma_f32_16x16x32_bf16 v[136:139], a[252:255], a[188:191], v[136:139]
s_nop 0
v_pk_fma_f32 v[44:45], v[140:141], v[18:19], v[44:45] op_sel:[0,1,0] op_sel_hi:[1,1,1] neg_lo:[0,1,0] neg_hi:[0,1,0]
v_pk_fma_f32 v[46:47], v[142:143], v[18:19], v[46:47] op_sel:[0,1,0] op_sel_hi:[1,1,1] neg_lo:[0,1,0] neg_hi:[0,1,0]
v_pk_fma_f32 v[48:49], v[144:145], v[18:19], v[48:49] op_sel:[0,1,0] op_sel_hi:[1,1,1] neg_lo:[0,1,0] neg_hi:[0,1,0]
v_pk_fma_f32 v[50:51], v[146:147], v[18:19], v[50:51] op_sel:[0,1,0] op_sel_hi:[1,1,1] neg_lo:[0,1,0] neg_hi:[0,1,0]
v_pk_mul_f32 v[36:37], v[44:45], v[44:45] op_sel:[0,0] op_sel_hi:[1,1]
v_pk_mul_f32 v[38:39], v[46:47], v[46:47] op_sel:[0,0] op_sel_hi:[1,1]
v_pk_fma_f32 v[36:37], v[36:37], v[20:21], v[24:25] op_sel:[0,1,1] op_sel_hi:[1,1,1]
v_pk_fma_f32 v[38:39], v[38:39], v[20:21], v[24:25] op_sel:[0,1,1] op_sel_hi:[1,1,1]
v_pk_mul_f32 v[36:37], v[44:45], v[36:37] op_sel:[0,0] op_sel_hi:[1,1]
v_pk_mul_f32 v[38:39], v[46:47], v[38:39] op_sel:[0,0] op_sel_hi:[1,1]
v_pk_mul_f32 v[48:49], v[44:45], v[48:49] op_sel:[0,0] op_sel_hi:[1,1]
v_pk_mul_f32 v[50:51], v[46:47], v[50:51] op_sel:[0,0] op_sel_hi:[1,1]
v_exp_f32 v36, v36
v_exp_f32 v37, v37
v_exp_f32 v38, v38
v_exp_f32 v39, v39
buffer_load_dwordx4 a[144:147], v11, s[4:7], s58 offen offset:1024 sc1
v_pk_fma_f32 v[36:37], v[36:37], v[22:23], v[22:23] op_sel:[0,1,1] op_sel_hi:[1,1,1]
v_pk_fma_f32 v[38:39], v[38:39], v[22:23], v[22:23] op_sel:[0,1,1] op_sel_hi:[1,1,1]
v_rcp_f32 v36, v36
v_rcp_f32 v37, v37
v_rcp_f32 v38, v38
v_rcp_f32 v39, v39
v_pk_mul_f32 v[48:49], v[48:49], v[36:37] op_sel:[0,0] op_sel_hi:[1,1]
v_pk_mul_f32 v[50:51], v[50:51], v[38:39] op_sel:[0,0] op_sel_hi:[1,1]
v_cvt_pk_bf16_f32 v28, v48, v49
v_cvt_pk_bf16_f32 v29, v50, v51
v_pk_fma_f32 v[52:53], v[148:149], v[18:19], v[52:53] op_sel:[0,1,0] op_sel_hi:[1,1,1] neg_lo:[0,1,0] neg_hi:[0,1,0]
v_pk_fma_f32 v[54:55], v[150:151], v[18:19], v[54:55] op_sel:[0,1,0] op_sel_hi:[1,1,1] neg_lo:[0,1,0] neg_hi:[0,1,0]
v_pk_fma_f32 v[56:57], v[152:153], v[18:19], v[56:57] op_sel:[0,1,0] op_sel_hi:[1,1,1] neg_lo:[0,1,0] neg_hi:[0,1,0]
v_pk_fma_f32 v[58:59], v[154:155], v[18:19], v[58:59] op_sel:[0,1,0] op_sel_hi:[1,1,1] neg_lo:[0,1,0] neg_hi:[0,1,0]
v_pk_mul_f32 v[36:37], v[52:53], v[52:53] op_sel:[0,0] op_sel_hi:[1,1]
v_pk_mul_f32 v[38:39], v[54:55], v[54:55] op_sel:[0,0] op_sel_hi:[1,1]
buffer_load_dwordx4 a[148:151], v11, s[4:7], s58 offen offset:2048 sc1
v_pk_fma_f32 v[36:37], v[36:37], v[20:21], v[24:25] op_sel:[0,1,1] op_sel_hi:[1,1,1]
v_pk_fma_f32 v[38:39], v[38:39], v[20:21], v[24:25] op_sel:[0,1,1] op_sel_hi:[1,1,1]
v_pk_mul_f32 v[36:37], v[52:53], v[36:37] op_sel:[0,0] op_sel_hi:[1,1]
v_pk_mul_f32 v[38:39], v[54:55], v[38:39] op_sel:[0,0] op_sel_hi:[1,1]
v_pk_mul_f32 v[56:57], v[52:53], v[56:57] op_sel:[0,0] op_sel_hi:[1,1]
v_pk_mul_f32 v[58:59], v[54:55], v[58:59] op_sel:[0,0] op_sel_hi:[1,1]
v_exp_f32 v36, v36
v_exp_f32 v37, v37
v_exp_f32 v38, v38
v_exp_f32 v39, v39
v_pk_fma_f32 v[36:37], v[36:37], v[22:23], v[22:23] op_sel:[0,1,1] op_sel_hi:[1,1,1]
v_pk_fma_f32 v[38:39], v[38:39], v[22:23], v[22:23] op_sel:[0,1,1] op_sel_hi:[1,1,1]
v_rcp_f32 v36, v36
v_rcp_f32 v37, v37
v_rcp_f32 v38, v38
v_rcp_f32 v39, v39
buffer_load_dwordx4 a[152:155], v11, s[4:7], s58 offen offset:3072 sc1
v_pk_mul_f32 v[56:57], v[56:57], v[36:37] op_sel:[0,0] op_sel_hi:[1,1]
v_pk_mul_f32 v[58:59], v[58:59], v[38:39] op_sel:[0,0] op_sel_hi:[1,1]
v_cvt_pk_bf16_f32 v30, v56, v57
v_cvt_pk_bf16_f32 v31, v58, v59
buffer_store_dwordx4 v[28:31], v18, s[4:7], 0 offen offset:0 sc1
v_pk_fma_f32 v[92:93], v[140:141], v[20:21], v[92:93] op_sel:[0,0,0] op_sel_hi:[1,0,1] neg_lo:[0,1,0] neg_hi:[0,1,0]
v_pk_fma_f32 v[94:95], v[142:143], v[20:21], v[94:95] op_sel:[0,0,0] op_sel_hi:[1,0,1] neg_lo:[0,1,0] neg_hi:[0,1,0]
v_pk_fma_f32 v[96:97], v[144:145], v[20:21], v[96:97] op_sel:[0,0,0] op_sel_hi:[1,0,1] neg_lo:[0,1,0] neg_hi:[0,1,0]
v_pk_fma_f32 v[98:99], v[146:147], v[20:21], v[98:99] op_sel:[0,0,0] op_sel_hi:[1,0,1] neg_lo:[0,1,0] neg_hi:[0,1,0]
v_pk_mul_f32 v[36:37], v[92:93], v[92:93] op_sel:[0,0] op_sel_hi:[1,1]
v_pk_mul_f32 v[38:39], v[94:95], v[94:95] op_sel:[0,0] op_sel_hi:[1,1]
v_pk_fma_f32 v[36:37], v[36:37], v[22:23], v[26:27] op_sel:[0,0,0] op_sel_hi:[1,0,0]
v_pk_fma_f32 v[38:39], v[38:39], v[22:23], v[26:27] op_sel:[0,0,0] op_sel_hi:[1,0,0]
v_pk_mul_f32 v[36:37], v[92:93], v[36:37] op_sel:[0,0] op_sel_hi:[1,1]
v_pk_mul_f32 v[38:39], v[94:95], v[38:39] op_sel:[0,0] op_sel_hi:[1,1]
v_pk_mul_f32 v[96:97], v[92:93], v[96:97] op_sel:[0,0] op_sel_hi:[1,1]
v_pk_mul_f32 v[98:99], v[94:95], v[98:99] op_sel:[0,0] op_sel_hi:[1,1]
s_mov_b32 s58, 55296
buffer_load_dwordx4 a[156:159], v11, s[4:7], s58 offen offset:0 sc1
v_exp_f32 v36, v36
v_exp_f32 v37, v37
v_exp_f32 v38, v38
v_exp_f32 v39, v39
v_pk_fma_f32 v[36:37], v[36:37], v[24:25], v[24:25] op_sel:[0,0,0] op_sel_hi:[1,0,0]
v_pk_fma_f32 v[38:39], v[38:39], v[24:25], v[24:25] op_sel:[0,0,0] op_sel_hi:[1,0,0]
v_rcp_f32 v36, v36
v_rcp_f32 v37, v37
v_rcp_f32 v38, v38
v_rcp_f32 v39, v39
v_pk_mul_f32 v[96:97], v[96:97], v[36:37] op_sel:[0,0] op_sel_hi:[1,1]
v_pk_mul_f32 v[98:99], v[98:99], v[38:39] op_sel:[0,0] op_sel_hi:[1,1]
v_cvt_pk_bf16_f32 v32, v96, v97
v_cvt_pk_bf16_f32 v33, v98, v99
v_pk_fma_f32 v[100:101], v[148:149], v[20:21], v[100:101] op_sel:[0,0,0] op_sel_hi:[1,0,1] neg_lo:[0,1,0] neg_hi:[0,1,0]
v_pk_fma_f32 v[102:103], v[150:151], v[20:21], v[102:103] op_sel:[0,0,0] op_sel_hi:[1,0,1] neg_lo:[0,1,0] neg_hi:[0,1,0]
s_mov_b32 s58, 10240
buffer_load_dwordx4 a[160:163], v11, s[4:7], s58 offen offset:0 sc1
v_pk_fma_f32 v[104:105], v[152:153], v[20:21], v[104:105] op_sel:[0,0,0] op_sel_hi:[1,0,1] neg_lo:[0,1,0] neg_hi:[0,1,0]
v_pk_fma_f32 v[106:107], v[154:155], v[20:21], v[106:107] op_sel:[0,0,0] op_sel_hi:[1,0,1] neg_lo:[0,1,0] neg_hi:[0,1,0]
v_pk_mul_f32 v[36:37], v[100:101], v[100:101] op_sel:[0,0] op_sel_hi:[1,1]
v_pk_mul_f32 v[38:39], v[102:103], v[102:103] op_sel:[0,0] op_sel_hi:[1,1]
v_pk_fma_f32 v[36:37], v[36:37], v[22:23], v[26:27] op_sel:[0,0,0] op_sel_hi:[1,0,0]
v_pk_fma_f32 v[38:39], v[38:39], v[22:23], v[26:27] op_sel:[0,0,0] op_sel_hi:[1,0,0]
v_pk_mul_f32 v[36:37], v[100:101], v[36:37] op_sel:[0,0] op_sel_hi:[1,1]
v_pk_mul_f32 v[38:39], v[102:103], v[38:39] op_sel:[0,0] op_sel_hi:[1,1]
v_pk_mul_f32 v[104:105], v[100:101], v[104:105] op_sel:[0,0] op_sel_hi:[1,1]
v_pk_mul_f32 v[106:107], v[102:103], v[106:107] op_sel:[0,0] op_sel_hi:[1,1]
v_exp_f32 v36, v36
v_exp_f32 v37, v37
v_exp_f32 v38, v38
v_exp_f32 v39, v39
v_pk_fma_f32 v[36:37], v[36:37], v[24:25], v[24:25] op_sel:[0,0,0] op_sel_hi:[1,0,0]
v_pk_fma_f32 v[38:39], v[38:39], v[24:25], v[24:25] op_sel:[0,0,0] op_sel_hi:[1,0,0]
buffer_load_dwordx4 a[164:167], v11, s[4:7], s58 offen offset:1024 sc1
v_rcp_f32 v36, v36
v_rcp_f32 v37, v37
v_rcp_f32 v38, v38
v_rcp_f32 v39, v39
v_pk_mul_f32 v[104:105], v[104:105], v[36:37] op_sel:[0,0] op_sel_hi:[1,1]
v_pk_mul_f32 v[106:107], v[106:107], v[38:39] op_sel:[0,0] op_sel_hi:[1,1]
v_cvt_pk_bf16_f32 v34, v104, v105
v_cvt_pk_bf16_f32 v35, v106, v107
buffer_store_dwordx4 v[32:35], v18, s[4:7], s23 offen offset:0 sc1
v_pk_fma_f32 v[60:61], v[156:157], v[18:19], v[60:61] op_sel:[0,1,0] op_sel_hi:[1,1,1] neg_lo:[0,1,0] neg_hi:[0,1,0]
v_pk_fma_f32 v[62:63], v[158:159], v[18:19], v[62:63] op_sel:[0,1,0] op_sel_hi:[1,1,1] neg_lo:[0,1,0] neg_hi:[0,1,0]
v_pk_fma_f32 v[64:65], v[160:161], v[18:19], v[64:65] op_sel:[0,1,0] op_sel_hi:[1,1,1] neg_lo:[0,1,0] neg_hi:[0,1,0]
v_pk_fma_f32 v[66:67], v[162:163], v[18:19], v[66:67] op_sel:[0,1,0] op_sel_hi:[1,1,1] neg_lo:[0,1,0] neg_hi:[0,1,0]
v_pk_mul_f32 v[36:37], v[60:61], v[60:61] op_sel:[0,0] op_sel_hi:[1,1]
v_pk_mul_f32 v[38:39], v[62:63], v[62:63] op_sel:[0,0] op_sel_hi:[1,1]
v_pk_fma_f32 v[36:37], v[36:37], v[20:21], v[24:25] op_sel:[0,1,1] op_sel_hi:[1,1,1]
v_pk_fma_f32 v[38:39], v[38:39], v[20:21], v[24:25] op_sel:[0,1,1] op_sel_hi:[1,1,1]
buffer_load_dwordx4 a[168:171], v11, s[4:7], s58 offen offset:2048 sc1
v_pk_mul_f32 v[36:37], v[60:61], v[36:37] op_sel:[0,0] op_sel_hi:[1,1]
v_pk_mul_f32 v[38:39], v[62:63], v[38:39] op_sel:[0,0] op_sel_hi:[1,1]
v_pk_mul_f32 v[64:65], v[60:61], v[64:65] op_sel:[0,0] op_sel_hi:[1,1]
v_pk_mul_f32 v[66:67], v[62:63], v[66:67] op_sel:[0,0] op_sel_hi:[1,1]
v_exp_f32 v36, v36
v_exp_f32 v37, v37
v_exp_f32 v38, v38
v_exp_f32 v39, v39
v_pk_fma_f32 v[36:37], v[36:37], v[22:23], v[22:23] op_sel:[0,1,1] op_sel_hi:[1,1,1]
v_pk_fma_f32 v[38:39], v[38:39], v[22:23], v[22:23] op_sel:[0,1,1] op_sel_hi:[1,1,1]
v_rcp_f32 v36, v36
v_rcp_f32 v37, v37
v_rcp_f32 v38, v38
v_rcp_f32 v39, v39
v_pk_mul_f32 v[64:65], v[64:65], v[36:37] op_sel:[0,0] op_sel_hi:[1,1]
v_pk_mul_f32 v[66:67], v[66:67], v[38:39] op_sel:[0,0] op_sel_hi:[1,1]
buffer_load_dwordx4 a[172:175], v11, s[4:7], s58 offen offset:3072 sc1
v_cvt_pk_bf16_f32 v28, v64, v65
v_cvt_pk_bf16_f32 v29, v66, v67
v_pk_fma_f32 v[68:69], v[164:165], v[18:19], v[68:69] op_sel:[0,1,0] op_sel_hi:[1,1,1] neg_lo:[0,1,0] neg_hi:[0,1,0]
v_pk_fma_f32 v[70:71], v[166:167], v[18:19], v[70:71] op_sel:[0,1,0] op_sel_hi:[1,1,1] neg_lo:[0,1,0] neg_hi:[0,1,0]
v_pk_fma_f32 v[72:73], v[168:169], v[18:19], v[72:73] op_sel:[0,1,0] op_sel_hi:[1,1,1] neg_lo:[0,1,0] neg_hi:[0,1,0]
v_pk_fma_f32 v[74:75], v[170:171], v[18:19], v[74:75] op_sel:[0,1,0] op_sel_hi:[1,1,1] neg_lo:[0,1,0] neg_hi:[0,1,0]
v_pk_mul_f32 v[36:37], v[68:69], v[68:69] op_sel:[0,0] op_sel_hi:[1,1]
v_pk_mul_f32 v[38:39], v[70:71], v[70:71] op_sel:[0,0] op_sel_hi:[1,1]
v_pk_fma_f32 v[36:37], v[36:37], v[20:21], v[24:25] op_sel:[0,1,1] op_sel_hi:[1,1,1]
v_pk_fma_f32 v[38:39], v[38:39], v[20:21], v[24:25] op_sel:[0,1,1] op_sel_hi:[1,1,1]
v_pk_mul_f32 v[36:37], v[68:69], v[36:37] op_sel:[0,0] op_sel_hi:[1,1]
v_pk_mul_f32 v[38:39], v[70:71], v[38:39] op_sel:[0,0] op_sel_hi:[1,1]
v_pk_mul_f32 v[72:73], v[68:69], v[72:73] op_sel:[0,0] op_sel_hi:[1,1]
v_pk_mul_f32 v[74:75], v[70:71], v[74:75] op_sel:[0,0] op_sel_hi:[1,1]
v_exp_f32 v36, v36
v_exp_f32 v37, v37
s_mov_b32 s58, 14336
buffer_load_dwordx4 a[176:179], v11, s[4:7], s58 offen offset:0 sc1
v_exp_f32 v38, v38
v_exp_f32 v39, v39
v_pk_fma_f32 v[36:37], v[36:37], v[22:23], v[22:23] op_sel:[0,1,1] op_sel_hi:[1,1,1]
v_pk_fma_f32 v[38:39], v[38:39], v[22:23], v[22:23] op_sel:[0,1,1] op_sel_hi:[1,1,1]
v_rcp_f32 v36, v36
v_rcp_f32 v37, v37
v_rcp_f32 v38, v38
v_rcp_f32 v39, v39
v_pk_mul_f32 v[72:73], v[72:73], v[36:37] op_sel:[0,0] op_sel_hi:[1,1]
v_pk_mul_f32 v[74:75], v[74:75], v[38:39] op_sel:[0,0] op_sel_hi:[1,1]
v_cvt_pk_bf16_f32 v30, v72, v73
v_cvt_pk_bf16_f32 v31, v74, v75
buffer_store_dwordx4 v[28:31], v18, s[4:7], 0 offen offset:1024 sc1
v_pk_fma_f32 v[108:109], v[156:157], v[20:21], v[108:109] op_sel:[0,0,0] op_sel_hi:[1,0,1] neg_lo:[0,1,0] neg_hi:[0,1,0]
v_pk_fma_f32 v[110:111], v[158:159], v[20:21], v[110:111] op_sel:[0,0,0] op_sel_hi:[1,0,1] neg_lo:[0,1,0] neg_hi:[0,1,0]
v_pk_fma_f32 v[112:113], v[160:161], v[20:21], v[112:113] op_sel:[0,0,0] op_sel_hi:[1,0,1] neg_lo:[0,1,0] neg_hi:[0,1,0]
v_pk_fma_f32 v[114:115], v[162:163], v[20:21], v[114:115] op_sel:[0,0,0] op_sel_hi:[1,0,1] neg_lo:[0,1,0] neg_hi:[0,1,0]
s_mov_b32 s58, 25600
buffer_load_dwordx4 a[180:183], v11, s[4:7], s58 offen offset:0 sc1
v_pk_mul_f32 v[36:37], v[108:109], v[108:109] op_sel:[0,0] op_sel_hi:[1,1]
v_pk_mul_f32 v[38:39], v[110:111], v[110:111] op_sel:[0,0] op_sel_hi:[1,1]
v_pk_fma_f32 v[36:37], v[36:37], v[22:23], v[26:27] op_sel:[0,0,0] op_sel_hi:[1,0,0]
v_pk_fma_f32 v[38:39], v[38:39], v[22:23], v[26:27] op_sel:[0,0,0] op_sel_hi:[1,0,0]
v_pk_mul_f32 v[36:37], v[108:109], v[36:37] op_sel:[0,0] op_sel_hi:[1,1]
v_pk_mul_f32 v[38:39], v[110:111], v[38:39] op_sel:[0,0] op_sel_hi:[1,1]
v_pk_mul_f32 v[112:113], v[108:109], v[112:113] op_sel:[0,0] op_sel_hi:[1,1]
v_pk_mul_f32 v[114:115], v[110:111], v[114:115] op_sel:[0,0] op_sel_hi:[1,1]
v_exp_f32 v36, v36
v_exp_f32 v37, v37
v_exp_f32 v38, v38
v_exp_f32 v39, v39
v_pk_fma_f32 v[36:37], v[36:37], v[24:25], v[24:25] op_sel:[0,0,0] op_sel_hi:[1,0,0]
v_pk_fma_f32 v[38:39], v[38:39], v[24:25], v[24:25] op_sel:[0,0,0] op_sel_hi:[1,0,0]
v_rcp_f32 v36, v36
v_rcp_f32 v37, v37
buffer_load_dwordx4 a[184:187], v11, s[4:7], s58 offen offset:1024 sc1
v_rcp_f32 v38, v38
v_rcp_f32 v39, v39
v_pk_mul_f32 v[112:113], v[112:113], v[36:37] op_sel:[0,0] op_sel_hi:[1,1]
v_pk_mul_f32 v[114:115], v[114:115], v[38:39] op_sel:[0,0] op_sel_hi:[1,1]
v_cvt_pk_bf16_f32 v32, v112, v113
v_cvt_pk_bf16_f32 v33, v114, v115
v_pk_fma_f32 v[116:117], v[164:165], v[20:21], v[116:117] op_sel:[0,0,0] op_sel_hi:[1,0,1] neg_lo:[0,1,0] neg_hi:[0,1,0]
v_pk_fma_f32 v[118:119], v[166:167], v[20:21], v[118:119] op_sel:[0,0,0] op_sel_hi:[1,0,1] neg_lo:[0,1,0] neg_hi:[0,1,0]
v_pk_fma_f32 v[120:121], v[168:169], v[20:21], v[120:121] op_sel:[0,0,0] op_sel_hi:[1,0,1] neg_lo:[0,1,0] neg_hi:[0,1,0]
v_pk_fma_f32 v[122:123], v[170:171], v[20:21], v[122:123] op_sel:[0,0,0] op_sel_hi:[1,0,1] neg_lo:[0,1,0] neg_hi:[0,1,0]
v_pk_mul_f32 v[36:37], v[116:117], v[116:117] op_sel:[0,0] op_sel_hi:[1,1]
v_pk_mul_f32 v[38:39], v[118:119], v[118:119] op_sel:[0,0] op_sel_hi:[1,1]
v_pk_fma_f32 v[36:37], v[36:37], v[22:23], v[26:27] op_sel:[0,0,0] op_sel_hi:[1,0,0]
v_pk_fma_f32 v[38:39], v[38:39], v[22:23], v[26:27] op_sel:[0,0,0] op_sel_hi:[1,0,0]
v_pk_mul_f32 v[36:37], v[116:117], v[36:37] op_sel:[0,0] op_sel_hi:[1,1]
v_pk_mul_f32 v[38:39], v[118:119], v[38:39] op_sel:[0,0] op_sel_hi:[1,1]
buffer_load_dwordx4 a[188:191], v11, s[4:7], s58 offen offset:2048 sc1
v_pk_mul_f32 v[120:121], v[116:117], v[120:121] op_sel:[0,0] op_sel_hi:[1,1]
v_pk_mul_f32 v[122:123], v[118:119], v[122:123] op_sel:[0,0] op_sel_hi:[1,1]
v_exp_f32 v36, v36
v_exp_f32 v37, v37
v_exp_f32 v38, v38
v_exp_f32 v39, v39
v_pk_fma_f32 v[36:37], v[36:37], v[24:25], v[24:25] op_sel:[0,0,0] op_sel_hi:[1,0,0]
v_pk_fma_f32 v[38:39], v[38:39], v[24:25], v[24:25] op_sel:[0,0,0] op_sel_hi:[1,0,0]
v_rcp_f32 v36, v36
v_rcp_f32 v37, v37
v_rcp_f32 v38, v38
v_rcp_f32 v39, v39
v_pk_mul_f32 v[120:121], v[120:121], v[36:37] op_sel:[0,0] op_sel_hi:[1,1]
v_pk_mul_f32 v[122:123], v[122:123], v[38:39] op_sel:[0,0] op_sel_hi:[1,1]
v_cvt_pk_bf16_f32 v34, v120, v121
v_cvt_pk_bf16_f32 v35, v122, v123
buffer_load_dwordx4 a[192:195], v11, s[4:7], s58 offen offset:3072 sc1
buffer_store_dwordx4 v[32:35], v18, s[4:7], s23 offen offset:1024 sc1
s_waitcnt vmcnt(9)
s_add_u32 s22, s22, 16
s_barrier
s_cmp_lg_u32 s10, 0
s_cbranch_scc1 L_arr_13
v_mov_b32 v255, 1
s_mov_b32 s42, 32768
buffer_atomic_add v255, v5, s[4:7], s42 offen
L_arr_13:
v_pk_fma_f32 v[76:77], v[172:173], v[18:19], v[76:77] op_sel:[0,1,0] op_sel_hi:[1,1,1] neg_lo:[0,1,0] neg_hi:[0,1,0]
v_pk_fma_f32 v[78:79], v[174:175], v[18:19], v[78:79] op_sel:[0,1,0] op_sel_hi:[1,1,1] neg_lo:[0,1,0] neg_hi:[0,1,0]
v_pk_fma_f32 v[80:81], v[176:177], v[18:19], v[80:81] op_sel:[0,1,0] op_sel_hi:[1,1,1] neg_lo:[0,1,0] neg_hi:[0,1,0]
v_pk_fma_f32 v[82:83], v[178:179], v[18:19], v[82:83] op_sel:[0,1,0] op_sel_hi:[1,1,1] neg_lo:[0,1,0] neg_hi:[0,1,0]
v_pk_mul_f32 v[36:37], v[76:77], v[76:77] op_sel:[0,0] op_sel_hi:[1,1]
v_pk_mul_f32 v[38:39], v[78:79], v[78:79] op_sel:[0,0] op_sel_hi:[1,1]
v_pk_fma_f32 v[36:37], v[36:37], v[20:21], v[24:25] op_sel:[0,1,1] op_sel_hi:[1,1,1]
v_pk_fma_f32 v[38:39], v[38:39], v[20:21], v[24:25] op_sel:[0,1,1] op_sel_hi:[1,1,1]
v_pk_mul_f32 v[36:37], v[76:77], v[36:37] op_sel:[0,0] op_sel_hi:[1,1]
v_pk_mul_f32 v[38:39], v[78:79], v[38:39] op_sel:[0,0] op_sel_hi:[1,1]
v_pk_mul_f32 v[80:81], v[76:77], v[80:81] op_sel:[0,0] op_sel_hi:[1,1]
v_pk_mul_f32 v[82:83], v[78:79], v[82:83] op_sel:[0,0] op_sel_hi:[1,1]
v_exp_f32 v36, v36
v_exp_f32 v37, v37
v_exp_f32 v38, v38
v_exp_f32 v39, v39
s_mov_b32 s58, 29696
buffer_load_dwordx4 a[196:199], v11, s[4:7], s58 offen offset:0 sc1
v_pk_fma_f32 v[36:37], v[36:37], v[22:23], v[22:23] op_sel:[0,1,1] op_sel_hi:[1,1,1]
v_pk_fma_f32 v[38:39], v[38:39], v[22:23], v[22:23] op_sel:[0,1,1] op_sel_hi:[1,1,1]
v_rcp_f32 v36, v36
v_rcp_f32 v37, v37
v_rcp_f32 v38, v38
v_rcp_f32 v39, v39
v_pk_mul_f32 v[80:81], v[80:81], v[36:37] op_sel:[0,0] op_sel_hi:[1,1]
v_pk_mul_f32 v[82:83], v[82:83], v[38:39] op_sel:[0,0] op_sel_hi:[1,1]
v_cvt_pk_bf16_f32 v28, v80, v81
v_cvt_pk_bf16_f32 v29, v82, v83
v_pk_fma_f32 v[84:85], v[180:181], v[18:19], v[84:85] op_sel:[0,1,0] op_sel_hi:[1,1,1] neg_lo:[0,1,0] neg_hi:[0,1,0]
v_pk_fma_f32 v[86:87], v[182:183], v[18:19], v[86:87] op_sel:[0,1,0] op_sel_hi:[1,1,1] neg_lo:[0,1,0] neg_hi:[0,1,0]
v_pk_fma_f32 v[88:89], v[184:185], v[18:19], v[88:89] op_sel:[0,1,0] op_sel_hi:[1,1,1] neg_lo:[0,1,0] neg_hi:[0,1,0]
v_pk_fma_f32 v[90:91], v[186:187], v[18:19], v[90:91] op_sel:[0,1,0] op_sel_hi:[1,1,1] neg_lo:[0,1,0] neg_hi:[0,1,0]
v_pk_mul_f32 v[36:37], v[84:85], v[84:85] op_sel:[0,0] op_sel_hi:[1,1]
v_pk_mul_f32 v[38:39], v[86:87], v[86:87] op_sel:[0,0] op_sel_hi:[1,1]
s_mov_b32 s58, 40960
buffer_load_dwordx4 a[200:203], v11, s[4:7], s58 offen offset:0 sc1
v_pk_fma_f32 v[36:37], v[36:37], v[20:21], v[24:25] op_sel:[0,1,1] op_sel_hi:[1,1,1]
v_pk_fma_f32 v[38:39], v[38:39], v[20:21], v[24:25] op_sel:[0,1,1] op_sel_hi:[1,1,1]
v_pk_mul_f32 v[36:37], v[84:85], v[36:37] op_sel:[0,0] op_sel_hi:[1,1]
v_pk_mul_f32 v[38:39], v[86:87], v[38:39] op_sel:[0,0] op_sel_hi:[1,1]
v_pk_mul_f32 v[88:89], v[84:85], v[88:89] op_sel:[0,0] op_sel_hi:[1,1]
v_pk_mul_f32 v[90:91], v[86:87], v[90:91] op_sel:[0,0] op_sel_hi:[1,1]
v_exp_f32 v36, v36
v_exp_f32 v37, v37
v_exp_f32 v38, v38
v_exp_f32 v39, v39
v_pk_fma_f32 v[36:37], v[36:37], v[22:23], v[22:23] op_sel:[0,1,1] op_sel_hi:[1,1,1]
v_pk_fma_f32 v[38:39], v[38:39], v[22:23], v[22:23] op_sel:[0,1,1] op_sel_hi:[1,1,1]
v_rcp_f32 v36, v36
v_rcp_f32 v37, v37
v_rcp_f32 v38, v38
v_rcp_f32 v39, v39
buffer_load_dwordx4 a[204:207], v11, s[4:7], s58 offen offset:1024 sc1
v_pk_mul_f32 v[88:89], v[88:89], v[36:37] op_sel:[0,0] op_sel_hi:[1,1]
v_pk_mul_f32 v[90:91], v[90:91], v[38:39] op_sel:[0,0] op_sel_hi:[1,1]
v_cvt_pk_bf16_f32 v30, v88, v89
v_cvt_pk_bf16_f32 v31, v90, v91
buffer_store_dwordx4 v[28:31], v18, s[4:7], 0 offen offset:2048 sc1
v_pk_fma_f32 v[124:125], v[172:173], v[20:21], v[124:125] op_sel:[0,0,0] op_sel_hi:[1,0,1] neg_lo:[0,1,0] neg_hi:[0,1,0]
v_pk_fma_f32 v[126:127], v[174:175], v[20:21], v[126:127] op_sel:[0,0,0] op_sel_hi:[1,0,1] neg_lo:[0,1,0] neg_hi:[0,1,0]
v_pk_fma_f32 v[128:129], v[176:177], v[20:21], v[128:129] op_sel:[0,0,0] op_sel_hi:[1,0,1] neg_lo:[0,1,0] neg_hi:[0,1,0]
v_pk_fma_f32 v[130:131], v[178:179], v[20:21], v[130:131] op_sel:[0,0,0] op_sel_hi:[1,0,1] neg_lo:[0,1,0] neg_hi:[0,1,0]
v_pk_mul_f32 v[36:37], v[124:125], v[124:125] op_sel:[0,0] op_sel_hi:[1,1]
v_pk_mul_f32 v[38:39], v[126:127], v[126:127] op_sel:[0,0] op_sel_hi:[1,1]
v_pk_fma_f32 v[36:37], v[36:37], v[22:23], v[26:27] op_sel:[0,0,0] op_sel_hi:[1,0,0]
v_pk_fma_f32 v[38:39], v[38:39], v[22:23], v[26:27] op_sel:[0,0,0] op_sel_hi:[1,0,0]
v_pk_mul_f32 v[36:37], v[124:125], v[36:37] op_sel:[0,0] op_sel_hi:[1,1]
v_pk_mul_f32 v[38:39], v[126:127], v[38:39] op_sel:[0,0] op_sel_hi:[1,1]
v_pk_mul_f32 v[128:129], v[124:125], v[128:129] op_sel:[0,0] op_sel_hi:[1,1]
v_pk_mul_f32 v[130:131], v[126:127], v[130:131] op_sel:[0,0] op_sel_hi:[1,1]
buffer_load_dwordx4 a[208:211], v11, s[4:7], s58 offen offset:2048 sc1
v_exp_f32 v36, v36
v_exp_f32 v37, v37
v_exp_f32 v38, v38
v_exp_f32 v39, v39
v_pk_fma_f32 v[36:37], v[36:37], v[24:25], v[24:25] op_sel:[0,0,0] op_sel_hi:[1,0,0]
v_pk_fma_f32 v[38:39], v[38:39], v[24:25], v[24:25] op_sel:[0,0,0] op_sel_hi:[1,0,0]
v_rcp_f32 v36, v36
v_rcp_f32 v37, v37
v_rcp_f32 v38, v38
v_rcp_f32 v39, v39
v_pk_mul_f32 v[128:129], v[128:129], v[36:37] op_sel:[0,0] op_sel_hi:[1,1]
v_pk_mul_f32 v[130:131], v[130:131], v[38:39] op_sel:[0,0] op_sel_hi:[1,1]
v_cvt_pk_bf16_f32 v32, v128, v129
v_cvt_pk_bf16_f32 v33, v130, v131
v_pk_fma_f32 v[132:133], v[180:181], v[20:21], v[132:133] op_sel:[0,0,0] op_sel_hi:[1,0,1] neg_lo:[0,1,0] neg_hi:[0,1,0]
v_pk_fma_f32 v[134:135], v[182:183], v[20:21], v[134:135] op_sel:[0,0,0] op_sel_hi:[1,0,1] neg_lo:[0,1,0] neg_hi:[0,1,0]
buffer_load_dwordx4 a[212:215], v11, s[4:7], s58 offen offset:3072 sc1
v_pk_fma_f32 v[136:137], v[184:185], v[20:21], v[136:137] op_sel:[0,0,0] op_sel_hi:[1,0,1] neg_lo:[0,1,0] neg_hi:[0,1,0]
v_pk_fma_f32 v[138:139], v[186:187], v[20:21], v[138:139] op_sel:[0,0,0] op_sel_hi:[1,0,1] neg_lo:[0,1,0] neg_hi:[0,1,0]
v_pk_mul_f32 v[36:37], v[132:133], v[132:133] op_sel:[0,0] op_sel_hi:[1,1]
v_pk_mul_f32 v[38:39], v[134:135], v[134:135] op_sel:[0,0] op_sel_hi:[1,1]
v_pk_fma_f32 v[36:37], v[36:37], v[22:23], v[26:27] op_sel:[0,0,0] op_sel_hi:[1,0,0]
v_pk_fma_f32 v[38:39], v[38:39], v[22:23], v[26:27] op_sel:[0,0,0] op_sel_hi:[1,0,0]
v_pk_mul_f32 v[36:37], v[132:133], v[36:37] op_sel:[0,0] op_sel_hi:[1,1]
v_pk_mul_f32 v[38:39], v[134:135], v[38:39] op_sel:[0,0] op_sel_hi:[1,1]
v_pk_mul_f32 v[136:137], v[132:133], v[136:137] op_sel:[0,0] op_sel_hi:[1,1]
v_pk_mul_f32 v[138:139], v[134:135], v[138:139] op_sel:[0,0] op_sel_hi:[1,1]
v_exp_f32 v36, v36
v_exp_f32 v37, v37
v_exp_f32 v38, v38
v_exp_f32 v39, v39
v_pk_fma_f32 v[36:37], v[36:37], v[24:25], v[24:25] op_sel:[0,0,0] op_sel_hi:[1,0,0]
v_pk_fma_f32 v[38:39], v[38:39], v[24:25], v[24:25] op_sel:[0,0,0] op_sel_hi:[1,0,0]
v_rcp_f32 v36, v36
v_rcp_f32 v37, v37
v_rcp_f32 v38, v38
v_rcp_f32 v39, v39
v_pk_mul_f32 v[136:137], v[136:137], v[36:37] op_sel:[0,0] op_sel_hi:[1,1]
v_pk_mul_f32 v[138:139], v[138:139], v[38:39] op_sel:[0,0] op_sel_hi:[1,1]
v_cvt_pk_bf16_f32 v34, v136, v137
v_cvt_pk_bf16_f32 v35, v138, v139
buffer_store_dwordx4 v[32:35], v18, s[4:7], s23 offen offset:2048 sc1
s_waitcnt vmcnt(7)
s_barrier
s_cmp_lg_u32 s10, 0
s_cbranch_scc1 L_arr_14
v_mov_b32 v255, 1
s_mov_b32 s42, 32772
buffer_atomic_add v255, v5, s[4:7], s42 offen
L_arr_14:
s_load_dword s43, s[100:101], 0x8000 glc
s_mov_b32 s42, 200000
L_sp_15:
s_waitcnt lgkmcnt(0)
s_cmp_ge_u32 s43, s22
s_cbranch_scc1 L_spd_16
s_load_dword s43, s[100:101], 0x8000 glc
s_sub_u32 s42, s42, 1
s_cbranch_scc0 L_sp_15
s_waitcnt lgkmcnt(0)
L_spd_16:
s_mov_b32 s20, 0
buffer_load_dwordx4 v[124:127], v241, s[4:7], s20 offen offset:0 sc1
buffer_load_dwordx4 v[128:131], v242, s[4:7], s20 offen offset:0 sc1
buffer_load_dwordx4 v[132:135], v243, s[4:7], s20 offen offset:0 sc1
buffer_load_dwordx4 v[136:139], v240, s[4:7], s20 offen offset:0 sc1
buffer_load_dwordx4 v[140:143], v241, s[4:7], s20 offen offset:3072 sc1
buffer_load_dwordx4 v[144:147], v242, s[4:7], s20 offen offset:3072 sc1
s_waitcnt vmcnt(6)
s_add_u32 s40, s40, 16
s_barrier
s_cmp_lg_u32 s10, 0
s_cbranch_scc1 L_arr_17
v_mov_b32 v255, 1
s_mov_b32 s42, 0
buffer_atomic_add v255, v5, s[4:7], s42 offen
L_arr_17:
buffer_load_dwordx4 v[148:151], v243, s[4:7], s20 offen offset:3072 sc1
buffer_load_dwordx4 v[152:155], v240, s[4:7], s20 offen offset:3072 sc1
s_mov_b32 s20, 4096
buffer_load_dwordx4 v[156:159], v241, s[4:7], s20 offen offset:2048 sc1
buffer_load_dwordx4 v[160:163], v242, s[4:7], s20 offen offset:2048 sc1
buffer_load_dwordx4 v[164:167], v243, s[4:7], s20 offen offset:2048 sc1
s_load_dword s43, s[100:101], 0x8004 glc
buffer_load_dwordx4 v[168:171], v240, s[4:7], s20 offen offset:2048 sc1
v_permlane16_swap_b32 v228, v230
v_permlane16_swap_b32 v229, v231
v_permlane16_swap_b32 v232, v234
v_permlane16_swap_b32 v233, v235
v_permlane32_swap_b32 v228, v230
v_permlane32_swap_b32 v229, v231
v_permlane32_swap_b32 v232, v234
v_permlane32_swap_b32 v233, v235
L_unsw_18:
s_nop 0
v_lshlrev_b32 v44, 16, v228
v_and_b32 v45, 0xffff0000, v228
v_lshlrev_b32 v46, 16, v229
v_and_b32 v47, 0xffff0000, v229
v_lshlrev_b32 v48, 16, v230
v_and_b32 v49, 0xffff0000, v230
v_lshlrev_b32 v50, 16, v231
v_and_b32 v51, 0xffff0000, v231
v_lshlrev_b32 v52, 16, v232
v_and_b32 v53, 0xffff0000, v232
v_lshlrev_b32 v54, 16, v233
v_and_b32 v55, 0xffff0000, v233
v_lshlrev_b32 v56, 16, v234
v_and_b32 v57, 0xffff0000, v234
v_lshlrev_b32 v58, 16, v235
v_and_b32 v59, 0xffff0000, v235
v_lshlrev_b32 v60, 16, v236
v_and_b32 v61, 0xffff0000, v236
v_lshlrev_b32 v62, 16, v237
v_and_b32 v63, 0xffff0000, v237
s_waitcnt vmcnt(11)
v_mfma_f32_16x16x32_bf16 v[64:67], a[0:3], v[124:127], 0
v_mfma_f32_16x16x32_bf16 v[68:71], a[4:7], v[124:127], 0
v_mfma_f32_16x16x32_bf16 v[72:75], a[8:11], v[124:127], 0
v_mfma_f32_16x16x32_bf16 v[76:79], a[12:15], v[124:127], 0
s_mov_b32 s20, 8192
buffer_load_dwordx4 v[172:175], v241, s[4:7], s20 offen offset:1024 sc1
v_mfma_f32_16x16x32_bf16 v[80:83], a[16:19], v[124:127], 0
s_waitcnt vmcnt(11)
v_mfma_f32_16x16x32_bf16 v[84:87], a[0:3], v[128:131], 0
v_mfma_f32_16x16x32_bf16 v[88:91], a[4:7], v[128:131], 0
v_mfma_f32_16x16x32_bf16 v[92:95], a[8:11], v[128:131], 0
buffer_load_dwordx4 v[176:179], v242, s[4:7], s20 offen offset:1024 sc1
v_mfma_f32_16x16x32_bf16 v[96:99], a[12:15], v[128:131], 0
v_mfma_f32_16x16x32_bf16 v[100:103], a[16:19], v[128:131], 0
s_waitcnt vmcnt(11)
v_mfma_f32_16x16x32_bf16 v[104:107], a[0:3], v[132:135], 0
v_mfma_f32_16x16x32_bf16 v[108:111], a[4:7], v[132:135], 0
buffer_load_dwordx4 v[180:183], v243, s[4:7], s20 offen offset:1024 sc1
v_mfma_f32_16x16x32_bf16 v[112:115], a[8:11], v[132:135], 0
v_mfma_f32_16x16x32_bf16 v[116:119], a[12:15], v[132:135], 0
v_mfma_f32_16x16x32_bf16 v[120:123], a[16:19], v[132:135], 0
s_waitcnt vmcnt(11)
v_mfma_f32_16x16x32_bf16 v[44:47], a[0:3], v[136:139], v[44:47]
buffer_load_dwordx4 v[184:187], v240, s[4:7], s20 offen offset:1024 sc1
v_mfma_f32_16x16x32_bf16 v[48:51], a[4:7], v[136:139], v[48:51]
v_mfma_f32_16x16x32_bf16 v[52:55], a[8:11], v[136:139], v[52:55]
v_mfma_f32_16x16x32_bf16 v[56:59], a[12:15], v[136:139], v[56:59]
v_mfma_f32_16x16x32_bf16 v[60:63], a[16:19], v[136:139], v[60:63]
s_mov_b32 s42, 200000
L_sp_19:
s_waitcnt lgkmcnt(0)
s_cmp_ge_u32 s43, s22
s_cbranch_scc1 L_spd_20
s_load_dword s43, s[100:101], 0x8004 glc
s_sub_u32 s42, s42, 1
s_cbranch_scc0 L_sp_19
s_waitcnt lgkmcnt(0)
L_spd_20:
s_mov_b32 s20, 0
buffer_load_dwordx4 v[188:191], v241, s[4:7], s20 offen offset:1024 sc1
s_waitcnt vmcnt(12)
v_mfma_f32_16x16x32_bf16 v[64:67], a[20:23], v[140:143], v[64:67]
v_mfma_f32_16x16x32_bf16 v[68:71], a[24:27], v[140:143], v[68:71]
v_mfma_f32_16x16x32_bf16 v[72:75], a[28:31], v[140:143], v[72:75]
v_mfma_f32_16x16x32_bf16 v[76:79], a[32:35], v[140:143], v[76:79]
buffer_load_dwordx4 v[192:195], v242, s[4:7], s20 offen offset:1024 sc1
v_mfma_f32_16x16x32_bf16 v[80:83], a[36:39], v[140:143], v[80:83]
s_waitcnt vmcnt(12)
v_mfma_f32_16x16x32_bf16 v[84:87], a[20:23], v[144:147], v[84:87]
v_mfma_f32_16x16x32_bf16 v[88:91], a[24:27], v[144:147], v[88:91]
v_mfma_f32_16x16x32_bf16 v[92:95], a[28:31], v[144:147], v[92:95]
buffer_load_dwordx4 v[196:199], v243, s[4:7], s20 offen offset:1024 sc1
v_mfma_f32_16x16x32_bf16 v[96:99], a[32:35], v[144:147], v[96:99]
v_mfma_f32_16x16x32_bf16 v[100:103], a[36:39], v[144:147], v[100:103]
s_waitcnt vmcnt(12)
v_mfma_f32_16x16x32_bf16 v[104:107], a[20:23], v[148:151], v[104:107]
v_mfma_f32_16x16x32_bf16 v[108:111], a[24:27], v[148:151], v[108:111]
buffer_load_dwordx4 v[200:203], v240, s[4:7], s20 offen offset:1024 sc1
v_mfma_f32_16x16x32_bf16 v[112:115], a[28:31], v[148:151], v[112:115]
v_mfma_f32_16x16x32_bf16 v[116:119], a[32:35], v[148:151], v[116:119]
v_mfma_f32_16x16x32_bf16 v[120:123], a[36:39], v[148:151], v[120:123]
s_waitcnt vmcnt(12)
v_mfma_f32_16x16x32_bf16 v[44:47], a[20:23], v[152:155], v[44:47]
s_mov_b32 s20, 4096
buffer_load_dwordx4 v[124:127], v241, s[4:7], s20 offen offset:0 sc1
v_mfma_f32_16x16x32_bf16 v[48:51], a[24:27], v[152:155], v[48:51]
v_mfma_f32_16x16x32_bf16 v[52:55], a[28:31], v[152:155], v[52:55]
v_mfma_f32_16x16x32_bf16 v[56:59], a[32:35], v[152:155], v[56:59]
v_mfma_f32_16x16x32_bf16 v[60:63], a[36:39], v[152:155], v[60:63]
buffer_load_dwordx4 v[128:131], v242, s[4:7], s20 offen offset:0 sc1
s_waitcnt vmcnt(13)
v_mfma_f32_16x16x32_bf16 v[64:67], a[40:43], v[156:159], v[64:67]
s_mul_i32 s17, s12, 163840
v_mfma_f32_16x16x32_bf16 v[68:71], a[44:47], v[156:159], v[68:71]
v_mfma_f32_16x16x32_bf16 v[72:75], a[48:51], v[156:159], v[72:75]
v_mfma_f32_16x16x32_bf16 v[76:79], a[52:55], v[156:159], v[76:79]
buffer_load_dwordx4 v[132:135], v243, s[4:7], s20 offen offset:0 sc1
v_mfma_f32_16x16x32_bf16 v[80:83], a[56:59], v[156:159], v[80:83]
s_lshl_b32 s44, s10, 12
s_waitcnt vmcnt(13)
v_mfma_f32_16x16x32_bf16 v[84:87], a[40:43], v[160:163], v[84:87]
v_mfma_f32_16x16x32_bf16 v[88:91], a[44:47], v[160:163], v[88:91]
v_mfma_f32_16x16x32_bf16 v[92:95], a[48:51], v[160:163], v[92:95]
buffer_load_dwordx4 v[136:139], v240, s[4:7], s20 offen offset:0 sc1
v_mfma_f32_16x16x32_bf16 v[96:99], a[52:55], v[160:163], v[96:99]
s_add_u32 s17, s17, s44
v_mfma_f32_16x16x32_bf16 v[100:103], a[56:59], v[160:163], v[100:103]
s_waitcnt vmcnt(13)
v_mfma_f32_16x16x32_bf16 v[104:107], a[40:43], v[164:167], v[104:107]
v_mfma_f32_16x16x32_bf16 v[108:111], a[44:47], v[164:167], v[108:111]
buffer_load_dwordx4 v[140:143], v241, s[4:7], s20 offen offset:3072 sc1
v_mfma_f32_16x16x32_bf16 v[112:115], a[48:51], v[164:167], v[112:115]
s_add_u32 s17, s17, 0
v_mfma_f32_16x16x32_bf16 v[116:119], a[52:55], v[164:167], v[116:119]
v_mfma_f32_16x16x32_bf16 v[120:123], a[56:59], v[164:167], v[120:123]
s_waitcnt vmcnt(13)
v_mfma_f32_16x16x32_bf16 v[44:47], a[40:43], v[168:171], v[44:47]
buffer_load_dwordx4 v[144:147], v242, s[4:7], s20 offen offset:3072 sc1
v_mfma_f32_16x16x32_bf16 v[48:51], a[44:47], v[168:171], v[48:51]
v_add_u32 v8, s17, v2
v_mfma_f32_16x16x32_bf16 v[52:55], a[48:51], v[168:171], v[52:55]
v_mfma_f32_16x16x32_bf16 v[56:59], a[52:55], v[168:171], v[56:59]
v_mfma_f32_16x16x32_bf16 v[60:63], a[56:59], v[168:171], v[60:63]
buffer_load_dwordx4 v[148:151], v243, s[4:7], s20 offen offset:3072 sc1
s_waitcnt vmcnt(14)
v_mfma_f32_16x16x32_bf16 v[64:67], a[60:63], v[172:175], v[64:67]
s_mov_b32 s45, 0
v_mfma_f32_16x16x32_bf16 v[68:71], a[64:67], v[172:175], v[68:71]
v_mfma_f32_16x16x32_bf16 v[72:75], a[68:71], v[172:175], v[72:75]
v_mfma_f32_16x16x32_bf16 v[76:79], a[72:75], v[172:175], v[76:79]
s_load_dword s43, s[100:101], 0x0 glc
buffer_load_dwordx4 v[152:155], v240, s[4:7], s20 offen offset:3072 sc1
v_mfma_f32_16x16x32_bf16 v[80:83], a[76:79], v[172:175], v[80:83]
s_mov_b32 s32, s90
s_waitcnt vmcnt(14)
v_mfma_f32_16x16x32_bf16 v[84:87], a[60:63], v[176:179], v[84:87]
v_mfma_f32_16x16x32_bf16 v[88:91], a[64:67], v[176:179], v[88:91]
v_mfma_f32_16x16x32_bf16 v[92:95], a[68:71], v[176:179], v[92:95]
s_mov_b32 s20, 8192
buffer_load_dwordx4 v[156:159], v241, s[4:7], s20 offen offset:2048 sc1
v_mfma_f32_16x16x32_bf16 v[96:99], a[72:75], v[176:179], v[96:99]
s_mov_b32 s33, s91
v_mfma_f32_16x16x32_bf16 v[100:103], a[76:79], v[176:179], v[100:103]
s_waitcnt vmcnt(14)
v_mfma_f32_16x16x32_bf16 v[104:107], a[60:63], v[180:183], v[104:107]
v_mfma_f32_16x16x32_bf16 v[108:111], a[64:67], v[180:183], v[108:111]
buffer_load_dwordx4 v[160:163], v242, s[4:7], s20 offen offset:2048 sc1
v_mfma_f32_16x16x32_bf16 v[112:115], a[68:71], v[180:183], v[112:115]
s_mov_b32 s34, 2621440
v_mfma_f32_16x16x32_bf16 v[116:119], a[72:75], v[180:183], v[116:119]
v_mfma_f32_16x16x32_bf16 v[120:123], a[76:79], v[180:183], v[120:123]
s_waitcnt vmcnt(14)
v_mfma_f32_16x16x32_bf16 v[44:47], a[60:63], v[184:187], v[44:47]
buffer_load_dwordx4 v[164:167], v243, s[4:7], s20 offen offset:2048 sc1
v_mfma_f32_16x16x32_bf16 v[48:51], a[64:67], v[184:187], v[48:51]
s_mov_b32 s35, 0x20000
v_mfma_f32_16x16x32_bf16 v[52:55], a[68:71], v[184:187], v[52:55]
v_mfma_f32_16x16x32_bf16 v[56:59], a[72:75], v[184:187], v[56:59]
v_mfma_f32_16x16x32_bf16 v[60:63], a[76:79], v[184:187], v[60:63]
s_mov_b32 s58, 45056
buffer_load_dwordx4 a[216:219], v11, s[4:7], s58 offen offset:0 sc1
s_waitcnt vmcnt(15)
v_mfma_f32_16x16x32_bf16 v[64:67], a[80:83], v[188:191], v[64:67]
s_mul_i32 s19, s16, 20480
v_mfma_f32_16x16x32_bf16 v[68:71], a[84:87], v[188:191], v[68:71]
v_mfma_f32_16x16x32_bf16 v[72:75], a[88:91], v[188:191], v[72:75]
v_mfma_f32_16x16x32_bf16 v[76:79], a[92:95], v[188:191], v[76:79]
buffer_load_dwordx4 v[168:171], v240, s[4:7], s20 offen offset:2048 sc1
v_mfma_f32_16x16x32_bf16 v[80:83], a[96:99], v[188:191], v[80:83]
v_mul_u32_u24 v238, 1280, v3
s_waitcnt vmcnt(15)
v_mfma_f32_16x16x32_bf16 v[84:87], a[80:83], v[192:195], v[84:87]
v_mfma_f32_16x16x32_bf16 v[88:91], a[84:87], v[192:195], v[88:91]
v_mfma_f32_16x16x32_bf16 v[92:95], a[88:91], v[192:195], v[92:95]
s_mov_b32 s58, 56320
buffer_load_dwordx4 a[220:223], v11, s[4:7], s58 offen offset:0 sc1
v_mfma_f32_16x16x32_bf16 v[96:99], a[92:95], v[192:195], v[96:99]
v_add_u32 v238, s19, v238
v_mfma_f32_16x16x32_bf16 v[100:103], a[96:99], v[192:195], v[100:103]
s_waitcnt vmcnt(15)
v_mfma_f32_16x16x32_bf16 v[104:107], a[80:83], v[196:199], v[104:107]
v_mfma_f32_16x16x32_bf16 v[108:111], a[84:87], v[196:199], v[108:111]
buffer_load_dwordx4 a[224:227], v11, s[4:7], s58 offen offset:1024 sc1
v_mfma_f32_16x16x32_bf16 v[112:115], a[88:91], v[196:199], v[112:115]
v_lshrrev_b32 v239, 1, v4
v_mfma_f32_16x16x32_bf16 v[116:119], a[92:95], v[196:199], v[116:119]
v_mfma_f32_16x16x32_bf16 v[120:123], a[96:99], v[196:199], v[120:123]
s_waitcnt vmcnt(15)
v_mfma_f32_16x16x32_bf16 v[44:47], a[80:83], v[200:203], v[44:47]
buffer_load_dwordx4 a[228:231], v11, s[4:7], s58 offen offset:2048 sc1
v_mfma_f32_16x16x32_bf16 v[48:51], a[84:87], v[200:203], v[48:51]
v_lshl_add_u32 v239, v239, 4, v238
v_mfma_f32_16x16x32_bf16 v[52:55], a[88:91], v[200:203], v[52:55]
v_mfma_f32_16x16x32_bf16 v[56:59], a[92:95], v[200:203], v[56:59]
v_mfma_f32_16x16x32_bf16 v[60:63], a[96:99], v[200:203], v[60:63]
buffer_load_dwordx4 a[232:235], v11, s[4:7], s58 offen offset:3072 sc1
s_waitcnt vmcnt(16)
v_mfma_f32_16x16x32_bf16 v[64:67], a[100:103], v[124:127], v[64:67]
v_lshl_add_u32 v238, v4, 4, v238
v_mfma_f32_16x16x32_bf16 v[68:71], a[104:107], v[124:127], v[68:71]
v_mfma_f32_16x16x32_bf16 v[72:75], a[108:111], v[124:127], v[72:75]
v_mfma_f32_16x16x32_bf16 v[76:79], a[112:115], v[124:127], v[76:79]
s_mov_b32 s58, 60416
buffer_load_dwordx4 a[236:239], v11, s[4:7], s58 offen offset:0 sc1
v_mfma_f32_16x16x32_bf16 v[80:83], a[116:119], v[124:127], v[80:83]
v_and_b32 v250, 1, v4
s_waitcnt vmcnt(16)
v_mfma_f32_16x16x32_bf16 v[84:87], a[100:103], v[128:131], v[84:87]
v_mfma_f32_16x16x32_bf16 v[88:91], a[104:107], v[128:131], v[88:91]
v_mfma_f32_16x16x32_bf16 v[92:95], a[108:111], v[128:131], v[92:95]
s_mov_b32 s42, 200000
L_sp_21:
s_waitcnt lgkmcnt(0)
s_cmp_ge_u32 s43, s40
s_cbranch_scc1 L_spd_22
s_load_dword s43, s[100:101], 0x0 glc
s_sub_u32 s42, s42, 1
s_cbranch_scc0 L_sp_21
s_waitcnt lgkmcnt(0)
L_spd_22:
s_mov_b32 s20, 0
buffer_load_dwordx4 v[172:175], v241, s[4:7], s20 offen offset:2048 sc1
v_mfma_f32_16x16x32_bf16 v[96:99], a[112:115], v[128:131], v[96:99]
v_lshl_add_u32 v239, v250, 30, v239
v_mfma_f32_16x16x32_bf16 v[100:103], a[116:119], v[128:131], v[100:103]
s_waitcnt vmcnt(16)
v_mfma_f32_16x16x32_bf16 v[104:107], a[100:103], v[132:135], v[104:107]
v_mfma_f32_16x16x32_bf16 v[108:111], a[104:107], v[132:135], v[108:111]
s_mov_b32 s20, 4096
buffer_load_dwordx4 v[176:179], v241, s[4:7], s20 offen offset:1024 sc1
v_mfma_f32_16x16x32_bf16 v[112:115], a[108:111], v[132:135], v[112:115]
s_lshl_b32 s30, s30, 5
v_mfma_f32_16x16x32_bf16 v[116:119], a[112:115], v[132:135], v[116:119]
v_mfma_f32_16x16x32_bf16 v[120:123], a[116:119], v[132:135], v[120:123]
s_waitcnt vmcnt(16)
v_mfma_f32_16x16x32_bf16 v[44:47], a[100:103], v[136:139], v[44:47]
s_mov_b32 s20, 8192
buffer_load_dwordx4 v[180:183], v241, s[4:7], s20 offen offset:0 sc1
v_mfma_f32_16x16x32_bf16 v[48:51], a[104:107], v[136:139], v[48:51]
s_lshl_b32 s29, s29, 5
v_mfma_f32_16x16x32_bf16 v[52:55], a[108:111], v[136:139], v[52:55]
v_mfma_f32_16x16x32_bf16 v[56:59], a[112:115], v[136:139], v[56:59]
v_mfma_f32_16x16x32_bf16 v[60:63], a[116:119], v[136:139], v[60:63]
buffer_load_dwordx4 v[184:187], v241, s[4:7], s20 offen offset:3072 sc1
s_waitcnt vmcnt(17)
v_mfma_f32_16x16x32_bf16 v[64:67], a[120:123], v[140:143], v[64:67]
v_mfma_f32_16x16x32_bf16 v[68:71], a[124:127], v[140:143], v[68:71]
v_mfma_f32_16x16x32_bf16 v[72:75], a[128:131], v[140:143], v[72:75]
v_mfma_f32_16x16x32_bf16 v[76:79], a[132:135], v[140:143], v[76:79]
s_mov_b32 s20, 0
buffer_load_dwordx4 v[188:191], v242, s[4:7], s20 offen offset:2048 sc1
v_mfma_f32_16x16x32_bf16 v[80:83], a[136:139], v[140:143], v[80:83]
s_waitcnt vmcnt(17)
v_mfma_f32_16x16x32_bf16 v[84:87], a[120:123], v[144:147], v[84:87]
v_mfma_f32_16x16x32_bf16 v[88:91], a[124:127], v[144:147], v[88:91]
v_mfma_f32_16x16x32_bf16 v[92:95], a[128:131], v[144:147], v[92:95]
s_mov_b32 s20, 4096
buffer_load_dwordx4 v[192:195], v242, s[4:7], s20 offen offset:1024 sc1
v_mfma_f32_16x16x32_bf16 v[96:99], a[132:135], v[144:147], v[96:99]
v_mfma_f32_16x16x32_bf16 v[100:103], a[136:139], v[144:147], v[100:103]
s_waitcnt vmcnt(17)
v_mfma_f32_16x16x32_bf16 v[104:107], a[120:123], v[148:151], v[104:107]
v_mfma_f32_16x16x32_bf16 v[108:111], a[124:127], v[148:151], v[108:111]
s_mov_b32 s20, 8192
buffer_load_dwordx4 v[196:199], v242, s[4:7], s20 offen offset:0 sc1
v_mfma_f32_16x16x32_bf16 v[112:115], a[128:131], v[148:151], v[112:115]
v_mfma_f32_16x16x32_bf16 v[116:119], a[132:135], v[148:151], v[116:119]
v_mfma_f32_16x16x32_bf16 v[120:123], a[136:139], v[148:151], v[120:123]
s_waitcnt vmcnt(17)
v_mfma_f32_16x16x32_bf16 v[44:47], a[120:123], v[152:155], v[44:47]
buffer_load_dwordx4 v[200:203], v242, s[4:7], s20 offen offset:3072 sc1
v_mfma_f32_16x16x32_bf16 v[48:51], a[124:127], v[152:155], v[48:51]
v_mfma_f32_16x16x32_bf16 v[52:55], a[128:131], v[152:155], v[52:55]
v_mfma_f32_16x16x32_bf16 v[56:59], a[132:135], v[152:155], v[56:59]
v_mfma_f32_16x16x32_bf16 v[60:63], a[136:139], v[152:155], v[60:63]
s_mov_b32 s20, 0
buffer_load_dwordx4 v[124:127], v243, s[4:7], s20 offen offset:2048 sc1
s_waitcnt vmcnt(18)
v_mfma_f32_16x16x32_bf16 v[64:67], a[140:143], v[156:159], v[64:67]
v_mfma_f32_16x16x32_bf16 v[68:71], a[144:147], v[156:159], v[68:71]
v_mfma_f32_16x16x32_bf16 v[72:75], a[148:151], v[156:159], v[72:75]
v_mfma_f32_16x16x32_bf16 v[76:79], a[152:155], v[156:159], v[76:79]
s_mov_b32 s20, 4096
buffer_load_dwordx4 v[128:131], v243, s[4:7], s20 offen offset:1024 sc1
v_mfma_f32_16x16x32_bf16 v[80:83], a[156:159], v[156:159], v[80:83]
s_waitcnt vmcnt(18)
v_mfma_f32_16x16x32_bf16 v[84:87], a[140:143], v[160:163], v[84:87]
v_mfma_f32_16x16x32_bf16 v[88:91], a[144:147], v[160:163], v[88:91]
v_mfma_f32_16x16x32_bf16 v[92:95], a[148:151], v[160:163], v[92:95]
s_mov_b32 s20, 8192
buffer_load_dwordx4 v[132:135], v243, s[4:7], s20 offen offset:0 sc1
v_mfma_f32_16x16x32_bf16 v[96:99], a[152:155], v[160:163], v[96:99]
v_mfma_f32_16x16x32_bf16 v[100:103], a[156:159], v[160:163], v[100:103]
s_waitcnt vmcnt(18)
v_mfma_f32_16x16x32_bf16 v[104:107], a[140:143], v[164:167], v[104:107]
v_mfma_f32_16x16x32_bf16 v[108:111], a[144:147], v[164:167], v[108:111]
buffer_load_dwordx4 v[136:139], v243, s[4:7], s20 offen offset:3072 sc1
v_mfma_f32_16x16x32_bf16 v[112:115], a[148:151], v[164:167], v[112:115]
v_mfma_f32_16x16x32_bf16 v[116:119], a[152:155], v[164:167], v[116:119]
v_mfma_f32_16x16x32_bf16 v[120:123], a[156:159], v[164:167], v[120:123]
s_waitcnt vmcnt(17)
v_mfma_f32_16x16x32_bf16 v[44:47], a[140:143], v[168:171], v[44:47]
s_mov_b32 s20, 0
buffer_load_dwordx4 v[140:143], v240, s[4:7], s20 offen offset:2048 sc1
v_mfma_f32_16x16x32_bf16 v[48:51], a[144:147], v[168:171], v[48:51]
v_mfma_f32_16x16x32_bf16 v[52:55], a[148:151], v[168:171], v[52:55]
v_mfma_f32_16x16x32_bf16 v[56:59], a[152:155], v[168:171], v[56:59]
v_mfma_f32_16x16x32_bf16 v[60:63], a[156:159], v[168:171], v[60:63]
s_mov_b32 s20, 4096
buffer_load_dwordx4 v[144:147], v240, s[4:7], s20 offen offset:1024 sc1
s_waitcnt vmcnt(13)
v_mfma_f32_16x16x32_bf16 v[64:67], a[160:163], v[172:175], v[64:67]
v_mfma_f32_16x16x32_bf16 v[68:71], a[164:167], v[172:175], v[68:71]
v_mfma_f32_16x16x32_bf16 v[72:75], a[168:171], v[172:175], v[72:75]
v_mfma_f32_16x16x32_bf16 v[76:79], a[172:175], v[172:175], v[76:79]
s_mov_b32 s20, 8192
buffer_load_dwordx4 v[148:151], v240, s[4:7], s20 offen offset:0 sc1
v_mfma_f32_16x16x32_bf16 v[80:83], a[176:179], v[172:175], v[80:83]
s_waitcnt vmcnt(13)
v_mfma_f32_16x16x32_bf16 v[64:67], a[180:183], v[176:179], v[64:67]
v_mfma_f32_16x16x32_bf16 v[68:71], a[184:187], v[176:179], v[68:71]
v_mfma_f32_16x16x32_bf16 v[72:75], a[188:191], v[176:179], v[72:75]
buffer_load_dwordx4 v[152:155], v240, s[4:7], s20 offen offset:3072 sc1
v_mfma_f32_16x16x32_bf16 v[76:79], a[192:195], v[176:179], v[76:79]
v_mfma_f32_16x16x32_bf16 v[80:83], a[196:199], v[176:179], v[80:83]
s_waitcnt vmcnt(13)
v_mfma_f32_16x16x32_bf16 v[64:67], a[200:203], v[180:183], v[64:67]
v_mfma_f32_16x16x32_bf16 v[68:71], a[204:207], v[180:183], v[68:71]
v_mfma_f32_16x16x32_bf16 v[72:75], a[208:211], v[180:183], v[72:75]
v_mfma_f32_16x16x32_bf16 v[76:79], a[212:215], v[180:183], v[76:79]
v_mfma_f32_16x16x32_bf16 v[80:83], a[216:219], v[180:183], v[80:83]
s_waitcnt vmcnt(12)
v_mfma_f32_16x16x32_bf16 v[64:67], a[220:223], v[184:187], v[64:67]
v_mfma_f32_16x16x32_bf16 v[68:71], a[224:227], v[184:187], v[68:71]
v_mfma_f32_16x16x32_bf16 v[72:75], a[228:231], v[184:187], v[72:75]
v_mfma_f32_16x16x32_bf16 v[76:79], a[232:235], v[184:187], v[76:79]
v_mfma_f32_16x16x32_bf16 v[80:83], a[236:239], v[184:187], v[80:83]
s_waitcnt vmcnt(11)
v_mfma_f32_16x16x32_bf16 v[84:87], a[160:163], v[188:191], v[84:87]
v_mfma_f32_16x16x32_bf16 v[88:91], a[164:167], v[188:191], v[88:91]
s_nop 0
ds_write_b128 v244, v[64:67] offset:0
ds_write_b128 v244, v[68:71] offset:1024
v_mfma_f32_16x16x32_bf16 v[92:95], a[168:171], v[188:191], v[92:95]
ds_write_b128 v244, v[72:75] offset:2048
ds_write_b128 v244, v[76:79] offset:3072
ds_write_b128 v244, v[80:83] offset:4096
v_mfma_f32_16x16x32_bf16 v[96:99], a[172:175], v[188:191], v[96:99]
v_mfma_f32_16x16x32_bf16 v[100:103], a[176:179], v[188:191], v[100:103]
s_waitcnt vmcnt(10)
v_mfma_f32_16x16x32_bf16 v[84:87], a[180:183], v[192:195], v[84:87]
s_waitcnt lgkmcnt(0)
s_barrier
ds_read_b128 v[204:207], v245 offset:0
ds_read_b128 v[208:211], v245 offset:1024
ds_read_b128 v[212:215], v245 offset:2048
ds_read_b128 v[216:219], v245 offset:3072
ds_read_b128 v[220:223], v245 offset:4096
v_mfma_f32_16x16x32_bf16 v[88:91], a[184:187], v[192:195], v[88:91]
v_mfma_f32_16x16x32_bf16 v[92:95], a[188:191], v[192:195], v[92:95]
v_mfma_f32_16x16x32_bf16 v[96:99], a[192:195], v[192:195], v[96:99]
v_mfma_f32_16x16x32_bf16 v[100:103], a[196:199], v[192:195], v[100:103]
s_waitcnt vmcnt(9)
v_mfma_f32_16x16x32_bf16 v[84:87], a[200:203], v[196:199], v[84:87]
v_mfma_f32_16x16x32_bf16 v[88:91], a[204:207], v[196:199], v[88:91]
v_mfma_f32_16x16x32_bf16 v[92:95], a[208:211], v[196:199], v[92:95]
v_mfma_f32_16x16x32_bf16 v[96:99], a[212:215], v[196:199], v[96:99]
v_mfma_f32_16x16x32_bf16 v[100:103], a[216:219], v[196:199], v[100:103]
s_waitcnt vmcnt(8)
v_mfma_f32_16x16x32_bf16 v[84:87], a[220:223], v[200:203], v[84:87]
v_mfma_f32_16x16x32_bf16 v[88:91], a[224:227], v[200:203], v[88:91]
v_mfma_f32_16x16x32_bf16 v[92:95], a[228:231], v[200:203], v[92:95]
v_mfma_f32_16x16x32_bf16 v[96:99], a[232:235], v[200:203], v[96:99]
v_mfma_f32_16x16x32_bf16 v[100:103], a[236:239], v[200:203], v[100:103]
s_waitcnt vmcnt(7)
v_mfma_f32_16x16x32_bf16 v[104:107], a[160:163], v[124:127], v[104:107]
v_mfma_f32_16x16x32_bf16 v[108:111], a[164:167], v[124:127], v[108:111]
s_waitcnt lgkmcnt(4)
v_add_f32 v84, v84, v204
v_mfma_f32_16x16x32_bf16 v[112:115], a[168:171], v[124:127], v[112:115]
v_add_f32 v85, v85, v205
v_add_f32 v86, v86, v206
v_add_f32 v87, v87, v207
v_mfma_f32_16x16x32_bf16 v[116:119], a[172:175], v[124:127], v[116:119]
ds_write_b128 v244, v[84:87] offset:5120
s_waitcnt lgkmcnt(4)
v_add_f32 v88, v88, v208
v_mfma_f32_16x16x32_bf16 v[120:123], a[176:179], v[124:127], v[120:123]
v_add_f32 v89, v89, v209
v_add_f32 v90, v90, v210
v_add_f32 v91, v91, v211
s_waitcnt vmcnt(6)
v_mfma_f32_16x16x32_bf16 v[104:107], a[180:183], v[128:131], v[104:107]
ds_write_b128 v244, v[88:91] offset:6144
s_waitcnt lgkmcnt(4)
v_add_f32 v92, v92, v212
v_mfma_f32_16x16x32_bf16 v[108:111], a[184:187], v[128:131], v[108:111]
v_add_f32 v93, v93, v213
v_add_f32 v94, v94, v214
v_add_f32 v95, v95, v215
v_mfma_f32_16x16x32_bf16 v[112:115], a[188:191], v[128:131], v[112:115]
ds_write_b128 v244, v[92:95] offset:7168
s_waitcnt lgkmcnt(4)
v_add_f32 v96, v96, v216
v_mfma_f32_16x16x32_bf16 v[116:119], a[192:195], v[128:131], v[116:119]
v_add_f32 v97, v97, v217
v_add_f32 v98, v98, v218
v_add_f32 v99, v99, v219
v_mfma_f32_16x16x32_bf16 v[120:123], a[196:199], v[128:131], v[120:123]
ds_write_b128 v244, v[96:99] offset:8192
s_waitcnt lgkmcnt(4)
v_add_f32 v100, v100, v220
s_waitcnt vmcnt(5)
v_mfma_f32_16x16x32_bf16 v[104:107], a[200:203], v[132:135], v[104:107]
v_add_f32 v101, v101, v221
v_add_f32 v102, v102, v222
v_add_f32 v103, v103, v223
v_mfma_f32_16x16x32_bf16 v[108:111], a[204:207], v[132:135], v[108:111]
ds_write_b128 v244, v[100:103] offset:9216
v_mfma_f32_16x16x32_bf16 v[112:115], a[208:211], v[132:135], v[112:115]
v_mfma_f32_16x16x32_bf16 v[116:119], a[212:215], v[132:135], v[116:119]
v_mfma_f32_16x16x32_bf16 v[120:123], a[216:219], v[132:135], v[120:123]
s_waitcnt lgkmcnt(0)
s_barrier
ds_read_b128 v[204:207], v245 offset:5120
ds_read_b128 v[208:211], v245 offset:6144
ds_read_b128 v[212:215], v245 offset:7168
ds_read_b128 v[216:219], v245 offset:8192
ds_read_b128 v[220:223], v245 offset:9216
s_waitcnt vmcnt(4)
v_mfma_f32_16x16x32_bf16 v[104:107], a[220:223], v[136:139], v[104:107]
v_mfma_f32_16x16x32_bf16 v[108:111], a[224:227], v[136:139], v[108:111]
v_mfma_f32_16x16x32_bf16 v[112:115], a[228:231], v[136:139], v[112:115]
v_mfma_f32_16x16x32_bf16 v[116:119], a[232:235], v[136:139], v[116:119]
v_mfma_f32_16x16x32_bf16 v[120:123], a[236:239], v[136:139], v[120:123]
s_waitcnt vmcnt(3)
v_mfma_f32_16x16x32_bf16 v[44:47], a[160:163], v[140:143], v[44:47]
v_mfma_f32_16x16x32_bf16 v[48:51], a[164:167], v[140:143], v[48:51]
s_waitcnt lgkmcnt(4)
v_add_f32 v104, v104, v204
v_mfma_f32_16x16x32_bf16 v[52:55], a[168:171], v[140:143], v[52:55]
v_add_f32 v105, v105, v205
v_add_f32 v106, v106, v206
v_add_f32 v107, v107, v207
v_mfma_f32_16x16x32_bf16 v[56:59], a[172:175], v[140:143], v[56:59]
ds_write_b128 v244, v[104:107] offset:0
s_waitcnt lgkmcnt(4)
v_add_f32 v108, v108, v208
v_mfma_f32_16x16x32_bf16 v[60:63], a[176:179], v[140:143], v[60:63]
v_add_f32 v109, v109, v209
v_add_f32 v110, v110, v210
v_add_f32 v111, v111, v211
s_waitcnt vmcnt(2)
v_mfma_f32_16x16x32_bf16 v[44:47], a[180:183], v[144:147], v[44:47]
ds_write_b128 v244, v[108:111] offset:1024
s_waitcnt lgkmcnt(4)
v_add_f32 v112, v112, v212
v_mfma_f32_16x16x32_bf16 v[48:51], a[184:187], v[144:147], v[48:51]
v_add_f32 v113, v113, v213
v_add_f32 v114, v114, v214
v_add_f32 v115, v115, v215
v_mfma_f32_16x16x32_bf16 v[52:55], a[188:191], v[144:147], v[52:55]
ds_write_b128 v244, v[112:115] offset:2048
s_waitcnt lgkmcnt(4)
v_add_f32 v116, v116, v216
v_mfma_f32_16x16x32_bf16 v[56:59], a[192:195], v[144:147], v[56:59]
v_add_f32 v117, v117, v217
v_add_f32 v118, v118, v218
v_add_f32 v119, v119, v219
v_mfma_f32_16x16x32_bf16 v[60:63], a[196:199], v[144:147], v[60:63]
ds_write_b128 v244, v[116:119] offset:3072
s_waitcnt lgkmcnt(4)
v_add_f32 v120, v120, v220
s_waitcnt vmcnt(1)
v_mfma_f32_16x16x32_bf16 v[44:47], a[200:203], v[148:151], v[44:47]
v_add_f32 v121, v121, v221
v_add_f32 v122, v122, v222
v_add_f32 v123, v123, v223
v_mfma_f32_16x16x32_bf16 v[48:51], a[204:207], v[148:151], v[48:51]
ds_write_b128 v244, v[120:123] offset:4096
v_mfma_f32_16x16x32_bf16 v[52:55], a[208:211], v[148:151], v[52:55]
v_mfma_f32_16x16x32_bf16 v[56:59], a[212:215], v[148:151], v[56:59]
v_mfma_f32_16x16x32_bf16 v[60:63], a[216:219], v[148:151], v[60:63]
s_waitcnt lgkmcnt(0)
s_barrier
ds_read_b128 v[204:207], v245 offset:0
ds_read_b128 v[208:211], v245 offset:1024
ds_read_b128 v[212:215], v245 offset:2048
ds_read_b128 v[216:219], v245 offset:3072
ds_read_b128 v[220:223], v245 offset:4096
s_waitcnt vmcnt(0)
v_mfma_f32_16x16x32_bf16 v[44:47], a[220:223], v[152:155], v[44:47]
v_mfma_f32_16x16x32_bf16 v[48:51], a[224:227], v[152:155], v[48:51]
v_mfma_f32_16x16x32_bf16 v[52:55], a[228:231], v[152:155], v[52:55]
v_mfma_f32_16x16x32_bf16 v[56:59], a[232:235], v[152:155], v[56:59]
v_mfma_f32_16x16x32_bf16 v[60:63], a[236:239], v[152:155], v[60:63]
s_mov_b32 s28, 9043968
s_waitcnt lgkmcnt(4)
s_nop 1
v_pk_add_f32 v[44:45], v[44:45], v[204:205] op_sel:[0,0] op_sel_hi:[1,1]
v_pk_add_f32 v[46:47], v[46:47], v[206:207] op_sel:[0,0] op_sel_hi:[1,1]
s_waitcnt lgkmcnt(3)
v_pk_add_f32 v[48:49], v[48:49], v[208:209] op_sel:[0,0] op_sel_hi:[1,1]
v_pk_add_f32 v[50:51], v[50:51], v[210:211] op_sel:[0,0] op_sel_hi:[1,1]
s_waitcnt lgkmcnt(2)
v_pk_add_f32 v[52:53], v[52:53], v[212:213] op_sel:[0,0] op_sel_hi:[1,1]
v_pk_add_f32 v[54:55], v[54:55], v[214:215] op_sel:[0,0] op_sel_hi:[1,1]
s_waitcnt lgkmcnt(1)
v_pk_add_f32 v[56:57], v[56:57], v[216:217] op_sel:[0,0] op_sel_hi:[1,1]
v_pk_add_f32 v[58:59], v[58:59], v[218:219] op_sel:[0,0] op_sel_hi:[1,1]
s_waitcnt lgkmcnt(0)
v_pk_add_f32 v[60:61], v[60:61], v[220:221] op_sel:[0,0] op_sel_hi:[1,1]
v_pk_add_f32 v[62:63], v[62:63], v[222:223] op_sel:[0,0] op_sel_hi:[1,1]
v_cvt_pk_bf16_f32 v228, v44, v45
v_cvt_pk_bf16_f32 v229, v46, v47
v_cvt_pk_bf16_f32 v230, v48, v49
v_cvt_pk_bf16_f32 v231, v50, v51
v_cvt_pk_bf16_f32 v232, v52, v53
v_cvt_pk_bf16_f32 v233, v54, v55
v_cvt_pk_bf16_f32 v234, v56, v57
v_cvt_pk_bf16_f32 v235, v58, v59
v_cvt_pk_bf16_f32 v236, v60, v61
v_cvt_pk_bf16_f32 v237, v62, v63
s_cmp_lg_u32 s15, 0
s_cbranch_scc1 L_final
v_mov_b32 v28, v236
v_mov_b32 v29, v237
v_mov_b32 v30, v236
v_mov_b32 v31, v237
v_permlane32_swap_b32 v228, v230
v_permlane32_swap_b32 v229, v231
s_nop 0
v_permlane16_swap_b32 v228, v230
v_permlane16_swap_b32 v229, v231
buffer_store_dwordx4 v[228:231], v246, s[4:7], s28 offen sc1
v_permlane32_swap_b32 v232, v234
v_permlane32_swap_b32 v233, v235
s_nop 0
v_permlane16_swap_b32 v232, v234
v_permlane16_swap_b32 v233, v235
v_permlane16_swap_b32 v28, v30
v_permlane16_swap_b32 v29, v31
buffer_store_dwordx4 v[232:235], v246, s[4:7], s28 offen offset:1024 sc1
buffer_store_dwordx4 v[28:31], v248, s[4:7], s28 offen sc1
s_mov_b32 s24, 0x3f803f80
v_mov_b32 v24, 0
v_mov_b32 v25, 0
v_mov_b32 v26, 0
v_mov_b32 v27, 0
v_dot2c_f32_bf16 v24, s24, v228
v_dot2c_f32_bf16 v25, v228, v228
v_dot2c_f32_bf16 v26, s24, v229
v_dot2c_f32_bf16 v27, v229, v229
v_dot2c_f32_bf16 v24, s24, v230
v_dot2c_f32_bf16 v25, v230, v230
v_dot2c_f32_bf16 v26, s24, v231
v_dot2c_f32_bf16 v27, v231, v231
v_dot2c_f32_bf16 v24, s24, v232
v_dot2c_f32_bf16 v25, v232, v232
v_dot2c_f32_bf16 v26, s24, v233
v_dot2c_f32_bf16 v27, v233, v233
v_dot2c_f32_bf16 v24, s24, v234
v_dot2c_f32_bf16 v25, v234, v234
v_dot2c_f32_bf16 v26, s24, v235
v_dot2c_f32_bf16 v27, v235, v235
v_dot2c_f32_bf16 v24, s24, v236
v_dot2c_f32_bf16 v25, v236, v236
v_dot2c_f32_bf16 v26, s24, v237
v_dot2c_f32_bf16 v27, v237, v237
s_nop 2
v_pk_add_f32 v[26:27], v[26:27], v[24:25] op_sel:[0,0] op_sel_hi:[1,1]
v_mov_b32 v24, v26
v_mov_b32 v25, v27
s_nop 0
v_permlane16_swap_b32 v26, v24
v_permlane16_swap_b32 v27, v25
v_pk_add_f32 v[26:27], v[26:27], v[24:25] op_sel:[0,0] op_sel_hi:[1,1]
v_mov_b32 v24, v26
v_mov_b32 v25, v27
s_nop 0
v_permlane32_swap_b32 v26, v24
v_permlane32_swap_b32 v27, v25
v_pk_add_f32 v[26:27], v[26:27], v[24:25] op_sel:[0,0] op_sel_hi:[1,1]
buffer_store_dwordx2 v[26:27], v249, s[4:7], 0 offen sc1
s_add_u32 s15, s15, 14475264
s_lshl_b32 s16, s11, 3
s_lshl_b32 s17, s10, 1
s_add_u32 s16, s16, s17
s_mul_i32 s19, s16, 20480
s_add_u32 s19, s19, s15
s_add_u32 s17, s19, 9744384
v_add_u32 v12, s17, v2
v_add_u32 v13, 20480, v12
v_add_u32 v14, 0x10000, v2
v_lshlrev_b32 v196, 3, v3
v_lshl_add_u32 v196, v4, 8, v196
s_lshl_b32 s17, s16, 10
s_add_u32 m0, s44, s45
s_nop 0
buffer_load_dwordx4 v8, s[4:7], s45 offen offset:0 sc1 lds
s_add_u32 s17, s17, s15
s_add_u32 s17, s17, 12365824
v_add_u32 v16, s17, v196
v_cmp_lt_u32 s[26:27], v3, 8
v_add_u32 v15, 0x20000, v2
s_lshr_b32 s17, s12, 2
s_mul_i32 s17, s17, 5120
s_add_u32 s19, s19, s17
s_add_u32 s19, s19, 12554240
s_and_b32 s17, s12, 3
s_lshl_b32 s18, s17, 10
s_add_u32 s18, s18, s19
buffer_load_dwordx4 v8, s[4:7], s45 offen offset:1024 sc1 lds
v_add_u32 v19, s18, v2
s_lshl_b32 s17, s17, 8
s_add_u32 s17, s17, s19
s_add_u32 s17, s17, 4096
v_add_u32 v20, s17, v2
v_mov_b32 v198, 0x40000000
v_cmp_gt_u32 vcc, 16, v1
s_nop 1
v_cndmask_b32 v20, v198, v20, vcc
s_lshl_b32 s17, s12, 7
s_add_u32 s17, s17, 9711616
v_lshl_add_u32 v34, v0, 11, s17
v_cmp_gt_u32 vcc, 16, v0
buffer_load_dwordx4 v8, s[4:7], s45 offen offset:2048 sc1 lds
s_nop 0
v_cndmask_b32 v34, v198, v34, vcc
v_add_u32 v201, 15360, v2
s_mul_i32 s19, s10, 3584
s_add_u32 s19, s19, 0
s_add_u32 s17, s19, 3200
v_lshl_add_u32 v196, v4, 2, 0
v_add_u32 v197, -8, v3
v_cmp_le_u32 vcc, 20, v196
s_nop 1
v_cndmask_b32 v198, 0, 20, vcc
v_sub_u32 v199, v197, v198
v_sub_u32 v198, v196, v198
v_cmp_gt_u32 vcc, 20, v199
buffer_load_dwordx4 v8, s[4:7], s45 offen offset:3072 sc1 lds
s_add_u32 s45, s45, 16384
v_mad_i32_i24 v198, v197, 20, v198
v_lshl_add_u32 v198, v198, 2, s19
v_cndmask_b32 v24, v201, v198, vcc
v_cmp_eq_u32 vcc, 0, v3
v_lshl_add_u32 v198, v196, 2, s17
s_nop 0
v_cndmask_b32 v24, v24, v198, vcc
v_lshl_add_u32 v196, v4, 2, 0
v_add_u32 v197, 8, v3
v_cmp_le_u32 vcc, 20, v196
s_nop 1
v_cndmask_b32 v198, 0, 20, vcc
v_sub_u32 v199, v197, v198
v_sub_u32 v198, v196, v198
s_add_u32 m0, s44, s45
s_nop 0
buffer_load_dwordx4 v8, s[4:7], s45 offen offset:0 sc1 lds
v_cmp_gt_u32 vcc, 20, v199
v_mad_i32_i24 v198, v197, 20, v198
v_lshl_add_u32 v198, v198, 2, s19
v_cndmask_b32 v25, v201, v198, vcc
v_lshl_add_u32 v196, v4, 2, 16
v_add_u32 v197, -8, v3
v_cmp_le_u32 vcc, 20, v196
s_nop 1
v_cndmask_b32 v198, 0, 20, vcc
v_sub_u32 v199, v197, v198
v_sub_u32 v198, v196, v198
v_cmp_gt_u32 vcc, 20, v199
v_mad_i32_i24 v198, v197, 20, v198
buffer_load_dwordx4 v8, s[4:7], s45 offen offset:1024 sc1 lds
v_lshl_add_u32 v198, v198, 2, s19
v_cndmask_b32 v26, v201, v198, vcc
v_cmp_eq_u32 vcc, 0, v3
v_lshl_add_u32 v198, v196, 2, s17
s_nop 0
v_cndmask_b32 v26, v26, v198, vcc
v_lshl_add_u32 v196, v4, 2, 16
v_add_u32 v197, 8, v3
v_cmp_le_u32 vcc, 20, v196
s_nop 1
v_cndmask_b32 v198, 0, 20, vcc
v_sub_u32 v199, v197, v198
v_sub_u32 v198, v196, v198
v_cmp_gt_u32 vcc, 20, v199
buffer_load_dwordx4 v8, s[4:7], s45 offen offset:2048 sc1 lds
v_mad_i32_i24 v198, v197, 20, v198
v_lshl_add_u32 v198, v198, 2, s19
v_cndmask_b32 v27, v201, v198, vcc
v_lshl_add_u32 v196, v4, 2, 16
v_add_u32 v197, 24, v3
v_cmp_le_u32 vcc, 20, v196
s_nop 1
v_cndmask_b32 v198, 0, 20, vcc
v_sub_u32 v199, v197, v198
v_sub_u32 v198, v196, v198
v_cmp_gt_u32 vcc, 20, v199
v_mad_i32_i24 v198, v197, 20, v198
v_lshl_add_u32 v198, v198, 2, s19
buffer_load_dwordx4 v8, s[4:7], s45 offen offset:3072 sc1 lds
s_add_u32 s45, s45, 16384
v_cndmask_b32 v28, v201, v198, vcc
v_lshl_add_u32 v196, v4, 2, 32
v_add_u32 v197, -8, v3
v_cmp_le_u32 vcc, 20, v196
s_nop 1
v_cndmask_b32 v198, 0, 20, vcc
v_sub_u32 v199, v197, v198
v_sub_u32_e64 v198, v196, v198
v_cmp_gt_u32 vcc, 20, v199
v_mad_i32_i24 v198, v197, 20, v198
v_lshl_add_u32 v198, v198, 2, s19
v_cndmask_b32 v29, v201, v198, vcc
v_cmp_eq_u32 vcc, 0, v3
s_add_u32 m0, s44, s45
s_nop 0
buffer_load_dwordx4 v8, s[4:7], s45 offen offset:0 sc1 lds
v_lshl_add_u32 v198, v196, 2, s17
v_cndmask_b32 v29, v29, v198, vcc
v_cmp_gt_u32 vcc, 2, v4
s_nop 1
v_cndmask_b32 v29, v201, v29, vcc
v_lshl_add_u32 v196, v4, 2, 32
v_add_u32 v197, 8, v3
v_cmp_le_u32 vcc, 20, v196
s_nop 1
v_cndmask_b32 v198, 0, 20, vcc
v_sub_u32 v199, v197, v198
v_sub_u32 v198, v196, v198
v_cmp_gt_u32 vcc, 20, v199
v_mad_i32_i24 v198, v197, 20, v198
buffer_load_dwordx4 v8, s[4:7], s45 offen offset:1024 sc1 lds
v_lshl_add_u32 v198, v198, 2, s19
v_cndmask_b32 v30, v201, v198, vcc
v_cmp_gt_u32 vcc, 2, v4
s_nop 1
v_cndmask_b32 v30, v201, v30, vcc
v_lshl_add_u32 v196, v4, 2, 32
v_add_u32 v197, 24, v3
v_cmp_le_u32 vcc, 20, v196
s_nop 1
v_cndmask_b32 v198, 0, 20, vcc
v_sub_u32 v199, v197, v198
v_sub_u32 v198, v196, v198
v_cmp_gt_u32 vcc, 20, v199
v_mad_i32_i24 v198, v197, 20, v198
buffer_load_dwordx4 v8, s[4:7], s45 offen offset:2048 sc1 lds
v_lshl_add_u32 v198, v198, 2, s19
v_cndmask_b32 v31, v201, v198, vcc
v_cmp_gt_u32 vcc, 2, v4
s_nop 1
v_cndmask_b32 v31, v201, v31, vcc
v_lshlrev_b32 v33, 2, v0
s_mul_i32 s17, s12, 3360
s_add_u32 s17, s17, s15
s_add_u32 s17, s17, 12496896
v_add_u32 v32, s17, v33
v_add_u32 v33, 0, v33
s_lshl_b32 s17, s2, 9
s_add_u32 s17, s17, 9515008
buffer_load_dwordx4 v8, s[4:7], s45 offen offset:3072 sc1 lds
s_add_u32 s45, s45, 16384
v_lshl_add_u32 v17, v3, 2, s17
v_lshl_add_u32 v18, v4, 4, s17
s_mov_b32 s23, 20480
s_mov_b32 s20, 0
v_lshlrev_b32 v196, 4, v4
v_add_u32 v197, 0, v196
v_add_u32 v198, 4, v196
v_add_u32 v199, 8, v196
v_add_u32 v200, 12, v196
s_mul_i32 s3, s12, 3360
s_add_u32 s3, s3, s15
s_add_u32 s3, s3, 12496896
s_add_u32 m0, s44, s45
s_nop 0
buffer_load_dwordx4 v8, s[4:7], s45 offen offset:0 sc1 lds
v_mov_b32 v207, 0x40000000
s_lshl_b32 s17, s10, 1
s_add_u32 s17, s17, 1
s_lshr_b32 s19, s17, 1
s_lshl_b32 s19, s19, 4
v_add_u32 v204, s19, v3
v_cmp_le_u32 vcc, 20, v204
s_nop 1
v_cndmask_b32 v205, 0, 20, vcc
v_mul_u32_u24 v206, 20, v204
v_sub_u32 v206, v206, v205
v_cmp_gt_u32 vcc, 40, v204
s_nop 1
v_cndmask_b32 v205, 63, v205, vcc
buffer_load_dwordx4 v8, s[4:7], s45 offen offset:1024 sc1 lds
s_cmp_eq_u32 s19, 48
s_cselect_b64 vcc, -1, 0
v_and_b32 v204, 3, v1
v_mul_u32_u24 v204, 20, v204
v_cndmask_b32 v205, v205, v204, vcc
v_mov_b32 v204, 800
v_cndmask_b32_e64 v206, v206, v204, vcc
s_cmp_eq_u32 s10, 0
s_cselect_b32 s19, 0, 32
v_lshl_add_u32 v204, v4, 2, s19
v_cmp_gt_u32 s[38:39], 40, v204
v_add_lshl_u32 v224, v204, v206, 2
v_sub_u32 v204, v204, v205
v_cmp_gt_u32 vcc, 20, v204
buffer_load_dwordx4 v8, s[4:7], s45 offen offset:2048 sc1 lds
s_and_b64 vcc, vcc, s[38:39]
v_cndmask_b32 v224, v207, v224, vcc
v_lshl_add_u32 v204, v4, 2, s19
v_add_u32_e64 v204, 16, v204
v_cmp_gt_u32 s[38:39], 40, v204
v_add_lshl_u32 v225, v204, v206, 2
v_sub_u32 v204, v204, v205
v_cmp_gt_u32 vcc, 20, v204
s_and_b64 vcc, vcc, s[38:39]
s_nop 0
v_cndmask_b32 v225, v207, v225, vcc
s_lshl_b32 s17, s10, 1
s_add_u32 s17, s17, 2
buffer_load_dwordx4 v8, s[4:7], s45 offen offset:3072 sc1 lds
s_add_u32 s45, s45, 16384
s_lshr_b32 s19, s17, 1
s_lshl_b32 s19, s19, 4
v_add_u32 v204, s19, v3
v_cmp_le_u32 vcc, 20, v204
s_nop 1
v_cndmask_b32 v205, 0, 20, vcc
v_mul_u32_u24 v206, 20, v204
v_sub_u32 v206, v206, v205
v_cmp_gt_u32 vcc, 40, v204
s_nop 1
v_cndmask_b32 v205, 63, v205, vcc
s_cmp_eq_u32 s19, 48
s_cselect_b64 vcc, -1, 0
v_and_b32 v204, 3, v1
v_mul_u32_u24 v204, 20, v204
s_add_u32 m0, s44, s45
s_nop 0
buffer_load_dwordx4 v8, s[4:7], s45 offen offset:0 sc1 lds
v_cndmask_b32 v205, v205, v204, vcc
v_mov_b32 v204, 800
v_cndmask_b32_e64 v206, v206, v204, vcc
s_cmp_eq_u32 s10, 3
s_cselect_b32 s19, 64, 0
v_lshl_add_u32 v204, v4, 2, s19
v_cmp_gt_u32 s[38:39], 40, v204
v_add_lshl_u32 v226, v204, v206, 2
v_sub_u32 v204, v204, v205
v_cmp_gt_u32 vcc, 20, v204
s_and_b64 vcc, vcc, s[38:39]
s_nop 0
v_cndmask_b32 v226, v207, v226, vcc
v_lshl_add_u32 v204, v4, 2, s19
buffer_load_dwordx4 v8, s[4:7], s45 offen offset:1024 sc1 lds
v_add_u32 v204, 16, v204
v_cmp_gt_u32 s[38:39], 40, v204
v_add_lshl_u32 v227, v204, v206, 2
v_sub_u32 v204, v204, v205
v_cmp_gt_u32 vcc, 20, v204
s_and_b64 vcc, vcc, s[38:39]
s_nop 0
v_cndmask_b32 v227, v207, v227, vcc
s_lshl_b32 s17, s11, 11
s_add_u32 s17, s17, 9711616
v_lshl_add_u32 v153, v1, 7, s17
s_cmp_eq_u32 s10, 1
s_cselect_b32 s17, 0, 0x40000000
v_and_b32 v204, 0x40000000, v5
buffer_load_dwordx4 v8, s[4:7], s45 offen offset:2048 sc1 lds
v_or3_b32 v153, v204, s17, v153
s_lshl_b32 s17, s10, 11
s_add_u32 s17, s17, 122880
v_add_u32 v154, s17, v2
v_add_u32 v155, 122880, v2
buffer_load_dwordx4 v8, s[4:7], s45 offen offset:3072 sc1 lds
s_add_u32 s45, s45, 16384
s_add_u32 m0, s44, s45
s_nop 0
buffer_load_dwordx4 v8, s[4:7], s45 offen offset:0 sc1 lds
buffer_load_dwordx4 v8, s[4:7], s45 offen offset:1024 sc1 lds
s_waitcnt vmcnt(22)
s_waitcnt lgkmcnt(0)
s_add_u32 s40, s40, 16
s_barrier
s_cmp_lg_u32 s10, 0
s_cbranch_scc1 L_arr_23
v_mov_b32 v255, 1
buffer_atomic_add v255, v5, s[4:7], 0 offen
L_arr_23:
s_cmp_lg_u32 s10, 1
s_cbranch_scc1 L_other_25
v_mov_b32 v255, 0
buffer_atomic_add v255, v6, s[4:7], 0 offen sc0
buffer_load_dwordx4 v8, s[4:7], s45 offen offset:2048 sc1 lds
buffer_load_dwordx4 v8, s[4:7], s45 offen offset:3072 sc1 lds
s_add_u32 s45, s45, 16384
v_mov_b32 v254, 0
buffer_atomic_add v254, v6, s[4:7], 0 offen sc0
s_add_u32 m0, s44, s45
s_nop 0
buffer_load_dwordx4 v8, s[4:7], s45 offen offset:0 sc1 lds
buffer_load_dwordx4 v8, s[4:7], s45 offen offset:1024 sc1 lds
v_mov_b32 v253, 0
buffer_atomic_add v253, v6, s[4:7], 0 offen sc0
buffer_load_dwordx4 v8, s[4:7], s45 offen offset:2048 sc1 lds
buffer_load_dwordx4 v8, s[4:7], s45 offen offset:3072 sc1 lds
s_add_u32 s45, s45, 16384
v_mov_b32 v252, 0
buffer_atomic_add v252, v6, s[4:7], 0 offen sc0
s_waitcnt vmcnt(9)
v_readfirstlane_b32 s43, v255
s_cmp_ge_u32 s43, s40
s_cbranch_scc1 L_pdone_24
v_mov_b32 v255, 0
buffer_atomic_add v255, v6, s[4:7], 0 offen sc0
s_waitcnt vmcnt(7)
v_readfirstlane_b32 s43, v254
s_cmp_ge_u32 s43, s40
s_cbranch_scc1 L_pdone_24
v_mov_b32 v254, 0
buffer_atomic_add v254, v6, s[4:7], 0 offen sc0
s_waitcnt vmcnt(5)
v_readfirstlane_b32 s43, v253
s_cmp_ge_u32 s43, s40
s_cbranch_scc1 L_pdone_24
s_mov_b32 s42, 200000
L_poll_26:
v_mov_b32 v253, 0
buffer_atomic_add v253, v6, s[4:7], 0 offen sc0
s_waitcnt vmcnt(3)
v_readfirstlane_b32 s43, v252
s_cmp_ge_u32 s43, s40
s_cbranch_scc1 L_pdone_24
v_mov_b32 v252, 0
buffer_atomic_add v252, v6, s[4:7], 0 offen sc0
s_waitcnt vmcnt(3)
v_readfirstlane_b32 s43, v255
s_cmp_ge_u32 s43, s40
s_cbranch_scc1 L_pdone_24
v_mov_b32 v255, 0
buffer_atomic_add v255, v6, s[4:7], 0 offen sc0
s_waitcnt vmcnt(3)
v_readfirstlane_b32 s43, v254
s_cmp_ge_u32 s43, s40
s_cbranch_scc1 L_pdone_24
v_mov_b32 v254, 0
buffer_atomic_add v254, v6, s[4:7], 0 offen sc0
s_waitcnt vmcnt(3)
v_readfirstlane_b32 s43, v253
s_cmp_ge_u32 s43, s40
s_cbranch_scc1 L_pdone_24
s_sub_u32 s42, s42, 1
s_cbranch_scc0 L_poll_26
s_branch L_pdone_24
L_other_25:
buffer_load_dwordx4 v8, s[4:7], s45 offen offset:2048 sc1 lds
buffer_load_dwordx4 v8, s[4:7], s45 offen offset:3072 sc1 lds
s_add_u32 s45, s45, 16384
s_add_u32 m0, s44, s45
s_nop 0
buffer_load_dwordx4 v8, s[4:7], s45 offen offset:0 sc1 lds
buffer_load_dwordx4 v8, s[4:7], s45 offen offset:1024 sc1 lds
buffer_load_dwordx4 v8, s[4:7], s45 offen offset:2048 sc1 lds
buffer_load_dwordx4 v8, s[4:7], s45 offen offset:3072 sc1 lds
s_add_u32 s45, s45, 16384
L_pdone_24:
s_barrier
s_mov_b32 s20, 0
buffer_load_dwordx4 a[0:3], v12, s[4:7], s20 offen offset:0 sc1
buffer_load_dwordx4 a[4:7], v13, s[4:7], s20 offen offset:0 sc1
buffer_load_dwordx4 a[8:11], v12, s[4:7], s20 offen offset:3072 sc1
buffer_load_dwordx4 a[12:15], v13, s[4:7], s20 offen offset:3072 sc1
s_mov_b32 s20, 4096
buffer_load_dwordx4 a[16:19], v12, s[4:7], s20 offen offset:1024 sc1
buffer_load_dwordx4 a[20:23], v13, s[4:7], s20 offen offset:1024 sc1
s_mov_b32 s20, 8192
buffer_load_dwordx4 a[24:27], v12, s[4:7], s20 offen offset:0 sc1
buffer_load_dwordx4 a[28:31], v13, s[4:7], s20 offen offset:0 sc1
buffer_load_dwordx2 v[68:69], v16, s[4:7], 0 offen offset:0 sc1
buffer_load_dwordx2 v[70:71], v16, s[4:7], 0 offen offset:128 sc1
buffer_load_dwordx2 v[72:73], v16, s[4:7], 0 offen offset:1024 sc1
buffer_load_dwordx2 v[74:75], v16, s[4:7], 0 offen offset:1152 sc1
buffer_load_dwordx4 a[32:35], v12, s[4:7], s20 offen offset:2048 sc1
buffer_load_dwordx4 a[36:39], v13, s[4:7], s20 offen offset:2048 sc1
s_mov_b32 s20, 12288
buffer_load_dwordx4 a[40:43], v12, s[4:7], s20 offen offset:1024 sc1
buffer_load_dwordx4 a[44:47], v13, s[4:7], s20 offen offset:1024 sc1
buffer_load_dwordx4 a[48:51], v12, s[4:7], s20 offen offset:3072 sc1
buffer_load_dwordx4 a[52:55], v13, s[4:7], s20 offen offset:3072 sc1
s_waitcnt vmcnt(16)
s_barrier
ds_read_b128 a[160:163], v2 offset:0
ds_read_b128 a[164:167], v2 offset:1024
ds_read_b128 a[168:171], v2 offset:2048
ds_read_b128 a[172:175], v2 offset:3072
ds_read_b128 a[176:179], v2 offset:4096
ds_read_b128 a[180:183], v2 offset:5120
ds_read_b128 a[184:187], v2 offset:6144
s_waitcnt lgkmcnt(5)
v_mfma_f32_16x16x32_bf16 v[84:87], a[0:3], a[160:163], 0
v_mfma_f32_16x16x32_bf16 v[116:119], a[4:7], a[160:163], 0
ds_read_b128 a[188:191], v2 offset:7168
v_mfma_f32_16x16x32_bf16 v[88:91], a[0:3], a[164:167], 0
v_mfma_f32_16x16x32_bf16 v[120:123], a[4:7], a[164:167], 0
ds_read_b128 a[160:163], v2 offset:8192
s_waitcnt lgkmcnt(5)
v_mfma_f32_16x16x32_bf16 v[92:95], a[0:3], a[168:171], 0
s_mov_b32 s20, 16384
buffer_load_dwordx4 a[56:59], v12, s[4:7], s20 offen offset:2048 sc1
v_mfma_f32_16x16x32_bf16 v[124:127], a[4:7], a[168:171], 0
ds_read_b128 a[164:167], v2 offset:9216
v_mfma_f32_16x16x32_bf16 v[96:99], a[0:3], a[172:175], 0
v_mfma_f32_16x16x32_bf16 v[128:131], a[4:7], a[172:175], 0
ds_read_b128 a[168:171], v2 offset:10240
s_waitcnt lgkmcnt(5)
v_mfma_f32_16x16x32_bf16 v[100:103], a[0:3], a[176:179], 0
v_mfma_f32_16x16x32_bf16 v[132:135], a[4:7], a[176:179], 0
ds_read_b128 a[172:175], v2 offset:11264
v_mfma_f32_16x16x32_bf16 v[104:107], a[180:183], a[0:3], 0
buffer_load_dwordx4 a[60:63], v13, s[4:7], s20 offen offset:2048 sc1
v_mfma_f32_16x16x32_bf16 v[136:139], a[180:183], a[4:7], 0
s_waitcnt vmcnt(16)
ds_read_b128 a[176:179], v2 offset:12288
s_waitcnt lgkmcnt(5)
v_mfma_f32_16x16x32_bf16 v[84:87], a[8:11], a[184:187], v[84:87]
v_mfma_f32_16x16x32_bf16 v[116:119], a[12:15], a[184:187], v[116:119]
ds_read_b128 a[180:183], v2 offset:13312
v_mfma_f32_16x16x32_bf16 v[88:91], a[8:11], a[188:191], v[88:91]
s_mov_b32 s20, 0
buffer_load_dwordx4 a[64:67], v12, s[4:7], s20 offen offset:1024 sc1
v_mfma_f32_16x16x32_bf16 v[120:123], a[12:15], a[188:191], v[120:123]
ds_read_b128 a[184:187], v2 offset:14336
s_waitcnt lgkmcnt(5)
v_mfma_f32_16x16x32_bf16 v[92:95], a[8:11], a[160:163], v[92:95]
v_mfma_f32_16x16x32_bf16 v[124:127], a[12:15], a[160:163], v[124:127]
ds_read_b128 a[188:191], v2 offset:15360
v_mfma_f32_16x16x32_bf16 v[96:99], a[8:11], a[164:167], v[96:99]
v_mfma_f32_16x16x32_bf16 v[128:131], a[12:15], a[164:167], v[128:131]
ds_read_b128 a[160:163], v2 offset:16384
s_waitcnt lgkmcnt(5)
v_mfma_f32_16x16x32_bf16 v[100:103], a[8:11], a[168:171], v[100:103]
buffer_load_dwordx4 a[68:71], v13, s[4:7], s20 offen offset:1024 sc1
v_mfma_f32_16x16x32_bf16 v[132:135], a[12:15], a[168:171], v[132:135]
ds_read_b128 a[164:167], v2 offset:17408
v_mfma_f32_16x16x32_bf16 v[104:107], a[172:175], a[8:11], v[104:107]
v_mfma_f32_16x16x32_bf16 v[136:139], a[172:175], a[12:15], v[136:139]
s_waitcnt vmcnt(16)
ds_read_b128 a[168:171], v2 offset:18432
s_waitcnt lgkmcnt(5)
v_mfma_f32_16x16x32_bf16 v[84:87], a[16:19], a[176:179], v[84:87]
buffer_load_dwordx4 a[72:75], v12, s[4:7], s20 offen offset:2048 sc1
v_mfma_f32_16x16x32_bf16 v[116:119], a[20:23], a[176:179], v[116:119]
ds_read_b128 a[172:175], v2 offset:19456
v_mfma_f32_16x16x32_bf16 v[88:91], a[16:19], a[180:183], v[88:91]
v_mfma_f32_16x16x32_bf16 v[120:123], a[20:23], a[180:183], v[120:123]
ds_read_b128 a[176:179], v2 offset:20480
s_waitcnt lgkmcnt(5)
v_mfma_f32_16x16x32_bf16 v[92:95], a[16:19], a[184:187], v[92:95]
v_mfma_f32_16x16x32_bf16 v[124:127], a[20:23], a[184:187], v[124:127]
ds_read_b128 a[180:183], v2 offset:21504
v_mfma_f32_16x16x32_bf16 v[96:99], a[16:19], a[188:191], v[96:99]
buffer_load_dwordx4 a[76:79], v13, s[4:7], s20 offen offset:2048 sc1
v_mfma_f32_16x16x32_bf16 v[128:131], a[20:23], a[188:191], v[128:131]
ds_read_b128 a[184:187], v2 offset:22528
s_waitcnt lgkmcnt(5)
v_mfma_f32_16x16x32_bf16 v[100:103], a[16:19], a[160:163], v[100:103]
v_mfma_f32_16x16x32_bf16 v[132:135], a[20:23], a[160:163], v[132:135]
ds_read_b128 a[188:191], v2 offset:23552
v_mfma_f32_16x16x32_bf16 v[104:107], a[164:167], a[16:19], v[104:107]
s_mov_b32 s20, 4096
buffer_load_dwordx4 a[80:83], v12, s[4:7], s20 offen offset:0 sc1
v_mfma_f32_16x16x32_bf16 v[136:139], a[164:167], a[20:23], v[136:139]
s_waitcnt vmcnt(17)
ds_read_b128 a[160:163], v2 offset:24576
s_waitcnt lgkmcnt(5)
v_mfma_f32_16x16x32_bf16 v[84:87], a[24:27], a[168:171], v[84:87]
v_mfma_f32_16x16x32_bf16 v[116:119], a[28:31], a[168:171], v[116:119]
ds_read_b128 a[164:167], v2 offset:25600
v_mfma_f32_16x16x32_bf16 v[88:91], a[24:27], a[172:175], v[88:91]
v_mfma_f32_16x16x32_bf16 v[120:123], a[28:31], a[172:175], v[120:123]
ds_read_b128 a[168:171], v2 offset:26624
s_waitcnt lgkmcnt(5)
v_mfma_f32_16x16x32_bf16 v[92:95], a[24:27], a[176:179], v[92:95]
buffer_load_dwordx4 a[84:87], v13, s[4:7], s20 offen offset:0 sc1
v_mfma_f32_16x16x32_bf16 v[124:127], a[28:31], a[176:179], v[124:127]
ds_read_b128 a[172:175], v2 offset:27648
v_mfma_f32_16x16x32_bf16 v[96:99], a[24:27], a[180:183], v[96:99]
v_mfma_f32_16x16x32_bf16 v[128:131], a[28:31], a[180:183], v[128:131]
ds_read_b128 a[176:179], v2 offset:28672
s_waitcnt lgkmcnt(5)
v_mfma_f32_16x16x32_bf16 v[100:103], a[24:27], a[184:187], v[100:103]
buffer_load_dwordx4 a[88:91], v12, s[4:7], s20 offen offset:2048 sc1
v_mfma_f32_16x16x32_bf16 v[132:135], a[28:31], a[184:187], v[132:135]
ds_read_b128 a[180:183], v2 offset:29696
v_mfma_f32_16x16x32_bf16 v[104:107], a[188:191], a[24:27], v[104:107]
v_mfma_f32_16x16x32_bf16 v[136:139], a[188:191], a[28:31], v[136:139]
s_waitcnt vmcnt(13)
ds_read_b128 a[184:187], v2 offset:30720
s_waitcnt lgkmcnt(5)
v_mfma_f32_16x16x32_bf16 v[84:87], a[32:35], a[160:163], v[84:87]
v_mfma_f32_16x16x32_bf16 v[116:119], a[36:39], a[160:163], v[116:119]
ds_read_b128 a[188:191], v2 offset:31744
v_mfma_f32_16x16x32_bf16 v[88:91], a[32:35], a[164:167], v[88:91]
buffer_load_dwordx4 a[92:95], v13, s[4:7], s20 offen offset:2048 sc1
v_mfma_f32_16x16x32_bf16 v[120:123], a[36:39], a[164:167], v[120:123]
ds_read_b128 a[160:163], v2 offset:32768
s_waitcnt lgkmcnt(5)
v_mfma_f32_16x16x32_bf16 v[92:95], a[32:35], a[168:171], v[92:95]
v_mfma_f32_16x16x32_bf16 v[124:127], a[36:39], a[168:171], v[124:127]
ds_read_b128 a[164:167], v2 offset:33792
v_mfma_f32_16x16x32_bf16 v[96:99], a[32:35], a[172:175], v[96:99]
buffer_load_dwordx4 a[96:99], v12, s[4:7], s20 offen offset:3072 sc1
v_mfma_f32_16x16x32_bf16 v[128:131], a[36:39], a[172:175], v[128:131]
ds_read_b128 a[168:171], v2 offset:34816
s_waitcnt lgkmcnt(5)
v_mfma_f32_16x16x32_bf16 v[100:103], a[32:35], a[176:179], v[100:103]
v_mfma_f32_16x16x32_bf16 v[132:135], a[36:39], a[176:179], v[132:135]
ds_read_b128 a[172:175], v2 offset:35840
v_mfma_f32_16x16x32_bf16 v[104:107], a[180:183], a[32:35], v[104:107]
v_mfma_f32_16x16x32_bf16 v[136:139], a[180:183], a[36:39], v[136:139]
s_waitcnt vmcnt(13)
ds_read_b128 a[176:179], v2 offset:36864
s_waitcnt lgkmcnt(5)
v_mfma_f32_16x16x32_bf16 v[84:87], a[40:43], a[184:187], v[84:87]
buffer_load_dwordx4 a[100:103], v13, s[4:7], s20 offen offset:3072 sc1
v_mfma_f32_16x16x32_bf16 v[116:119], a[44:47], a[184:187], v[116:119]
ds_read_b128 a[180:183], v2 offset:37888
v_mfma_f32_16x16x32_bf16 v[88:91], a[40:43], a[188:191], v[88:91]
v_mfma_f32_16x16x32_bf16 v[120:123], a[44:47], a[188:191], v[120:123]
ds_read_b128 a[184:187], v2 offset:38912
s_waitcnt lgkmcnt(5)
v_mfma_f32_16x16x32_bf16 v[92:95], a[40:43], a[160:163], v[92:95]
s_mov_b32 s20, 8192
buffer_load_dwordx4 a[104:107], v12, s[4:7], s20 offen offset:1024 sc1
v_mfma_f32_16x16x32_bf16 v[124:127], a[44:47], a[160:163], v[124:127]
ds_read_b128 a[188:191], v2 offset:39936
v_mfma_f32_16x16x32_bf16 v[96:99], a[40:43], a[164:167], v[96:99]
v_mfma_f32_16x16x32_bf16 v[128:131], a[44:47], a[164:167], v[128:131]
ds_read_b128 a[160:163], v2 offset:40960
s_waitcnt lgkmcnt(5)
v_mfma_f32_16x16x32_bf16 v[100:103], a[40:43], a[168:171], v[100:103]
v_mfma_f32_16x16x32_bf16 v[132:135], a[44:47], a[168:171], v[132:135]
ds_read_b128 a[164:167], v2 offset:41984
v_mfma_f32_16x16x32_bf16 v[104:107], a[172:175], a[40:43], v[104:107]
buffer_load_dwordx4 a[108:111], v13, s[4:7], s20 offen offset:1024 sc1
v_mfma_f32_16x16x32_bf16 v[136:139], a[172:175], a[44:47], v[136:139]
s_waitcnt vmcnt(14)
ds_read_b128 a[168:171], v2 offset:43008
s_waitcnt lgkmcnt(5)
v_mfma_f32_16x16x32_bf16 v[84:87], a[48:51], a[176:179], v[84:87]
v_mfma_f32_16x16x32_bf16 v[116:119], a[52:55], a[176:179], v[116:119]
ds_read_b128 a[172:175], v2 offset:44032
v_mfma_f32_16x16x32_bf16 v[88:91], a[48:51], a[180:183], v[88:91]
buffer_load_dwordx4 a[112:115], v12, s[4:7], s20 offen offset:3072 sc1
v_mfma_f32_16x16x32_bf16 v[120:123], a[52:55], a[180:183], v[120:123]
ds_read_b128 a[176:179], v2 offset:45056
s_waitcnt lgkmcnt(5)
v_mfma_f32_16x16x32_bf16 v[92:95], a[48:51], a[184:187], v[92:95]
v_mfma_f32_16x16x32_bf16 v[124:127], a[52:55], a[184:187], v[124:127]
ds_read_b128 a[180:183], v2 offset:46080
v_mfma_f32_16x16x32_bf16 v[96:99], a[48:51], a[188:191], v[96:99]
v_mfma_f32_16x16x32_bf16 v[128:131], a[52:55], a[188:191], v[128:131]
ds_read_b128 a[184:187], v2 offset:47104
s_waitcnt lgkmcnt(5)
v_mfma_f32_16x16x32_bf16 v[100:103], a[48:51], a[160:163], v[100:103]
buffer_load_dwordx4 a[116:119], v13, s[4:7], s20 offen offset:3072 sc1
v_mfma_f32_16x16x32_bf16 v[132:135], a[52:55], a[160:163], v[132:135]
ds_read_b128 a[188:191], v2 offset:48128
v_mfma_f32_16x16x32_bf16 v[104:107], a[164:167], a[48:51], v[104:107]
v_mfma_f32_16x16x32_bf16 v[136:139], a[164:167], a[52:55], v[136:139]
s_waitcnt vmcnt(14)
ds_read_b128 a[160:163], v2 offset:49152
s_waitcnt lgkmcnt(5)
v_mfma_f32_16x16x32_bf16 v[84:87], a[56:59], a[168:171], v[84:87]
s_mov_b32 s20, 12288
buffer_load_dwordx4 a[120:123], v12, s[4:7], s20 offen offset:0 sc1
v_mfma_f32_16x16x32_bf16 v[116:119], a[60:63], a[168:171], v[116:119]
ds_read_b128 a[164:167], v2 offset:50176
v_mfma_f32_16x16x32_bf16 v[88:91], a[56:59], a[172:175], v[88:91]
v_mfma_f32_16x16x32_bf16 v[120:123], a[60:63], a[172:175], v[120:123]
ds_read_b128 a[168:171], v2 offset:51200
s_waitcnt lgkmcnt(5)
v_mfma_f32_16x16x32_bf16 v[92:95], a[56:59], a[176:179], v[92:95]
v_mfma_f32_16x16x32_bf16 v[124:127], a[60:63], a[176:179], v[124:127]
ds_read_b128 a[172:175], v2 offset:52224
v_mfma_f32_16x16x32_bf16 v[96:99], a[56:59], a[180:183], v[96:99]
buffer_load_dwordx4 a[124:127], v13, s[4:7], s20 offen offset:0 sc1
v_mfma_f32_16x16x32_bf16 v[128:131], a[60:63], a[180:183], v[128:131]
ds_read_b128 a[176:179], v2 offset:53248
s_waitcnt lgkmcnt(5)
v_mfma_f32_16x16x32_bf16 v[100:103], a[56:59], a[184:187], v[100:103]
v_mfma_f32_16x16x32_bf16 v[132:135], a[60:63], a[184:187], v[132:135]
ds_read_b128 a[180:183], v2 offset:54272
v_mfma_f32_16x16x32_bf16 v[104:107], a[188:191], a[56:59], v[104:107]
v_mfma_f32_16x16x32_bf16 v[136:139], a[188:191], a[60:63], v[136:139]
s_waitcnt vmcnt(14)
ds_read_b128 a[184:187], v2 offset:55296
s_waitcnt lgkmcnt(5)
v_mfma_f32_16x16x32_bf16 v[84:87], a[64:67], a[160:163], v[84:87]
buffer_load_dwordx4 a[128:131], v12, s[4:7], s20 offen offset:2048 sc1
v_mfma_f32_16x16x32_bf16 v[116:119], a[68:71], a[160:163], v[116:119]
ds_read_b128 a[188:191], v2 offset:56320
v_mfma_f32_16x16x32_bf16 v[88:91], a[64:67], a[164:167], v[88:91]
v_add_f32 v68, v68, v70
v_mfma_f32_16x16x32_bf16 v[120:123], a[68:71], a[164:167], v[120:123]
ds_read_b128 a[160:163], v2 offset:57344
s_waitcnt lgkmcnt(5)
v_mfma_f32_16x16x32_bf16 v[92:95], a[64:67], a[168:171], v[92:95]
buffer_load_dwordx4 a[132:135], v13, s[4:7], s20 offen offset:2048 sc1
v_mfma_f32_16x16x32_bf16 v[124:127], a[68:71], a[168:171], v[124:127]
ds_read_b128 a[164:167], v2 offset:58368
v_mfma_f32_16x16x32_bf16 v[96:99], a[64:67], a[172:175], v[96:99]
v_add_f32 v69, v69, v71
v_mov_b32 v76, v68
v_mfma_f32_16x16x32_bf16 v[128:131], a[68:71], a[172:175], v[128:131]
ds_read_b128 a[168:171], v2 offset:59392
s_waitcnt lgkmcnt(5)
v_mfma_f32_16x16x32_bf16 v[100:103], a[64:67], a[176:179], v[100:103]
v_permlane16_swap_b32 v68, v76
v_add_f32 v68, v68, v76
v_mfma_f32_16x16x32_bf16 v[132:135], a[68:71], a[176:179], v[132:135]
ds_read_b128 a[172:175], v2 offset:60416
v_mfma_f32_16x16x32_bf16 v[104:107], a[180:183], a[64:67], v[104:107]
s_mov_b32 s20, 16384
buffer_load_dwordx4 a[136:139], v12, s[4:7], s20 offen offset:0 sc1
v_mfma_f32_16x16x32_bf16 v[136:139], a[180:183], a[68:71], v[136:139]
s_waitcnt vmcnt(15)
ds_read_b128 a[176:179], v2 offset:61440
s_waitcnt lgkmcnt(5)
v_mfma_f32_16x16x32_bf16 v[84:87], a[72:75], a[184:187], v[84:87]
v_mov_b32 v76, v68
s_nop 1
v_permlane32_swap_b32 v68, v76
v_mfma_f32_16x16x32_bf16 v[116:119], a[76:79], a[184:187], v[116:119]
ds_read_b128 a[180:183], v2 offset:62464
v_mfma_f32_16x16x32_bf16 v[88:91], a[72:75], a[188:191], v[88:91]
buffer_load_dwordx4 a[140:143], v13, s[4:7], s20 offen offset:0 sc1
v_mfma_f32_16x16x32_bf16 v[120:123], a[76:79], a[188:191], v[120:123]
ds_read_b128 a[184:187], v2 offset:63488
s_waitcnt lgkmcnt(5)
v_mfma_f32_16x16x32_bf16 v[92:95], a[72:75], a[160:163], v[92:95]
v_add_f32 v68, v68, v76
v_mov_b32 v76, v69
v_mfma_f32_16x16x32_bf16 v[124:127], a[76:79], a[160:163], v[124:127]
ds_read_b128 a[188:191], v2 offset:64512
v_mfma_f32_16x16x32_bf16 v[96:99], a[72:75], a[164:167], v[96:99]
v_permlane16_swap_b32 v69, v76
v_add_f32 v69, v69, v76
v_mfma_f32_16x16x32_bf16 v[128:131], a[76:79], a[164:167], v[128:131]
ds_read_b128 a[160:163], v14 offset:0
s_waitcnt lgkmcnt(5)
v_mfma_f32_16x16x32_bf16 v[100:103], a[72:75], a[168:171], v[100:103]
s_add_u32 m0, s44, s45
s_nop 0
buffer_load_dwordx4 v8, s[4:7], s45 offen offset:0 sc1 lds
v_mfma_f32_16x16x32_bf16 v[132:135], a[76:79], a[168:171], v[132:135]
ds_read_b128 a[164:167], v14 offset:1024
v_mfma_f32_16x16x32_bf16 v[104:107], a[172:175], a[72:75], v[104:107]
v_mov_b32 v76, v69
s_nop 1
v_permlane32_swap_b32 v69, v76
v_mfma_f32_16x16x32_bf16 v[136:139], a[172:175], a[76:79], v[136:139]
s_waitcnt vmcnt(15)
ds_read_b128 a[168:171], v14 offset:2048
s_waitcnt lgkmcnt(5)
v_mfma_f32_16x16x32_bf16 v[84:87], a[80:83], a[176:179], v[84:87]
buffer_load_dwordx4 v8, s[4:7], s45 offen offset:1024 sc1 lds
v_mfma_f32_16x16x32_bf16 v[116:119], a[84:87], a[176:179], v[116:119]
ds_read_b128 a[172:175], v14 offset:3072
v_mfma_f32_16x16x32_bf16 v[88:91], a[80:83], a[180:183], v[88:91]
v_add_f32 v69, v69, v76
v_mul_f32 v36, 0x3acccccd, v68
v_mfma_f32_16x16x32_bf16 v[120:123], a[84:87], a[180:183], v[120:123]
ds_read_b128 a[176:179], v14 offset:4096
s_waitcnt lgkmcnt(5)
v_mfma_f32_16x16x32_bf16 v[92:95], a[80:83], a[184:187], v[92:95]
v_mul_f32 v69, 0x3acccccd, v69
v_fma_f32 v69, -v36, v36, v69
v_mfma_f32_16x16x32_bf16 v[124:127], a[84:87], a[184:187], v[124:127]
ds_read_b128 a[180:183], v14 offset:5120
v_mfma_f32_16x16x32_bf16 v[96:99], a[80:83], a[188:191], v[96:99]
buffer_load_dwordx4 v8, s[4:7], s45 offen offset:2048 sc1 lds
v_mfma_f32_16x16x32_bf16 v[128:131], a[84:87], a[188:191], v[128:131]
ds_read_b128 a[184:187], v14 offset:6144
s_waitcnt lgkmcnt(5)
v_mfma_f32_16x16x32_bf16 v[100:103], a[80:83], a[160:163], v[100:103]
v_max_f32 v69, 0, v69
v_add_f32 v69, 0x3727c5ac, v69
v_mfma_f32_16x16x32_bf16 v[132:135], a[84:87], a[160:163], v[132:135]
ds_read_b128 a[188:191], v14 offset:7168
v_mfma_f32_16x16x32_bf16 v[104:107], a[164:167], a[80:83], v[104:107]
buffer_load_dwordx4 v8, s[4:7], s45 offen offset:3072 sc1 lds
s_add_u32 s45, s45, 16384
v_mfma_f32_16x16x32_bf16 v[136:139], a[164:167], a[84:87], v[136:139]
s_waitcnt vmcnt(16)
ds_read_b128 a[160:163], v14 offset:8192
s_waitcnt lgkmcnt(5)
v_mfma_f32_16x16x32_bf16 v[84:87], a[88:91], a[168:171], v[84:87]
v_rsq_f32 v38, v69
s_nop 0
v_mul_f32 v40, 0x3fb8aa3b, v38
v_mfma_f32_16x16x32_bf16 v[116:119], a[92:95], a[168:171], v[116:119]
ds_read_b128 a[164:167], v14 offset:9216
v_mfma_f32_16x16x32_bf16 v[88:91], a[88:91], a[172:175], v[88:91]
v_add_f32 v72, v72, v74
v_add_f32 v73, v73, v75
v_mfma_f32_16x16x32_bf16 v[120:123], a[92:95], a[172:175], v[120:123]
ds_read_b128 a[168:171], v14 offset:10240
s_waitcnt lgkmcnt(5)
v_mfma_f32_16x16x32_bf16 v[92:95], a[88:91], a[176:179], v[92:95]
buffer_load_dwordx4 a[144:147], v12, s[4:7], s20 offen offset:1024 sc1
v_mfma_f32_16x16x32_bf16 v[124:127], a[92:95], a[176:179], v[124:127]
ds_read_b128 a[172:175], v14 offset:11264
v_mfma_f32_16x16x32_bf16 v[96:99], a[88:91], a[180:183], v[96:99]
v_mov_b32 v76, v72
s_nop 1
v_permlane16_swap_b32 v72, v76
v_mfma_f32_16x16x32_bf16 v[128:131], a[92:95], a[180:183], v[128:131]
ds_read_b128 a[176:179], v14 offset:12288
s_waitcnt lgkmcnt(5)
v_mfma_f32_16x16x32_bf16 v[100:103], a[88:91], a[184:187], v[100:103]
buffer_load_dwordx4 a[148:151], v13, s[4:7], s20 offen offset:1024 sc1
v_mfma_f32_16x16x32_bf16 v[132:135], a[92:95], a[184:187], v[132:135]
ds_read_b128 a[180:183], v14 offset:13312
v_mfma_f32_16x16x32_bf16 v[104:107], a[188:191], a[88:91], v[104:107]
v_add_f32 v72, v72, v76
v_mov_b32 v76, v72
v_mfma_f32_16x16x32_bf16 v[136:139], a[188:191], a[92:95], v[136:139]
s_waitcnt vmcnt(16)
ds_read_b128 a[184:187], v14 offset:14336
s_waitcnt lgkmcnt(5)
v_mfma_f32_16x16x32_bf16 v[84:87], a[96:99], a[160:163], v[84:87]
v_permlane32_swap_b32 v72, v76
v_add_f32 v72, v72, v76
v_mfma_f32_16x16x32_bf16 v[116:119], a[100:103], a[160:163], v[116:119]
ds_read_b128 a[188:191], v14 offset:15360
v_mfma_f32_16x16x32_bf16 v[88:91], a[96:99], a[164:167], v[88:91]
buffer_load_dwordx4 a[152:155], v12, s[4:7], s20 offen offset:3072 sc1
v_mfma_f32_16x16x32_bf16 v[120:123], a[100:103], a[164:167], v[120:123]
ds_read_b128 a[160:163], v14 offset:16384
s_waitcnt lgkmcnt(5)
v_mfma_f32_16x16x32_bf16 v[92:95], a[96:99], a[168:171], v[92:95]
v_mov_b32 v76, v73
s_nop 1
v_permlane16_swap_b32 v73, v76
v_mfma_f32_16x16x32_bf16 v[124:127], a[100:103], a[168:171], v[124:127]
ds_read_b128 a[164:167], v14 offset:17408
v_mfma_f32_16x16x32_bf16 v[96:99], a[96:99], a[172:175], v[96:99]
buffer_load_dwordx4 a[156:159], v13, s[4:7], s20 offen offset:3072 sc1
v_mfma_f32_16x16x32_bf16 v[128:131], a[100:103], a[172:175], v[128:131]
ds_read_b128 a[168:171], v14 offset:18432
s_waitcnt lgkmcnt(5)
v_mfma_f32_16x16x32_bf16 v[100:103], a[96:99], a[176:179], v[100:103]
v_add_f32 v73, v73, v76
v_mov_b32 v76, v73
v_mfma_f32_16x16x32_bf16 v[132:135], a[100:103], a[176:179], v[132:135]
ds_read_b128 a[172:175], v14 offset:19456
v_mfma_f32_16x16x32_bf16 v[104:107], a[180:183], a[96:99], v[104:107]
v_permlane32_swap_b32 v73, v76
v_add_f32 v73, v73, v76
v_mfma_f32_16x16x32_bf16 v[136:139], a[180:183], a[100:103], v[136:139]
s_waitcnt vmcnt(16)
ds_read_b128 a[176:179], v14 offset:20480
s_waitcnt lgkmcnt(5)
v_mfma_f32_16x16x32_bf16 v[84:87], a[104:107], a[184:187], v[84:87]
buffer_load_dword v148, v17, s[4:7], 0 offen offset:0
v_mfma_f32_16x16x32_bf16 v[116:119], a[108:111], a[184:187], v[116:119]
ds_read_b128 a[180:183], v14 offset:21504
v_mfma_f32_16x16x32_bf16 v[88:91], a[104:107], a[188:191], v[88:91]
v_mul_f32 v37, 0x3acccccd, v72
v_mul_f32 v73, 0x3acccccd, v73
v_mfma_f32_16x16x32_bf16 v[120:123], a[108:111], a[188:191], v[120:123]
ds_read_b128 a[184:187], v14 offset:22528
s_waitcnt lgkmcnt(5)
v_mfma_f32_16x16x32_bf16 v[92:95], a[104:107], a[160:163], v[92:95]
buffer_load_dword v149, v17, s[4:7], 0 offen offset:64
v_mfma_f32_16x16x32_bf16 v[124:127], a[108:111], a[160:163], v[124:127]
ds_read_b128 a[188:191], v14 offset:23552
v_mfma_f32_16x16x32_bf16 v[96:99], a[104:107], a[164:167], v[96:99]
v_fma_f32 v73, -v37, v37, v73
v_max_f32 v73, 0, v73
v_mfma_f32_16x16x32_bf16 v[128:131], a[108:111], a[164:167], v[128:131]
ds_read_b128 a[160:163], v14 offset:24576
s_waitcnt lgkmcnt(5)
v_mfma_f32_16x16x32_bf16 v[100:103], a[104:107], a[168:171], v[100:103]
v_add_f32 v73, 0x3727c5ac, v73
v_rsq_f32 v39, v73
v_mfma_f32_16x16x32_bf16 v[132:135], a[108:111], a[168:171], v[132:135]
ds_read_b128 a[164:167], v14 offset:25600
v_mfma_f32_16x16x32_bf16 v[104:107], a[172:175], a[104:107], v[104:107]
buffer_load_dword v150, v17, s[4:7], 0 offen offset:128
v_mfma_f32_16x16x32_bf16 v[136:139], a[172:175], a[108:111], v[136:139]
s_waitcnt vmcnt(17)
ds_read_b128 a[168:171], v14 offset:26624
s_waitcnt lgkmcnt(5)
v_mfma_f32_16x16x32_bf16 v[84:87], a[112:115], a[176:179], v[84:87]
v_mul_f32 v41, 0x3fb8aa3b, v39
ds_bpermute_b32 v44, v197, v36
v_mfma_f32_16x16x32_bf16 v[116:119], a[116:119], a[176:179], v[116:119]
ds_read_b128 a[172:175], v14 offset:27648
v_mfma_f32_16x16x32_bf16 v[88:91], a[112:115], a[180:183], v[88:91]
buffer_load_dword v151, v17, s[4:7], 0 offen offset:192
v_mfma_f32_16x16x32_bf16 v[120:123], a[116:119], a[180:183], v[120:123]
ds_read_b128 a[176:179], v14 offset:28672
s_waitcnt lgkmcnt(6)
v_mfma_f32_16x16x32_bf16 v[92:95], a[112:115], a[184:187], v[92:95]
ds_bpermute_b32 v52, v197, v38
ds_bpermute_b32 v45, v198, v36
v_mfma_f32_16x16x32_bf16 v[124:127], a[116:119], a[184:187], v[124:127]
ds_read_b128 a[180:183], v14 offset:29696
v_mfma_f32_16x16x32_bf16 v[96:99], a[112:115], a[188:191], v[96:99]
ds_bpermute_b32 v53, v198, v38
ds_bpermute_b32 v46, v199, v36
v_mfma_f32_16x16x32_bf16 v[128:131], a[116:119], a[188:191], v[128:131]
ds_read_b128 a[184:187], v14 offset:30720
s_waitcnt lgkmcnt(10)
v_mfma_f32_16x16x32_bf16 v[100:103], a[112:115], a[160:163], v[100:103]
buffer_load_dword v152, v17, s[4:7], 0 offen offset:256
v_mfma_f32_16x16x32_bf16 v[132:135], a[116:119], a[160:163], v[132:135]
ds_read_b128 a[188:191], v14 offset:31744
v_mfma_f32_16x16x32_bf16 v[104:107], a[164:167], a[112:115], v[104:107]
ds_bpermute_b32 v54, v199, v38
ds_bpermute_b32 v47, v200, v36
v_mfma_f32_16x16x32_bf16 v[136:139], a[164:167], a[116:119], v[136:139]
s_waitcnt vmcnt(17)
ds_read_b128 a[160:163], v14 offset:32768
s_waitcnt lgkmcnt(11)
v_mfma_f32_16x16x32_bf16 v[84:87], a[120:123], a[168:171], v[84:87]
buffer_load_dwordx4 v[156:159], v18, s[4:7], 0 offen offset:320
v_mfma_f32_16x16x32_bf16 v[116:119], a[124:127], a[168:171], v[116:119]
ds_read_b128 a[164:167], v14 offset:33792
v_mfma_f32_16x16x32_bf16 v[88:91], a[120:123], a[172:175], v[88:91]
ds_bpermute_b32 v55, v200, v38
ds_bpermute_b32 v48, v197, v37
v_mfma_f32_16x16x32_bf16 v[120:123], a[124:127], a[172:175], v[120:123]
ds_read_b128 a[168:171], v14 offset:34816
s_waitcnt lgkmcnt(11)
v_mfma_f32_16x16x32_bf16 v[92:95], a[120:123], a[176:179], v[92:95]
ds_bpermute_b32 v56, v197, v39
ds_bpermute_b32 v49, v198, v37
v_mfma_f32_16x16x32_bf16 v[124:127], a[124:127], a[176:179], v[124:127]
ds_read_b128 a[172:175], v14 offset:35840
v_mfma_f32_16x16x32_bf16 v[96:99], a[120:123], a[180:183], v[96:99]
buffer_load_dwordx4 v[160:163], v18, s[4:7], 0 offen offset:384
v_mfma_f32_16x16x32_bf16 v[128:131], a[124:127], a[180:183], v[128:131]
ds_read_b128 a[176:179], v14 offset:36864
s_waitcnt lgkmcnt(11)
v_mfma_f32_16x16x32_bf16 v[100:103], a[120:123], a[184:187], v[100:103]
ds_bpermute_b32 v57, v198, v39
ds_bpermute_b32 v50, v199, v37
v_mfma_f32_16x16x32_bf16 v[132:135], a[124:127], a[184:187], v[132:135]
ds_read_b128 a[180:183], v14 offset:37888
v_mfma_f32_16x16x32_bf16 v[104:107], a[188:191], a[120:123], v[104:107]
ds_bpermute_b32 v58, v199, v39
ds_bpermute_b32 v51, v200, v37
v_mfma_f32_16x16x32_bf16 v[136:139], a[188:191], a[124:127], v[136:139]
s_waitcnt vmcnt(17)
ds_read_b128 a[184:187], v14 offset:38912
s_waitcnt lgkmcnt(13)
v_mfma_f32_16x16x32_bf16 v[84:87], a[128:131], a[160:163], v[84:87]
buffer_load_dwordx4 v[164:167], v18, s[4:7], 0 offen offset:448
v_mfma_f32_16x16x32_bf16 v[116:119], a[132:135], a[160:163], v[116:119]
ds_read_b128 a[188:191], v14 offset:39936
v_mfma_f32_16x16x32_bf16 v[88:91], a[128:131], a[164:167], v[88:91]
ds_bpermute_b32 v59, v200, v39
v_mfma_f32_16x16x32_bf16 v[120:123], a[132:135], a[164:167], v[120:123]
ds_read_b128 a[160:163], v14 offset:40960
s_waitcnt lgkmcnt(10)
v_mfma_f32_16x16x32_bf16 v[92:95], a[128:131], a[168:171], v[92:95]
s_add_u32 m0, s44, s45
s_nop 0
buffer_load_dwordx4 v8, s[4:7], s45 offen offset:0 sc1 lds
v_mfma_f32_16x16x32_bf16 v[124:127], a[132:135], a[168:171], v[124:127]
ds_read_b128 a[164:167], v14 offset:41984
v_mfma_f32_16x16x32_bf16 v[96:99], a[128:131], a[172:175], v[96:99]
v_mfma_f32_16x16x32_bf16 v[128:131], a[132:135], a[172:175], v[128:131]
ds_read_b128 a[168:171], v14 offset:43008
s_waitcnt lgkmcnt(8)
v_mfma_f32_16x16x32_bf16 v[100:103], a[128:131], a[176:179], v[100:103]
v_mfma_f32_16x16x32_bf16 v[132:135], a[132:135], a[176:179], v[132:135]
ds_read_b128 a[172:175], v14 offset:44032
v_mfma_f32_16x16x32_bf16 v[104:107], a[180:183], a[128:131], v[104:107]
buffer_load_dwordx4 v8, s[4:7], s45 offen offset:1024 sc1 lds
v_mfma_f32_16x16x32_bf16 v[136:139], a[180:183], a[132:135], v[136:139]
s_waitcnt vmcnt(18)
ds_read_b128 a[176:179], v14 offset:45056
s_waitcnt lgkmcnt(6)
v_mfma_f32_16x16x32_bf16 v[84:87], a[136:139], a[184:187], v[84:87]
s_waitcnt lgkmcnt(5)
v_mfma_f32_16x16x32_bf16 v[116:119], a[140:143], a[184:187], v[116:119]
ds_read_b128 a[180:183], v14 offset:46080
v_mfma_f32_16x16x32_bf16 v[88:91], a[136:139], a[188:191], v[88:91]
buffer_load_dwordx4 v8, s[4:7], s45 offen offset:2048 sc1 lds
v_mfma_f32_16x16x32_bf16 v[120:123], a[140:143], a[188:191], v[120:123]
ds_read_b128 a[184:187], v14 offset:47104
s_waitcnt lgkmcnt(5)
v_mfma_f32_16x16x32_bf16 v[92:95], a[136:139], a[160:163], v[92:95]
v_mul_f32 v60, 0x3fb8aa3b, v52
v_mul_f32 v61, 0x3fb8aa3b, v53
v_mfma_f32_16x16x32_bf16 v[124:127], a[140:143], a[160:163], v[124:127]
ds_read_b128 a[188:191], v14 offset:48128
v_mfma_f32_16x16x32_bf16 v[96:99], a[136:139], a[164:167], v[96:99]
v_mul_f32 v62, 0x3fb8aa3b, v54
v_mul_f32 v63, 0x3fb8aa3b, v55
v_mfma_f32_16x16x32_bf16 v[128:131], a[140:143], a[164:167], v[128:131]
s_waitcnt vmcnt(15)
s_barrier
ds_read_b128 a[160:163], v14 offset:49152
s_waitcnt lgkmcnt(5)
v_mfma_f32_16x16x32_bf16 v[100:103], a[136:139], a[168:171], v[100:103]
buffer_load_dwordx4 v8, s[4:7], s45 offen offset:3072 sc1 lds
s_add_u32 s45, s45, 16384
v_mfma_f32_16x16x32_bf16 v[132:135], a[140:143], a[168:171], v[132:135]
ds_read_b128 a[164:167], v14 offset:50176
v_mfma_f32_16x16x32_bf16 v[104:107], a[172:175], a[136:139], v[104:107]
v_mul_f32 v64, 0x3fb8aa3b, v56
v_mul_f32 v65, 0x3fb8aa3b, v57
v_mfma_f32_16x16x32_bf16 v[136:139], a[172:175], a[140:143], v[136:139]
s_waitcnt vmcnt(14)
ds_read_b128 a[168:171], v14 offset:51200
s_waitcnt lgkmcnt(5)
v_mfma_f32_16x16x32_bf16 v[84:87], a[144:147], a[176:179], v[84:87]
s_add_u32 m0, s44, s45
s_nop 0
buffer_load_dwordx4 v8, s[4:7], s45 offen offset:0 sc1 lds
v_mfma_f32_16x16x32_bf16 v[116:119], a[148:151], a[176:179], v[116:119]
ds_read_b128 a[172:175], v14 offset:52224
v_mfma_f32_16x16x32_bf16 v[88:91], a[144:147], a[180:183], v[88:91]
v_mul_f32 v66, 0x3fb8aa3b, v58
v_mul_f32 v67, 0x3fb8aa3b, v59
v_mfma_f32_16x16x32_bf16 v[120:123], a[148:151], a[180:183], v[120:123]
ds_read_b128 a[176:179], v14 offset:53248
s_waitcnt lgkmcnt(5)
v_mfma_f32_16x16x32_bf16 v[92:95], a[144:147], a[184:187], v[92:95]
s_mul_i32 s17, s14, 102400
s_mul_i32 s19, s10, 25600
v_mfma_f32_16x16x32_bf16 v[124:127], a[148:151], a[184:187], v[124:127]
ds_read_b128 a[180:183], v14 offset:54272
v_mfma_f32_16x16x32_bf16 v[96:99], a[144:147], a[188:191], v[96:99]
buffer_load_dwordx4 v8, s[4:7], s45 offen offset:1024 sc1 lds
v_mfma_f32_16x16x32_bf16 v[128:131], a[148:151], a[188:191], v[128:131]
ds_read_b128 a[184:187], v14 offset:55296
s_waitcnt lgkmcnt(5)
v_mfma_f32_16x16x32_bf16 v[100:103], a[144:147], a[160:163], v[100:103]
s_add_u32 s17, s17, s19
s_add_u32 s17, s17, 2621440
v_mfma_f32_16x16x32_bf16 v[132:135], a[148:151], a[160:163], v[132:135]
ds_read_b128 a[188:191], v14 offset:56320
v_mfma_f32_16x16x32_bf16 v[104:107], a[164:167], a[144:147], v[104:107]
buffer_load_dwordx4 v8, s[4:7], s45 offen offset:2048 sc1 lds
v_mfma_f32_16x16x32_bf16 v[136:139], a[164:167], a[148:151], v[136:139]
s_waitcnt vmcnt(15)
ds_read_b128 a[160:163], v14 offset:57344
s_waitcnt lgkmcnt(5)
v_mfma_f32_16x16x32_bf16 v[84:87], a[152:155], a[168:171], v[84:87]
v_add_u32 v10, s17, v2
v_mfma_f32_16x16x32_bf16 v[116:119], a[156:159], a[168:171], v[116:119]
ds_read_b128 a[164:167], v14 offset:58368
v_mfma_f32_16x16x32_bf16 v[88:91], a[152:155], a[172:175], v[88:91]
v_mfma_f32_16x16x32_bf16 v[120:123], a[156:159], a[172:175], v[120:123]
ds_read_b128 a[168:171], v14 offset:59392
s_waitcnt lgkmcnt(5)
v_mfma_f32_16x16x32_bf16 v[92:95], a[152:155], a[176:179], v[92:95]
buffer_load_dwordx4 v8, s[4:7], s45 offen offset:3072 sc1 lds
s_add_u32 s45, s45, 16384
v_mfma_f32_16x16x32_bf16 v[124:127], a[156:159], a[176:179], v[124:127]
ds_read_b128 a[172:175], v14 offset:60416
v_mfma_f32_16x16x32_bf16 v[96:99], a[152:155], a[180:183], v[96:99]
v_mfma_f32_16x16x32_bf16 v[128:131], a[156:159], a[180:183], v[128:131]
ds_read_b128 a[176:179], v14 offset:61440
s_waitcnt lgkmcnt(5)
v_mfma_f32_16x16x32_bf16 v[100:103], a[152:155], a[184:187], v[100:103]
v_mfma_f32_16x16x32_bf16 v[132:135], a[156:159], a[184:187], v[132:135]
ds_read_b128 a[180:183], v14 offset:62464
v_mfma_f32_16x16x32_bf16 v[104:107], a[188:191], a[152:155], v[104:107]
v_mfma_f32_16x16x32_bf16 v[136:139], a[188:191], a[156:159], v[136:139]
s_waitcnt vmcnt(8)
s_mov_b32 s24, 0x358637bd
v_pk_fma_f32 v[96:97], v[44:45], v[150:151], v[96:97] op_sel:[0,1,0] op_sel_hi:[1,1,1] neg_lo:[1,0,0] neg_hi:[1,0,0]
v_pk_fma_f32 v[98:99], v[46:47], v[150:151], v[98:99] op_sel:[0,1,0] op_sel_hi:[1,1,1] neg_lo:[1,0,0] neg_hi:[1,0,0]
v_pk_mul_f32 v[96:97], v[96:97], v[52:53] op_sel:[0,0] op_sel_hi:[1,1]
v_pk_mul_f32 v[98:99], v[98:99], v[54:55] op_sel:[0,0] op_sel_hi:[1,1]
v_cvt_pk_bf16_f32 v180, v96, v97
v_cvt_pk_bf16_f32 v181, v98, v99
v_pk_fma_f32 v[128:129], v[48:49], v[150:151], v[128:129] op_sel:[0,1,0] op_sel_hi:[1,1,1] neg_lo:[1,0,0] neg_hi:[1,0,0]
v_pk_fma_f32 v[130:131], v[50:51], v[150:151], v[130:131] op_sel:[0,1,0] op_sel_hi:[1,1,1] neg_lo:[1,0,0] neg_hi:[1,0,0]
v_pk_mul_f32 v[128:129], v[128:129], v[56:57] op_sel:[0,0] op_sel_hi:[1,1]
v_pk_mul_f32 v[130:131], v[130:131], v[58:59] op_sel:[0,0] op_sel_hi:[1,1]
v_cvt_pk_bf16_f32 v182, v128, v129
v_cvt_pk_bf16_f32 v183, v130, v131
v_pk_fma_f32 v[92:93], v[44:45], v[150:151], v[92:93] op_sel:[0,0,0] op_sel_hi:[1,0,1] neg_lo:[1,0,0] neg_hi:[1,0,0]
v_pk_fma_f32 v[94:95], v[46:47], v[150:151], v[94:95] op_sel:[0,0,0] op_sel_hi:[1,0,1] neg_lo:[1,0,0] neg_hi:[1,0,0]
v_pk_mul_f32 v[68:69], v[92:93], v[60:61] op_sel:[0,0] op_sel_hi:[1,1]
v_pk_mul_f32 v[70:71], v[94:95], v[62:63] op_sel:[0,0] op_sel_hi:[1,1]
v_pk_mul_f32 v[72:73], v[92:93], v[52:53] op_sel:[0,0] op_sel_hi:[1,1]
v_pk_mul_f32 v[74:75], v[94:95], v[54:55] op_sel:[0,0] op_sel_hi:[1,1]
v_pk_fma_f32 v[92:93], v[92:93], v[52:53], s[24:25] op_sel:[0,0,0] op_sel_hi:[1,1,0]
v_pk_fma_f32 v[94:95], v[94:95], v[54:55], s[24:25] op_sel:[0,0,0] op_sel_hi:[1,1,0]
v_exp_f32 v68, v68 clamp
v_exp_f32 v69, v69 clamp
v_exp_f32 v70, v70 clamp
v_exp_f32 v71, v71 clamp
v_max_f32 v92, s24, v92
v_max_f32 v93, s24, v93
v_max_f32 v94, s24, v94
v_max_f32 v95, s24, v95
v_pk_add_f32 v[92:93], v[92:93], v[68:69] op_sel:[0,0] op_sel_hi:[1,1]
v_pk_add_f32 v[94:95], v[94:95], v[70:71] op_sel:[0,0] op_sel_hi:[1,1]
v_cndmask_b32 v92, v72, v92, s[26:27]
v_cndmask_b32 v93, v73, v93, s[26:27]
v_cndmask_b32 v94, v74, v94, s[26:27]
v_cndmask_b32 v95, v75, v95, s[26:27]
v_cvt_pk_bf16_f32 v176, v92, v93
v_cvt_pk_bf16_f32 v177, v94, v95
v_pk_fma_f32 v[124:125], v[48:49], v[150:151], v[124:125] op_sel:[0,0,0] op_sel_hi:[1,0,1] neg_lo:[1,0,0] neg_hi:[1,0,0]
v_pk_fma_f32 v[126:127], v[50:51], v[150:151], v[126:127] op_sel:[0,0,0] op_sel_hi:[1,0,1] neg_lo:[1,0,0] neg_hi:[1,0,0]
v_pk_mul_f32 v[68:69], v[124:125], v[64:65] op_sel:[0,0] op_sel_hi:[1,1]
v_pk_mul_f32 v[70:71], v[126:127], v[66:67] op_sel:[0,0] op_sel_hi:[1,1]
v_pk_mul_f32 v[72:73], v[124:125], v[56:57] op_sel:[0,0] op_sel_hi:[1,1]
v_pk_mul_f32 v[74:75], v[126:127], v[58:59] op_sel:[0,0] op_sel_hi:[1,1]
v_pk_fma_f32 v[124:125], v[124:125], v[56:57], s[24:25] op_sel:[0,0,0] op_sel_hi:[1,1,0]
v_pk_fma_f32 v[126:127], v[126:127], v[58:59], s[24:25] op_sel:[0,0,0] op_sel_hi:[1,1,0]
v_exp_f32 v68, v68 clamp
v_exp_f32 v69, v69 clamp
v_exp_f32 v70, v70 clamp
v_exp_f32 v71, v71 clamp
v_max_f32 v124, s24, v124
v_max_f32 v125, s24, v125
v_max_f32 v126, s24, v126
v_max_f32 v127, s24, v127
v_pk_add_f32 v[124:125], v[124:125], v[68:69] op_sel:[0,0] op_sel_hi:[1,1]
v_pk_add_f32 v[126:127], v[126:127], v[70:71] op_sel:[0,0] op_sel_hi:[1,1]
v_cndmask_b32 v124, v72, v124, s[26:27]
v_cndmask_b32 v125, v73, v125, s[26:27]
v_cndmask_b32 v126, v74, v126, s[26:27]
v_cndmask_b32 v127, v75, v127, s[26:27]
v_cvt_pk_bf16_f32 v178, v124, v125
v_cvt_pk_bf16_f32 v179, v126, v127
v_mov_b32 v68, 0x3f803f80
v_cndmask_b32 v188, v176, v68, s[26:27]
v_cndmask_b32 v189, v177, v68, s[26:27]
v_cndmask_b32 v190, v178, v68, s[26:27]
v_cndmask_b32 v191, v179, v68, s[26:27]
s_nop 1
v_mfma_f32_16x16x32_bf16 v[212:215], v[176:179], v[188:191], 0
v_mfma_f32_16x16x32_bf16 v[216:219], v[176:179], v[180:183], 0
s_nop 0
v_pk_fma_f32 v[84:85], v[44:45], v[148:149], v[84:85] op_sel:[0,0,0] op_sel_hi:[1,0,1] neg_lo:[1,0,0] neg_hi:[1,0,0]
v_pk_fma_f32 v[86:87], v[46:47], v[148:149], v[86:87] op_sel:[0,0,0] op_sel_hi:[1,0,1] neg_lo:[1,0,0] neg_hi:[1,0,0]
v_pk_mul_f32 v[68:69], v[84:85], v[60:61] op_sel:[0,0] op_sel_hi:[1,1]
v_pk_mul_f32 v[70:71], v[86:87], v[62:63] op_sel:[0,0] op_sel_hi:[1,1]
v_pk_fma_f32 v[84:85], v[84:85], v[52:53], s[24:25] op_sel:[0,0,0] op_sel_hi:[1,1,0]
v_pk_fma_f32 v[86:87], v[86:87], v[54:55], s[24:25] op_sel:[0,0,0] op_sel_hi:[1,1,0]
v_exp_f32 v68, v68 clamp
ds_write_b128 v29, v[212:215]
v_exp_f32 v69, v69 clamp
v_exp_f32 v70, v70 clamp
v_exp_f32 v71, v71 clamp
v_max_f32 v84, s24, v84
v_max_f32 v85, s24, v85
v_max_f32 v86, s24, v86
v_max_f32 v87, s24, v87
v_pk_add_f32 v[84:85], v[84:85], v[68:69] op_sel:[0,0] op_sel_hi:[1,1]
v_pk_add_f32 v[86:87], v[86:87], v[70:71] op_sel:[0,0] op_sel_hi:[1,1]
v_cvt_pk_bf16_f32 v168, v84, v85
v_cvt_pk_bf16_f32 v169, v86, v87
v_pk_fma_f32 v[116:117], v[48:49], v[148:149], v[116:117] op_sel:[0,0,0] op_sel_hi:[1,0,1] neg_lo:[1,0,0] neg_hi:[1,0,0]
ds_write_b128 v30, v[216:219]
v_pk_fma_f32 v[118:119], v[50:51], v[148:149], v[118:119] op_sel:[0,0,0] op_sel_hi:[1,0,1] neg_lo:[1,0,0] neg_hi:[1,0,0]
v_pk_mul_f32 v[68:69], v[116:117], v[64:65] op_sel:[0,0] op_sel_hi:[1,1]
v_pk_mul_f32 v[70:71], v[118:119], v[66:67] op_sel:[0,0] op_sel_hi:[1,1]
v_pk_fma_f32 v[116:117], v[116:117], v[56:57], s[24:25] op_sel:[0,0,0] op_sel_hi:[1,1,0]
v_pk_fma_f32 v[118:119], v[118:119], v[58:59], s[24:25] op_sel:[0,0,0] op_sel_hi:[1,1,0]
v_exp_f32 v68, v68 clamp
v_exp_f32 v69, v69 clamp
v_exp_f32 v70, v70 clamp
v_exp_f32 v71, v71 clamp
v_max_f32 v116, s24, v116
v_max_f32 v117, s24, v117
v_max_f32 v118, s24, v118
v_max_f32 v119, s24, v119
v_pk_add_f32 v[116:117], v[116:117], v[68:69] op_sel:[0,0] op_sel_hi:[1,1]
v_pk_add_f32 v[118:119], v[118:119], v[70:71] op_sel:[0,0] op_sel_hi:[1,1]
v_cvt_pk_bf16_f32 v170, v116, v117
v_cvt_pk_bf16_f32 v171, v118, v119
s_nop 1
v_mfma_f32_16x16x32_bf16 v[192:195], v[168:171], v[188:191], 0
v_mfma_f32_16x16x32_bf16 v[196:199], v[168:171], v[180:183], 0
s_nop 0
v_pk_fma_f32 v[100:101], v[44:45], v[152:153], v[100:101] op_sel:[0,0,0] op_sel_hi:[1,0,1] neg_lo:[1,0,0] neg_hi:[1,0,0]
v_pk_fma_f32 v[102:103], v[46:47], v[152:153], v[102:103] op_sel:[0,0,0] op_sel_hi:[1,0,1] neg_lo:[1,0,0] neg_hi:[1,0,0]
v_pk_mul_f32 v[100:101], v[100:101], v[52:53] op_sel:[0,0] op_sel_hi:[1,1]
v_pk_mul_f32 v[102:103], v[102:103], v[54:55] op_sel:[0,0] op_sel_hi:[1,1]
v_cvt_pk_bf16_f32 v184, v100, v101
v_cvt_pk_bf16_f32 v185, v102, v103
v_pk_fma_f32 v[132:133], v[48:49], v[152:153], v[132:133] op_sel:[0,0,0] op_sel_hi:[1,0,1] neg_lo:[1,0,0] neg_hi:[1,0,0]
ds_write_b128 v24, v[192:195]
v_pk_fma_f32 v[134:135], v[50:51], v[152:153], v[134:135] op_sel:[0,0,0] op_sel_hi:[1,0,1] neg_lo:[1,0,0] neg_hi:[1,0,0]
v_pk_mul_f32 v[132:133], v[132:133], v[56:57] op_sel:[0,0] op_sel_hi:[1,1]
v_pk_mul_f32 v[134:135], v[134:135], v[58:59] op_sel:[0,0] op_sel_hi:[1,1]
v_cvt_pk_bf16_f32 v186, v132, v133
v_cvt_pk_bf16_f32 v187, v134, v135
s_nop 1
v_mfma_f32_16x16x32_bf16 v[220:223], v[176:179], v[184:187], 0
s_nop 0
v_pk_fma_f32 v[88:89], v[44:45], v[148:149], v[88:89] op_sel:[0,1,0] op_sel_hi:[1,1,1] neg_lo:[1,0,0] neg_hi:[1,0,0]
v_pk_fma_f32 v[90:91], v[46:47], v[148:149], v[90:91] op_sel:[0,1,0] op_sel_hi:[1,1,1] neg_lo:[1,0,0] neg_hi:[1,0,0]
v_pk_mul_f32 v[68:69], v[88:89], v[60:61] op_sel:[0,0] op_sel_hi:[1,1]
v_pk_mul_f32 v[70:71], v[90:91], v[62:63] op_sel:[0,0] op_sel_hi:[1,1]
v_pk_fma_f32 v[88:89], v[88:89], v[52:53], s[24:25] op_sel:[0,0,0] op_sel_hi:[1,1,0]
v_pk_fma_f32 v[90:91], v[90:91], v[54:55], s[24:25] op_sel:[0,0,0] op_sel_hi:[1,1,0]
v_exp_f32 v68, v68 clamp
s_nop 0
ds_write_b128 v31, v[220:223]
v_exp_f32 v69, v69 clamp
v_exp_f32 v70, v70 clamp
v_exp_f32 v71, v71 clamp
v_max_f32 v88, s24, v88
v_max_f32 v89, s24, v89
v_max_f32 v90, s24, v90
v_max_f32_e64 v91, s24, v91
v_pk_add_f32 v[88:89], v[88:89], v[68:69] op_sel:[0,0] op_sel_hi:[1,1]
v_pk_add_f32 v[90:91], v[90:91], v[70:71] op_sel:[0,0] op_sel_hi:[1,1]
v_cvt_pk_bf16_f32 v172, v88, v89
v_cvt_pk_bf16_f32 v173, v90, v91
v_pk_fma_f32 v[120:121], v[48:49], v[148:149], v[120:121] op_sel:[0,1,0] op_sel_hi:[1,1,1] neg_lo:[1,0,0] neg_hi:[1,0,0]
ds_write_b128 v25, v[196:199]
v_pk_fma_f32 v[122:123], v[50:51], v[148:149], v[122:123] op_sel:[0,1,0] op_sel_hi:[1,1,1] neg_lo:[1,0,0] neg_hi:[1,0,0]
v_pk_mul_f32 v[68:69], v[120:121], v[64:65] op_sel:[0,0] op_sel_hi:[1,1]
v_pk_mul_f32 v[70:71], v[122:123], v[66:67] op_sel:[0,0] op_sel_hi:[1,1]
v_pk_fma_f32 v[120:121], v[120:121], v[56:57], s[24:25] op_sel:[0,0,0] op_sel_hi:[1,1,0]
v_pk_fma_f32 v[122:123], v[122:123], v[58:59], s[24:25] op_sel:[0,0,0] op_sel_hi:[1,1,0]
v_exp_f32 v68, v68 clamp
v_exp_f32 v69, v69 clamp
v_exp_f32 v70, v70 clamp
v_exp_f32 v71, v71 clamp
v_max_f32 v120, s24, v120
v_max_f32 v121, s24, v121
v_max_f32 v122, s24, v122
v_max_f32 v123, s24, v123
v_pk_add_f32 v[120:121], v[120:121], v[68:69] op_sel:[0,0] op_sel_hi:[1,1]
v_pk_add_f32 v[122:123], v[122:123], v[70:71] op_sel:[0,0] op_sel_hi:[1,1]
v_cvt_pk_bf16_f32 v174, v120, v121
v_cvt_pk_bf16_f32 v175, v122, v123
s_nop 1
v_mfma_f32_16x16x32_bf16 v[200:203], v[172:175], v[188:191], 0
v_mfma_f32_16x16x32_bf16 v[204:207], v[172:175], v[180:183], 0
v_mfma_f32_16x16x32_bf16 v[208:211], v[172:175], v[184:187], 0
s_nop 5
ds_write_b128 v26, v[200:203]
ds_write_b128 v27, v[204:207]
ds_write_b128 v28, v[208:211]
v_pk_fma_f32 v[104:105], v[36:37], v[156:157], v[104:105] op_sel:[0,0,0] op_sel_hi:[0,1,1] neg_lo:[1,0,0] neg_hi:[1,0,0]
v_pk_fma_f32 v[106:107], v[36:37], v[158:159], v[106:107] op_sel:[0,0,0] op_sel_hi:[0,1,1] neg_lo:[1,0,0] neg_hi:[1,0,0]
v_pk_mul_f32 v[68:69], v[104:105], v[40:41] op_sel:[0,0] op_sel_hi:[1,0]
v_pk_mul_f32 v[70:71], v[106:107], v[40:41] op_sel:[0,0] op_sel_hi:[1,0]
v_pk_fma_f32 v[104:105], v[104:105], v[38:39], s[24:25] op_sel:[0,0,0] op_sel_hi:[1,0,0]
v_pk_fma_f32 v[106:107], v[106:107], v[38:39], s[24:25] op_sel:[0,0,0] op_sel_hi:[1,0,0]
v_exp_f32 v68, v68 clamp
v_exp_f32 v69, v69 clamp
v_exp_f32 v70, v70 clamp
v_exp_f32 v71, v71 clamp
v_max_f32 v104, s24, v104
v_max_f32 v105, s24, v105
v_max_f32 v106, s24, v106
v_max_f32 v107, s24, v107
v_pk_add_f32 v[104:105], v[104:105], v[68:69] op_sel:[0,0] op_sel_hi:[1,1]
v_pk_add_f32 v[106:107], v[106:107], v[70:71] op_sel:[0,0] op_sel_hi:[1,1]
v_cvt_pk_bf16_f32 v168, v104, v105
v_cvt_pk_bf16_f32 v169, v106, v107
s_waitcnt lgkmcnt(0)
s_barrier
ds_read_b32 v192, v33 offset:0
ds_read_b32 v193, v33 offset:3584
ds_read_b32 v194, v33 offset:7168
ds_read_b32 v195, v33 offset:10752
ds_read_b32 v196, v33 offset:1024
ds_read_b32 v197, v33 offset:4608
ds_read_b32 v198, v33 offset:8192
ds_read_b32 v199, v33 offset:11776
ds_read_b32 v200, v33 offset:2048
ds_read_b32 v201, v33 offset:5632
ds_read_b32 v202, v33 offset:9216
ds_read_b32 v203, v33 offset:12800
ds_read_b32 v204, v33 offset:3072
ds_read_b32 v205, v33 offset:6656
ds_read_b32 v206, v33 offset:10240
ds_read_b32 v207, v33 offset:13824
v_mov_b32 v209, 0x40000000
v_cmp_gt_u32 vcc, 72, v0
s_nop 1
v_cndmask_b32 v208, v209, v32, vcc
s_waitcnt lgkmcnt(12)
v_pk_add_f32 v[192:193], v[192:193], v[194:195] op_sel:[0,0] op_sel_hi:[1,1]
v_add_f32 v192, v192, v193
buffer_atomic_add_f32 v192, v32, s[4:7], 0 offen offset:0
s_waitcnt lgkmcnt(8)
v_pk_add_f32 v[196:197], v[196:197], v[198:199] op_sel:[0,0] op_sel_hi:[1,1]
v_add_f32 v196, v196, v197
buffer_atomic_add_f32 v196, v32, s[4:7], 0 offen offset:1024
s_waitcnt lgkmcnt(4)
v_pk_add_f32 v[200:201], v[200:201], v[202:203] op_sel:[0,0] op_sel_hi:[1,1]
v_add_f32 v200, v200, v201
buffer_atomic_add_f32 v200, v32, s[4:7], 0 offen offset:2048
s_waitcnt lgkmcnt(0)
v_pk_add_f32 v[204:205], v[204:205], v[206:207] op_sel:[0,0] op_sel_hi:[1,1]
v_add_f32 v204, v204, v205
buffer_atomic_add_f32 v204, v208, s[4:7], 0 offen offset:3072
v_mov_b32 v35, 1
ds_read_b128 a[184:187], v14 offset:63488
v_mfma_f32_16x16x32_bf16 v[108:111], a[160:163], a[0:3], 0
v_cmp_lt_u32 s[36:37], 0, v4
v_mov_b32 v120, s24
v_mfma_f32_16x16x32_bf16 v[140:143], a[160:163], a[4:7], 0
ds_read_b128 a[188:191], v14 offset:64512
v_mfma_f32_16x16x32_bf16 v[112:115], a[164:167], a[0:3], 0
v_mov_b32 v121, s24
v_mov_b32 v122, s24
v_mfma_f32_16x16x32_bf16 v[144:147], a[164:167], a[4:7], 0
s_waitcnt vmcnt(8)
s_barrier
ds_read_b128 a[160:163], v15 offset:0
v_mfma_f32_16x16x32_bf16 v[108:111], a[168:171], a[8:11], v[108:111]
s_mov_b32 s47, 0
buffer_load_dwordx4 a[192:195], v10, s[4:7], s47 offen offset:0 sc1
v_mfma_f32_16x16x32_bf16 v[140:143], a[168:171], a[12:15], v[140:143]
ds_read_b128 a[164:167], v15 offset:1024
v_mfma_f32_16x16x32_bf16 v[112:115], a[172:175], a[8:11], v[112:115]
v_mov_b32 v123, s24
v_mfma_f32_16x16x32_bf16 v[144:147], a[172:175], a[12:15], v[144:147]
ds_read_b128 a[168:171], v15 offset:2048
v_mfma_f32_16x16x32_bf16 v[108:111], a[176:179], a[16:19], v[108:111]
v_mfma_f32_16x16x32_bf16 v[140:143], a[176:179], a[20:23], v[140:143]
ds_read_b128 a[172:175], v15 offset:3072
v_mfma_f32_16x16x32_bf16 v[112:115], a[180:183], a[16:19], v[112:115]
buffer_load_dwordx4 a[196:199], v10, s[4:7], s47 offen offset:1024 sc1
v_mfma_f32_16x16x32_bf16 v[144:147], a[180:183], a[20:23], v[144:147]
ds_read_b128 a[176:179], v15 offset:4096
s_waitcnt lgkmcnt(5)
v_mfma_f32_16x16x32_bf16 v[108:111], a[184:187], a[24:27], v[108:111]
v_mfma_f32_16x16x32_bf16 v[140:143], a[184:187], a[28:31], v[140:143]
ds_read_b128 a[180:183], v15 offset:5120
v_mfma_f32_16x16x32_bf16 v[112:115], a[188:191], a[24:27], v[112:115]
v_mfma_f32_16x16x32_bf16 v[144:147], a[188:191], a[28:31], v[144:147]
ds_read_b128 a[184:187], v15 offset:6144
s_waitcnt lgkmcnt(5)
v_mfma_f32_16x16x32_bf16 v[108:111], a[160:163], a[32:35], v[108:111]
buffer_load_dwordx4 a[200:203], v10, s[4:7], s47 offen offset:2048 sc1
v_mfma_f32_16x16x32_bf16 v[140:143], a[160:163], a[36:39], v[140:143]
ds_read_b128 a[188:191], v15 offset:7168
v_mfma_f32_16x16x32_bf16 v[112:115], a[164:167], a[32:35], v[112:115]
v_mfma_f32_16x16x32_bf16 v[144:147], a[164:167], a[36:39], v[144:147]
ds_read_b128 a[160:163], v15 offset:8192
s_waitcnt lgkmcnt(5)
v_mfma_f32_16x16x32_bf16 v[108:111], a[168:171], a[40:43], v[108:111]
v_mfma_f32_16x16x32_bf16 v[140:143], a[168:171], a[44:47], v[140:143]
ds_read_b128 a[164:167], v15 offset:9216
v_mfma_f32_16x16x32_bf16 v[112:115], a[172:175], a[40:43], v[112:115]
buffer_load_dwordx4 a[204:207], v10, s[4:7], s47 offen offset:3072 sc1
v_mfma_f32_16x16x32_bf16 v[144:147], a[172:175], a[44:47], v[144:147]
ds_read_b128 a[168:171], v15 offset:10240
s_waitcnt lgkmcnt(5)
v_mfma_f32_16x16x32_bf16 v[108:111], a[176:179], a[48:51], v[108:111]
v_mfma_f32_16x16x32_bf16 v[140:143], a[176:179], a[52:55], v[140:143]
ds_read_b128 a[172:175], v15 offset:11264
v_mfma_f32_16x16x32_bf16 v[112:115], a[180:183], a[48:51], v[112:115]
v_mfma_f32_16x16x32_bf16 v[144:147], a[180:183], a[52:55], v[144:147]
ds_read_b128 a[176:179], v15 offset:12288
s_waitcnt lgkmcnt(5)
v_mfma_f32_16x16x32_bf16 v[108:111], a[184:187], a[56:59], v[108:111]
s_mov_b32 s47, 4096
buffer_load_dwordx4 a[208:211], v10, s[4:7], s47 offen offset:0 sc1
v_mfma_f32_16x16x32_bf16 v[140:143], a[184:187], a[60:63], v[140:143]
ds_read_b128 a[180:183], v15 offset:13312
v_mfma_f32_16x16x32_bf16 v[112:115], a[188:191], a[56:59], v[112:115]
v_mfma_f32_16x16x32_bf16 v[144:147], a[188:191], a[60:63], v[144:147]
ds_read_b128 a[184:187], v15 offset:14336
s_waitcnt lgkmcnt(5)
v_mfma_f32_16x16x32_bf16 v[108:111], a[160:163], a[64:67], v[108:111]
v_mfma_f32_16x16x32_bf16 v[140:143], a[160:163], a[68:71], v[140:143]
ds_read_b128 a[188:191], v15 offset:15360
v_mfma_f32_16x16x32_bf16 v[112:115], a[164:167], a[64:67], v[112:115]
s_mov_b32 s47, 5120
buffer_load_dwordx4 a[212:215], v10, s[4:7], s47 offen offset:0 sc1
v_mfma_f32_16x16x32_bf16 v[144:147], a[164:167], a[68:71], v[144:147]
s_waitcnt vmcnt(10)
s_barrier
ds_read_b128 a[160:163], v15 offset:16384
s_waitcnt lgkmcnt(5)
v_mfma_f32_16x16x32_bf16 v[108:111], a[168:171], a[72:75], v[108:111]
v_mfma_f32_16x16x32_bf16 v[140:143], a[168:171], a[76:79], v[140:143]
ds_read_b128 a[164:167], v15 offset:17408
v_mfma_f32_16x16x32_bf16 v[112:115], a[172:175], a[72:75], v[112:115]
v_mfma_f32_16x16x32_bf16 v[144:147], a[172:175], a[76:79], v[144:147]
ds_read_b128 a[168:171], v15 offset:18432
s_waitcnt lgkmcnt(5)
v_mfma_f32_16x16x32_bf16 v[108:111], a[176:179], a[80:83], v[108:111]
buffer_load_dwordx4 a[216:219], v10, s[4:7], s47 offen offset:1024 sc1
v_mfma_f32_16x16x32_bf16 v[140:143], a[176:179], a[84:87], v[140:143]
ds_read_b128 a[172:175], v15 offset:19456
v_mfma_f32_16x16x32_bf16 v[112:115], a[180:183], a[80:83], v[112:115]
v_mfma_f32_16x16x32_bf16 v[144:147], a[180:183], a[84:87], v[144:147]
ds_read_b128 a[176:179], v15 offset:20480
s_waitcnt lgkmcnt(5)
v_mfma_f32_16x16x32_bf16 v[108:111], a[184:187], a[88:91], v[108:111]
v_mfma_f32_16x16x32_bf16 v[140:143], a[184:187], a[92:95], v[140:143]
ds_read_b128 a[180:183], v15 offset:21504
v_mfma_f32_16x16x32_bf16 v[112:115], a[188:191], a[88:91], v[112:115]
buffer_load_dwordx4 a[220:223], v10, s[4:7], s47 offen offset:2048 sc1
v_mfma_f32_16x16x32_bf16 v[144:147], a[188:191], a[92:95], v[144:147]
s_waitcnt vmcnt(8)
s_barrier
buffer_atomic_add v35, v34, s[4:7], 0 offen
ds_read_b128 a[184:187], v15 offset:22528
s_waitcnt lgkmcnt(5)
v_mfma_f32_16x16x32_bf16 v[108:111], a[160:163], a[96:99], v[108:111]
v_mfma_f32_16x16x32_bf16 v[140:143], a[160:163], a[100:103], v[140:143]
ds_read_b128 a[188:191], v15 offset:23552
v_mfma_f32_16x16x32_bf16 v[112:115], a[164:167], a[96:99], v[112:115]
v_mfma_f32_16x16x32_bf16 v[144:147], a[164:167], a[100:103], v[144:147]
ds_read_b128 a[160:163], v15 offset:24576
s_waitcnt lgkmcnt(5)
v_mfma_f32_16x16x32_bf16 v[108:111], a[168:171], a[104:107], v[108:111]
buffer_load_dwordx4 a[224:227], v10, s[4:7], s47 offen offset:3072 sc1
v_mfma_f32_16x16x32_bf16 v[140:143], a[168:171], a[108:111], v[140:143]
ds_read_b128 a[164:167], v15 offset:25600
v_mfma_f32_16x16x32_bf16 v[112:115], a[172:175], a[104:107], v[112:115]
v_mfma_f32_16x16x32_bf16 v[144:147], a[172:175], a[108:111], v[144:147]
ds_read_b128 a[168:171], v15 offset:26624
s_waitcnt lgkmcnt(5)
v_mfma_f32_16x16x32_bf16 v[108:111], a[176:179], a[112:115], v[108:111]
v_mfma_f32_16x16x32_bf16 v[140:143], a[176:179], a[116:119], v[140:143]
ds_read_b128 a[172:175], v15 offset:27648
v_mfma_f32_16x16x32_bf16 v[112:115], a[180:183], a[112:115], v[112:115]
s_mov_b32 s47, 9216
buffer_load_dwordx4 a[228:231], v10, s[4:7], s47 offen offset:0 sc1
v_mfma_f32_16x16x32_bf16 v[144:147], a[180:183], a[116:119], v[144:147]
ds_read_b128 a[176:179], v15 offset:28672
s_waitcnt lgkmcnt(5)
v_mfma_f32_16x16x32_bf16 v[108:111], a[184:187], a[120:123], v[108:111]
v_mfma_f32_16x16x32_bf16 v[140:143], a[184:187], a[124:127], v[140:143]
ds_read_b128 a[180:183], v15 offset:29696
v_mfma_f32_16x16x32_bf16 v[112:115], a[188:191], a[120:123], v[112:115]
v_mfma_f32_16x16x32_bf16 v[144:147], a[188:191], a[124:127], v[144:147]
ds_read_b128 a[184:187], v15 offset:30720
s_waitcnt lgkmcnt(5)
v_mfma_f32_16x16x32_bf16 v[108:111], a[160:163], a[128:131], v[108:111]
s_mov_b32 s47, 10240
buffer_load_dwordx4 a[232:235], v10, s[4:7], s47 offen offset:0 sc1
v_mfma_f32_16x16x32_bf16 v[140:143], a[160:163], a[132:135], v[140:143]
ds_read_b128 a[188:191], v15 offset:31744
v_mfma_f32_16x16x32_bf16 v[112:115], a[164:167], a[128:131], v[112:115]
v_mfma_f32_16x16x32_bf16 v[144:147], a[164:167], a[132:135], v[144:147]
s_waitcnt lgkmcnt(4)
v_mfma_f32_16x16x32_bf16 v[108:111], a[168:171], a[136:139], v[108:111]
v_mfma_f32_16x16x32_bf16 v[140:143], a[168:171], a[140:143], v[140:143]
v_mfma_f32_16x16x32_bf16 v[112:115], a[172:175], a[136:139], v[112:115]
buffer_load_dwordx4 a[236:239], v10, s[4:7], s47 offen offset:1024 sc1
v_mfma_f32_16x16x32_bf16 v[144:147], a[172:175], a[140:143], v[144:147]
s_waitcnt lgkmcnt(2)
v_mfma_f32_16x16x32_bf16 v[108:111], a[176:179], a[144:147], v[108:111]
v_mfma_f32_16x16x32_bf16 v[140:143], a[176:179], a[148:151], v[140:143]
v_mfma_f32_16x16x32_bf16 v[112:115], a[180:183], a[144:147], v[112:115]
v_mfma_f32_16x16x32_bf16 v[144:147], a[180:183], a[148:151], v[144:147]
s_waitcnt lgkmcnt(0)
v_mfma_f32_16x16x32_bf16 v[108:111], a[184:187], a[152:155], v[108:111]
buffer_load_dwordx4 a[240:243], v10, s[4:7], s47 offen offset:2048 sc1
v_mfma_f32_16x16x32_bf16 v[140:143], a[184:187], a[156:159], v[140:143]
v_mfma_f32_16x16x32_bf16 v[112:115], a[188:191], a[152:155], v[112:115]
v_mfma_f32_16x16x32_bf16 v[144:147], a[188:191], a[156:159], v[144:147]
v_mov_b32 v252, 0
v_mov_b32 v253, 0
buffer_atomic_add v253, v153, s[4:7], 0 offen sc0
v_pk_fma_f32 v[136:137], v[36:37], v[156:157], v[136:137] op_sel:[1,0,0] op_sel_hi:[1,1,1] neg_lo:[1,0,0] neg_hi:[1,0,0]
v_pk_fma_f32 v[138:139], v[36:37], v[158:159], v[138:139] op_sel:[1,0,0] op_sel_hi:[1,1,1] neg_lo:[1,0,0] neg_hi:[1,0,0]
v_pk_mul_f32 v[68:69], v[136:137], v[40:41] op_sel:[0,1] op_sel_hi:[1,1]
v_pk_mul_f32 v[70:71], v[138:139], v[40:41] op_sel:[0,1] op_sel_hi:[1,1]
v_pk_fma_f32 v[136:137], v[136:137], v[38:39], s[24:25] op_sel:[0,1,0] op_sel_hi:[1,1,0]
v_pk_fma_f32 v[138:139], v[138:139], v[38:39], s[24:25] op_sel:[0,1,0] op_sel_hi:[1,1,0]
v_exp_f32 v68, v68 clamp
v_exp_f32 v69, v69 clamp
v_exp_f32 v70, v70 clamp
v_exp_f32 v71, v71 clamp
v_max_f32 v136, s24, v136
v_max_f32 v137, s24, v137
v_max_f32 v138, s24, v138
v_max_f32 v139, s24, v139
v_pk_add_f32 v[136:137], v[136:137], v[68:69] op_sel:[0,0] op_sel_hi:[1,1]
v_pk_add_f32 v[138:139], v[138:139], v[70:71] op_sel:[0,0] op_sel_hi:[1,1]
buffer_load_dwordx4 a[244:247], v10, s[4:7], s47 offen offset:3072 sc1
v_cvt_pk_bf16_f32 v172, v136, v137
v_cvt_pk_bf16_f32 v173, v138, v139
v_pk_fma_f32 v[108:109], v[36:37], v[160:161], v[108:109] op_sel:[0,0,0] op_sel_hi:[0,1,1] neg_lo:[1,0,0] neg_hi:[1,0,0]
v_pk_fma_f32 v[110:111], v[36:37], v[162:163], v[110:111] op_sel:[0,0,0] op_sel_hi:[0,1,1] neg_lo:[1,0,0] neg_hi:[1,0,0]
v_pk_mul_f32 v[68:69], v[108:109], v[40:41] op_sel:[0,0] op_sel_hi:[1,0]
v_pk_mul_f32 v[70:71], v[110:111], v[40:41] op_sel:[0,0] op_sel_hi:[1,0]
v_pk_fma_f32 v[108:109], v[108:109], v[38:39], s[24:25] op_sel:[0,0,0] op_sel_hi:[1,0,0]
v_pk_fma_f32 v[110:111], v[110:111], v[38:39], s[24:25] op_sel:[0,0,0] op_sel_hi:[1,0,0]
v_exp_f32 v68, v68 clamp
v_exp_f32 v69, v69 clamp
v_exp_f32 v70, v70 clamp
v_exp_f32 v71, v71 clamp
v_max_f32 v108, s24, v108
v_max_f32 v109, s24, v109
v_max_f32 v110, s24, v110
v_max_f32 v111, s24, v111
s_mov_b32 s47, 14336
buffer_load_dwordx4 a[248:251], v10, s[4:7], s47 offen offset:0 sc1
v_pk_add_f32 v[108:109], v[108:109], v[68:69] op_sel:[0,0] op_sel_hi:[1,1]
v_pk_add_f32 v[110:111], v[110:111], v[70:71] op_sel:[0,0] op_sel_hi:[1,1]
v_cvt_pk_bf16_f32 v170, v108, v109
v_cvt_pk_bf16_f32 v171, v110, v111
buffer_atomic_add v252, v153, s[4:7], 0 offen sc0
v_pk_fma_f32 v[140:141], v[36:37], v[160:161], v[140:141] op_sel:[1,0,0] op_sel_hi:[1,1,1] neg_lo:[1,0,0] neg_hi:[1,0,0]
v_pk_fma_f32 v[142:143], v[36:37], v[162:163], v[142:143] op_sel:[1,0,0] op_sel_hi:[1,1,1] neg_lo:[1,0,0] neg_hi:[1,0,0]
v_pk_mul_f32 v[68:69], v[140:141], v[40:41] op_sel:[0,1] op_sel_hi:[1,1]
v_pk_mul_f32 v[70:71], v[142:143], v[40:41] op_sel:[0,1] op_sel_hi:[1,1]
v_pk_fma_f32 v[140:141], v[140:141], v[38:39], s[24:25] op_sel:[0,1,0] op_sel_hi:[1,1,0]
v_pk_fma_f32 v[142:143], v[142:143], v[38:39], s[24:25] op_sel:[0,1,0] op_sel_hi:[1,1,0]
v_exp_f32 v68, v68 clamp
v_exp_f32 v69, v69 clamp
v_exp_f32 v70, v70 clamp
v_exp_f32 v71, v71 clamp
v_max_f32 v140, s24, v140
v_max_f32 v141, s24, v141
s_mov_b32 s47, 15360
buffer_load_dwordx4 a[252:255], v10, s[4:7], s47 offen offset:0 sc1
v_max_f32 v142, s24, v142
v_max_f32 v143, s24, v143
v_pk_add_f32 v[140:141], v[140:141], v[68:69] op_sel:[0,0] op_sel_hi:[1,1]
v_pk_add_f32 v[142:143], v[142:143], v[70:71] op_sel:[0,0] op_sel_hi:[1,1]
v_cvt_pk_bf16_f32 v174, v140, v141
v_cvt_pk_bf16_f32 v175, v142, v143
v_pk_fma_f32 v[112:113], v[36:37], v[164:165], v[112:113] op_sel:[0,0,0] op_sel_hi:[0,1,1] neg_lo:[1,0,0] neg_hi:[1,0,0]
v_pk_fma_f32 v[114:115], v[36:37], v[166:167], v[114:115] op_sel:[0,0,0] op_sel_hi:[0,1,1] neg_lo:[1,0,0] neg_hi:[1,0,0]
v_pk_mul_f32 v[68:69], v[112:113], v[40:41] op_sel:[0,0] op_sel_hi:[1,0]
v_pk_mul_f32 v[70:71], v[114:115], v[40:41] op_sel:[0,0] op_sel_hi:[1,0]
v_pk_fma_f32 v[112:113], v[112:113], v[38:39], s[24:25] op_sel:[0,0,0] op_sel_hi:[1,0,0]
v_pk_fma_f32 v[114:115], v[114:115], v[38:39], s[24:25] op_sel:[0,0,0] op_sel_hi:[1,0,0]
v_exp_f32 v68, v68 clamp
v_exp_f32 v69, v69 clamp
v_exp_f32 v70, v70 clamp
v_exp_f32 v71, v71 clamp
buffer_load_dwordx4 a[156:159], v10, s[4:7], s47 offen offset:1024 sc1
v_max_f32 v112, s24, v112
v_max_f32 v113, s24, v113
v_max_f32 v114, s24, v114
v_max_f32 v115, s24, v115
v_pk_add_f32 v[112:113], v[112:113], v[68:69] op_sel:[0,0] op_sel_hi:[1,1]
v_pk_add_f32 v[114:115], v[114:115], v[70:71] op_sel:[0,0] op_sel_hi:[1,1]
v_cvt_pk_bf16_f32 v176, v112, v113
v_cvt_pk_bf16_f32 v177, v114, v115
v_pk_fma_f32 v[144:145], v[36:37], v[164:165], v[144:145] op_sel:[1,0,0] op_sel_hi:[1,1,1] neg_lo:[1,0,0] neg_hi:[1,0,0]
v_pk_fma_f32 v[146:147], v[36:37], v[166:167], v[146:147] op_sel:[1,0,0] op_sel_hi:[1,1,1] neg_lo:[1,0,0] neg_hi:[1,0,0]
v_pk_mul_f32 v[68:69], v[144:145], v[40:41] op_sel:[0,1] op_sel_hi:[1,1]
v_pk_mul_f32 v[70:71], v[146:147], v[40:41] op_sel:[0,1] op_sel_hi:[1,1]
v_pk_fma_f32 v[144:145], v[144:145], v[38:39], s[24:25] op_sel:[0,1,0] op_sel_hi:[1,1,0]
v_pk_fma_f32 v[146:147], v[146:147], v[38:39], s[24:25] op_sel:[0,1,0] op_sel_hi:[1,1,0]
v_exp_f32 v68, v68 clamp
v_exp_f32 v69, v69 clamp
buffer_load_dwordx4 a[160:163], v10, s[4:7], s47 offen offset:2048 sc1
v_exp_f32 v70, v70 clamp
v_exp_f32 v71, v71 clamp
v_max_f32 v144, s24, v144
v_max_f32 v145, s24, v145
v_max_f32 v146, s24, v146
v_max_f32 v147, s24, v147
v_pk_add_f32 v[144:145], v[144:145], v[68:69] op_sel:[0,0] op_sel_hi:[1,1]
v_pk_add_f32 v[146:147], v[146:147], v[70:71] op_sel:[0,0] op_sel_hi:[1,1]
v_cvt_pk_bf16_f32 v180, v144, v145
v_cvt_pk_bf16_f32 v181, v146, v147
buffer_load_dwordx4 a[164:167], v10, s[4:7], s47 offen offset:3072 sc1
s_mov_b32 s47, 19456
buffer_load_dwordx4 a[168:171], v10, s[4:7], s47 offen offset:0 sc1
s_mov_b32 s47, 20480
buffer_load_dwordx4 a[172:175], v10, s[4:7], s47 offen offset:0 sc1
s_add_u32 s49, s49, 16
s_cmp_lg_u32 s10, 1
s_cbranch_scc1 L_gd_28
s_mov_b32 s42, 200000
s_waitcnt vmcnt(9)
v_cmp_le_u32 vcc, s49, v253
s_cmp_eq_u32 vcc_lo, 0xffff
s_cbranch_scc1 L_gd_28
s_waitcnt vmcnt(6)
L_gp_27:
v_cmp_le_u32 vcc, s49, v252
s_cmp_eq_u32 vcc_lo, 0xffff
s_cbranch_scc1 L_gd_28
v_mov_b32 v252, 0
buffer_atomic_add v252, v153, s[4:7], 0 offen sc0
s_sub_u32 s42, s42, 1
s_waitcnt vmcnt(0)
s_cbranch_scc0 L_gp_27
L_gd_28:
s_barrier
buffer_load_dwordx4 v[192:195], v224, s[4:7], s3 offen sc1
buffer_load_dwordx4 v[196:199], v225, s[4:7], s3 offen sc1
buffer_load_dwordx4 v[200:203], v226, s[4:7], s3 offen sc1
buffer_load_dwordx4 v[204:207], v227, s[4:7], s3 offen sc1
s_mul_i32 s17, s12, 245760
s_mul_i32 s44, s10, 6144
s_add_u32 s17, s17, s44
s_add_u32 s17, s17, 3440640
v_add_u32 v8, s17, v2
s_mul_i32 s45, s8, 24576
s_add_u32 s46, s45, 3072
s_mul_i32 s17, s14, 245760
s_mul_i32 s19, s10, 61440
s_add_u32 s17, s17, s19
s_add_u32 s17, s17, 7372800
v_add_u32 v11, s17, v2
v_mov_b32 v178, 0
v_mov_b32 v179, 0
v_mov_b32 v182, 0
v_mov_b32 v183, 0
buffer_load_dwordx4 a[176:179], v10, s[4:7], s47 offen offset:1024 sc1
buffer_load_dwordx4 a[180:183], v10, s[4:7], s47 offen offset:2048 sc1
buffer_load_dwordx4 a[184:187], v10, s[4:7], s47 offen offset:3072 sc1
s_mov_b32 s47, 24576
buffer_load_dwordx4 a[188:191], v10, s[4:7], s47 offen offset:0 sc1
s_add_u32 m0, s44, 0
s_nop 0
buffer_load_dwordx4 v8, s[4:7], s45 offen offset:0 sc1 lds
buffer_load_dwordx4 v8, s[4:7], s45 offen offset:1024 sc1 lds
buffer_load_dwordx4 v8, s[4:7], s45 offen offset:2048 sc1 lds
s_add_u32 m0, s44, 3072
s_nop 0
buffer_load_dwordx4 v8, s[4:7], s46 offen offset:0 sc1 lds
buffer_load_dwordx4 v8, s[4:7], s46 offen offset:1024 sc1 lds
s_waitcnt vmcnt(9)
v_cvt_pk_bf16_f32 v72, v192, v193
v_cvt_pk_bf16_f32 v73, v194, v195
v_cvt_pk_bf16_f32 v74, v196, v197
v_cvt_pk_bf16_f32 v75, v198, v199
ds_write_b128 v154, v[72:75] offset:0
v_cvt_pk_bf16_f32 v76, v200, v201
v_cvt_pk_bf16_f32 v77, v202, v203
v_cvt_pk_bf16_f32 v78, v204, v205
v_cvt_pk_bf16_f32 v79, v206, v207
ds_write_b128 v154, v[76:79] offset:1024
s_waitcnt lgkmcnt(0)
s_barrier
buffer_load_dwordx4 v8, s[4:7], s46 offen offset:2048 sc1 lds
s_add_u32 s45, s45, 24576
s_add_u32 s46, s45, 3072
ds_read_b128 v[212:215], v155 offset:5120
ds_read_b128 v[216:219], v155 offset:6144
ds_read_b128 v[192:195], v155 offset:0
ds_read_b128 v[196:199], v155 offset:1024
ds_read_b128 v[200:203], v155 offset:2048
ds_read_b128 v[204:207], v155 offset:3072
ds_read_b128 v[208:211], v155 offset:4096
s_waitcnt lgkmcnt(6)
v_mfma_f32_16x16x32_bf16 v[104:107], v[212:215], v[168:171], v[120:123]
v_mfma_f32_16x16x32_bf16 v[136:139], v[212:215], v[172:175], v[120:123]
s_waitcnt lgkmcnt(5)
v_mfma_f32_16x16x32_bf16 v[104:107], v[216:219], v[176:179], v[104:107]
v_mfma_f32_16x16x32_bf16 v[136:139], v[216:219], v[180:183], v[136:139]
s_waitcnt lgkmcnt(4)
v_mfma_f32_16x16x32_bf16 v[92:95], v[192:195], v[168:171], 0
v_mfma_f32_16x16x32_bf16 v[124:127], v[192:195], v[172:175], 0
s_waitcnt lgkmcnt(3)
v_mfma_f32_16x16x32_bf16 v[96:99], v[196:199], v[168:171], 0
v_mfma_f32_16x16x32_bf16 v[128:131], v[196:199], v[172:175], 0
s_waitcnt lgkmcnt(2)
v_mfma_f32_16x16x32_bf16 v[96:99], v[200:203], v[176:179], v[96:99]
v_mfma_f32_16x16x32_bf16 v[128:131], v[200:203], v[180:183], v[128:131]
s_waitcnt lgkmcnt(1)
v_mfma_f32_16x16x32_bf16 v[100:103], v[204:207], v[168:171], 0
v_mfma_f32_16x16x32_bf16 v[132:135], v[204:207], v[172:175], 0
s_waitcnt lgkmcnt(0)
v_mfma_f32_16x16x32_bf16 v[100:103], v[208:211], v[176:179], v[100:103]
v_mfma_f32_16x16x32_bf16 v[132:135], v[208:211], v[180:183], v[132:135]
s_add_u32 m0, s44, 24576
s_nop 0
buffer_load_dwordx4 v8, s[4:7], s45 offen offset:0 sc1 lds
buffer_load_dwordx4 v8, s[4:7], s45 offen offset:1024 sc1 lds
v_rcp_f32 v104, v104
v_rcp_f32 v105, v105
v_rcp_f32 v136, v136
v_rcp_f32 v137, v137
v_cndmask_b32 v106, v104, v105, s[36:37]
v_cndmask_b32 v138, v136, v137, s[36:37]
v_pk_mul_f32 v[92:93], v[92:93], v[104:105] op_sel:[0,0] op_sel_hi:[1,0]
v_pk_mul_f32 v[94:95], v[94:95], v[104:105] op_sel:[0,0] op_sel_hi:[1,0]
v_cvt_pk_bf16_f32 v168, v92, v93
v_cvt_pk_bf16_f32 v169, v94, v95
v_pk_mul_f32 v[96:97], v[96:97], v[106:107] op_sel:[0,0] op_sel_hi:[1,0]
v_pk_mul_f32 v[98:99], v[98:99], v[106:107] op_sel:[0,0] op_sel_hi:[1,0]
v_cvt_pk_bf16_f32 v170, v96, v97
v_cvt_pk_bf16_f32 v171, v98, v99
buffer_store_dwordx4 v[168:171], v19, s[4:7], 0 offen sc1
v_pk_mul_f32 v[124:125], v[124:125], v[136:137] op_sel:[0,0] op_sel_hi:[1,0]
v_pk_mul_f32 v[126:127], v[126:127], v[136:137] op_sel:[0,0] op_sel_hi:[1,0]
v_cvt_pk_bf16_f32 v172, v124, v125
v_cvt_pk_bf16_f32 v173, v126, v127
v_pk_mul_f32 v[128:129], v[128:129], v[138:139] op_sel:[0,0] op_sel_hi:[1,0]
v_pk_mul_f32 v[130:131], v[130:131], v[138:139] op_sel:[0,0] op_sel_hi:[1,0]
v_cvt_pk_bf16_f32 v174, v128, v129
v_cvt_pk_bf16_f32 v175, v130, v131
buffer_store_dwordx4 v[172:175], v19, s[4:7], s23 offen sc1
v_pk_mul_f32 v[100:101], v[100:101], v[104:105] op_sel:[0,1] op_sel_hi:[1,1]
v_pk_mul_f32 v[102:103], v[102:103], v[104:105] op_sel:[0,1] op_sel_hi:[1,1]
v_cvt_pk_bf16_f32 v176, v100, v101
v_cvt_pk_bf16_f32 v177, v102, v103
v_mov_b32 v178, v176
v_mov_b32 v179, v177
s_nop 0
v_permlane16_swap_b32 v176, v178
v_permlane16_swap_b32 v177, v179
buffer_store_dwordx4 v[176:179], v20, s[4:7], 0 offen sc1
v_pk_mul_f32 v[132:133], v[132:133], v[136:137] op_sel:[0,1] op_sel_hi:[1,1]
v_pk_mul_f32 v[134:135], v[134:135], v[136:137] op_sel:[0,1] op_sel_hi:[1,1]
v_cvt_pk_bf16_f32 v180, v132, v133
v_cvt_pk_bf16_f32 v181, v134, v135
v_mov_b32 v182, v180
v_mov_b32 v183, v181
s_nop 0
v_permlane16_swap_b32 v180, v182
v_permlane16_swap_b32 v181, v183
buffer_store_dwordx4 v[180:183], v20, s[4:7], s23 offen sc1
s_branch L_mid
L_final:
v_mov_b32 v28, v236
v_mov_b32 v29, v237
v_mov_b32 v30, v236
v_mov_b32 v31, v237
v_permlane32_swap_b32 v228, v230
v_permlane32_swap_b32 v229, v231
v_permlane32_swap_b32 v232, v234
v_permlane32_swap_b32 v233, v235
v_permlane16_swap_b32 v228, v230
v_permlane16_swap_b32 v229, v231
v_permlane16_swap_b32 v232, v234
v_permlane16_swap_b32 v233, v235
buffer_store_dwordx4 v[228:231], v238, s[32:35], s30 offen
v_permlane16_swap_b32 v28, v30
v_permlane16_swap_b32 v29, v31
buffer_store_dwordx4 v[232:235], v238, s[32:35], s30 offen offset:64
buffer_store_dwordx4 v[28:31], v239, s[32:35], s29 offen
L_end:
s_endpgm
L_code_end:
.section .rodata,"a"
.p2align 6
.amdhsa_kernel interleave_layers__linear_attn_block__geglu_ffn__prompt_kernel
  .amdhsa_next_free_vgpr 512
  .amdhsa_next_free_sgpr 102
  .amdhsa_accum_offset 256
  .amdhsa_group_segment_fixed_size 0
  .amdhsa_kernarg_size 80
  .amdhsa_user_sgpr_count 2
  .amdhsa_user_sgpr_kernarg_segment_ptr 1
  .amdhsa_system_sgpr_workgroup_id_x 1
.end_amdhsa_kernel
.text
```
